```python
import torch

def _softmax(x, axis=-1):
    return torch.softmax(x, dim=axis)
def _gelu(x):
    return torch.nn.functional.gelu(x, approximate="tanh")
def _silu(x):
    return torch.nn.functional.silu(x)
def _sigmoid(x):
    return torch.sigmoid(x)
def _layernorm(x, axis=-1, eps=1e-5):
    m = x.mean(dim=axis, keepdim=True)
    v = x.var(dim=axis, keepdim=True, unbiased=False)
    return (x - m) / torch.sqrt(v + eps)
def _scatter_add(tgt, idx, src, axis=0):
    return tgt.clone().index_add_(axis, idx, src)
def _segment_sum(src, seg, n):
    out = torch.zeros((n,) + src.shape[1:], dtype=src.dtype)
    return out.index_add_(0, seg, src)
def _pad(x, pw):
    flat = tuple(v for pair in reversed(pw) for v in pair)
    return torch.nn.functional.pad(x, flat)

kernel_name = 'gated_mix__grouped_kv_mqa__compressed_kv_cla__prompt'

def setup_inputs():

    _w = (lambda a: (lambda t: t.to(torch.bfloat16) if t.is_floating_point() else t)(torch.as_tensor(a)))
    def _A_setup():
        B, S, D, H = 1, 2048, 512, 32
        Dh = D // H
        return {
            "x": _w((lambda *s: torch.randn(*s, dtype=torch.bfloat16) * 0.05)(B, S, D)),
            "wq": _w((lambda *s: torch.randn(*s, dtype=torch.bfloat16) * 1.6)(D, H * Dh)),
            "wk": _w((lambda *s: torch.randn(*s, dtype=torch.bfloat16) * 1.6)(D, Dh)),
            "wv": _w((lambda *s: torch.randn(*s, dtype=torch.bfloat16) * 0.8)(D, Dh)),
            "wo": _w((lambda *s: torch.randn(*s, dtype=torch.bfloat16) * 0.8)(H * Dh, D)),
        }
    _A_in = _A_setup()

    def _B_setup():
        B, H, Sq, Sk, D, M = 1, 32, 2048, 2048, 128, 512
        Dc = 4 * D
        return {
            "x": _w((lambda *s: torch.randn(*s, dtype=torch.bfloat16) * 0.05)(B, Sq, M)),
            "c_kv": _w((lambda *s: torch.randn(*s, dtype=torch.bfloat16) * 1.6)(B, Sk, Dc)),
            "w_q": _w((lambda *s: torch.randn(*s, dtype=torch.bfloat16) * 6.4)(M, H, D) * (M ** -0.5)),
            "w_uk": _w((lambda *s: torch.randn(*s, dtype=torch.bfloat16) * 6.4)(Dc, H, D) * (Dc ** -0.5)),
            "w_uv": _w((lambda *s: torch.randn(*s, dtype=torch.bfloat16) * 1.6)(Dc, H, D) * (Dc ** -0.5)),
            "w_o": _w((lambda *s: torch.randn(*s, dtype=torch.bfloat16) * 1.6)(H, D, M) * ((H * D) ** -0.5)),
        }
    _B_in = _B_setup()

    return {
        "A_x": _A_in["x"],
        "A_wq": _A_in["wq"],
        "A_wk": _A_in["wk"],
        "A_wv": _A_in["wv"],
        "A_wo": _A_in["wo"],
        "B_x": _B_in["x"],
        "B_c_kv": _B_in["c_kv"],
        "B_w_q": _B_in["w_q"],
        "B_w_uk": _B_in["w_uk"],
        "B_w_uv": _B_in["w_uv"],
        "B_w_o": _B_in["w_o"],
        "gate_w": _w((lambda *s: torch.randn(*s, dtype=torch.bfloat16) * 0.1)(512) * 16.0),
    }

def reference(A_x, A_wq, A_wk, A_wv, A_wo, B_x, B_c_kv, B_w_q, B_w_uk, B_w_uv, B_w_o, gate_w):
    def _A_ref(x, wq, wk, wv, wo):
        B, S, D = x.shape
        H = 32
        Dh = D // H
        q = (lambda x, *d: x.permute(*d))((x @ wq).reshape(B, S, H, Dh), 0, 2, 1, 3)
        k = x @ wk
        v = x @ wv
        scores = torch.einsum("bhqd,bkd->bhqk", q, k) * (Dh ** -0.5)
        p = _softmax(scores, axis=-1)
        o = torch.einsum("bhqk,bkd->bhqd", p, v)
        return (lambda x, *d: x.permute(*d))(o, 0, 2, 1, 3).reshape(B, S, H * Dh) @ wo

    def _B_ref(x, c_kv, w_q, w_uk, w_uv, w_o):
        B, Sq, M = x.shape[0], x.shape[1], x.shape[2]
        Sk = c_kv.shape[1]
        H, D = w_q.shape[1], w_q.shape[2]
        q = torch.einsum("bqm,mhd->bhqd", x, w_q)
        k = torch.einsum("bkc,chd->bhkd", c_kv, w_uk)
        v = torch.einsum("bkc,chd->bhkd", c_kv, w_uv)
        scores = torch.einsum("bhqd,bhkd->bhqk", q, k) * (D ** -0.5)
        off = Sk - Sq
        qi = torch.arange(Sq)[:, None]
        kj = torch.arange(Sk)[None, :]
        cmask = kj <= (qi + off)
        scores = torch.where(cmask[None, None], scores, -1e9)
        p = _softmax(scores, axis=-1)
        ctx = torch.einsum("bhqk,bhkd->bhqd", p, v)
        return torch.einsum("bhqd,hdm->bqm", ctx, w_o)

    x = A_x
    g = _sigmoid((x * gate_w).sum(-1, keepdims=True))
    a = _A_ref(x, A_wq, A_wk, A_wv, A_wo)
    b = _B_ref(x, B_c_kv, B_w_q, B_w_uk, B_w_uv, B_w_o)
    return g * a + (1 - g) * b
```

```asm
; @launch kernel=projattn_kernel grid=(256,1,1) block=(256,1,1) lds=163840
; @launch kernel=mqa_kernel grid=(256,1,1) block=(512,1,1) lds=132096
.amdgcn_target "amdgcn-amd-amdhsa--gfx950"
.text
.globl projattn_kernel
.p2align 8
.type projattn_kernel,@function
projattn_kernel:
    s_cmp_ge_u32 s2, 256
    s_cbranch_scc1 A_END
    s_load_dwordx8 s[16:23], s[0:1], 0
    s_load_dwordx8 s[24:31], s[0:1], 48
    s_load_dwordx4 s[52:55], s[0:1], 80
    s_load_dwordx2 s[34:35], s[0:1], 112
    s_load_dwordx2 s[56:57], s[0:1], 32
    s_load_dwordx2 s[72:73], s[0:1], 104
    v_lshrrev_b32 v1, 6, v0
    v_and_b32 v0, 63, v0
    v_readfirstlane_b32 s3, v1
    s_getpc_b64 s[96:97]
L1_PC:
    v_lshlrev_b32 v250, 7, v0
    s_lshl_b32 s98, s3, 13
    v_add_u32 v250, s98, v250
    v_min_u32 v252, TEXT_END-L1_PC-4, v250
    global_load_dword v251, v252, s[96:97]
    v_add_u32 v250, 32768, v250
    v_min_u32 v252, TEXT_END-L1_PC-4, v250
    global_load_dword v251, v252, s[96:97]
    s_and_b32 s4, s2, 7
    s_lshl_b32 s4, s4, 2
    s_lshr_b32 s96, s2, 3
    s_and_b32 s96, s96, 3
    s_add_u32 s4, s4, s96
    s_lshr_b32 s5, s2, 5
    v_lshrrev_b32 v24, 2, v0
    v_lshrrev_b32 v25, 4, v0
    v_and_b32 v26, 3, v0
    v_and_b32 v27, 7, v0
    v_xor_b32 v27, v27, v25
    v_lshlrev_b32 v27, 4, v27
    v_lshrrev_b32 v28, 3, v0
    v_lshl_add_u32 v27, v28, 10, v27
    s_lshl_b32 s96, s5, 8
    s_lshl_b32 s97, s3, 6
    s_add_u32 s96, s96, s97
    s_lshl_b32 s98, s96, 10
    v_add_u32 v1, s98, v27
    v_xor_b32 v2, 64, v1
    v_and_b32 v27, 3, v24
    v_xor_b32 v27, v27, v25
    v_lshlrev_b32 v27, 6, v27
    v_lshl_add_u32 v27, v26, 4, v27
    v_lshl_add_u32 v35, v25, 10, v27
    v_lshl_add_u32 v27, v25, 13, v27
    s_lshl_b32 s98, s4, 8
    s_lshl_b32 s99, s3, 17
    s_add_u32 s98, s98, s99
    v_add_u32 v3, s98, v27
    v_and_b32 v28, 31, v0
    v_lshrrev_b32 v29, 5, v0
    v_bfe_u32 v30, v28, 1, 3
    v_xor_b32 v30, v30, v29
    v_lshlrev_b32 v30, 4, v30
    v_lshl_add_u32 v30, v28, 7, v30
    s_lshl_b32 s74, s3, 13
    v_add_u32 v14, s74, v30
    s_lshl_b32 s75, s3, 12
    s_add_u32 s75, s75, 32768
    v_and_b32 v30, 3, v24
    v_and_b32 v31, 1, v25
    v_lshl_add_u32 v32, v29, 3, v30
    v_lshlrev_b32 v33, 3, v26
    v_lshl_add_u32 v33, v31, 5, v33
    v_lshl_add_u32 v33, v32, 8, v33
    v_add_u32 v33, 32768, v33
    v_xor_b32 v34, 0, v30
    v_lshl_add_u32 v16, v34, 6, v33
    v_xor_b32 v34, 1, v30
    v_lshl_add_u32 v17, v34, 6, v33
    v_xor_b32 v34, 2, v30
    v_lshl_add_u32 v18, v34, 6, v33
    v_xor_b32 v34, 3, v30
    v_lshl_add_u32 v19, v34, 6, v33
    v_add_u32 v4, 0, v14
    v_xor_b32 v5, 32, v4
    v_xor_b32 v6, 64, v4
    v_xor_b32 v7, 96, v4
    v_add_u32 v8, 0, v16
    v_add_u32 v9, 0, v17
    v_add_u32 v10, 0, v18
    v_add_u32 v11, 0, v19
    v_lshlrev_b32 v12, 4, v0
    s_lshl_b32 s98, s5, 8
    s_lshl_b32 s99, s4, 3
    s_add_u32 s98, s98, s99
    s_lshl_b32 s99, s3, 1
    s_add_u32 s98, s98, s99
    v_add_u32 v56, s98, v29
    v_lshlrev_b32 v57, 5, v28
    v_lshl_add_u32 v58, v56, 10, v57
    v_mov_b32 v59, v28
    s_lshr_b32 s98, s2, 3
    s_lshl_b32 s98, s98, 2
    s_add_u32 s98, s98, s3
    s_lshl_b32 s99, s98, 14
    s_add_u32 s99, s99, 256
    v_bfe_u32 v20, v0, 1, 4
    v_lshlrev_b32 v20, 10, v20
    v_and_b32 v34, 1, v0
    v_lshl_add_u32 v20, v34, 7, v20
    v_add_u32 v20, s99, v20
    s_lshl_b32 s98, s98, 13
    s_and_b32 s99, s2, 7
    s_lshl_b32 s99, s99, 10
    s_add_u32 s98, s98, s99
    s_add_u32 s98, s98, 0x100000
    v_and_b32 v21, 7, v0
    v_lshlrev_b32 v21, 7, v21
    v_add_u32 v21, s98, v21
    s_lshl_b32 s98, s2, 14
    s_lshl_b32 s99, s3, 8
    s_add_u32 s98, s98, s99
    v_add_u32 v22, s98, v35
    s_waitcnt lgkmcnt(0)
    s_mov_b32 s40, s24
    s_and_b32 s41, s25, 0xffff
    s_mov_b32 s42, 2097152
    s_mov_b32 s43, 0x20000
    s_mov_b32 s44, s28
    s_and_b32 s45, s29, 0xffff
    s_mov_b32 s46, 4194304
    s_mov_b32 s47, 0x20000
    s_mov_b32 s36, s16
    s_and_b32 s37, s17, 0xffff
    s_mov_b32 s38, 2097152
    s_mov_b32 s39, 0x20000
    s_mov_b32 s64, s54
    s_and_b32 s65, s55, 0xffff
    s_mov_b32 s66, 1024
    s_mov_b32 s67, 0x20000
    buffer_load_dwordx4 v[60:63], v58, s[36:39], 0 offen
    buffer_load_dwordx4 v[64:67], v58, s[36:39], 0 offen offset:16
    buffer_load_dwordx4 v[68:71], v57, s[64:67], 0 offen
    buffer_load_dwordx4 v[72:75], v57, s[64:67], 0 offen offset:16
    s_add_u32 m0, s74, 0
    s_mov_b32 s96, 0
    buffer_load_dwordx4 v1, s[40:43], s96 offen offset:0 lds
    s_add_u32 m0, s74, 0
    s_mov_b32 s96, 7168
    buffer_load_dwordx4 v2, s[40:43], s96 offen offset:1024 lds
    s_add_u32 m0, s74, 0
    s_mov_b32 s96, 14336
    buffer_load_dwordx4 v1, s[40:43], s96 offen offset:2048 lds
    s_add_u32 m0, s74, 0
    s_mov_b32 s96, 21504
    buffer_load_dwordx4 v2, s[40:43], s96 offen offset:3072 lds
    s_add_u32 m0, s74, 4096
    s_mov_b32 s96, 32768
    buffer_load_dwordx4 v1, s[40:43], s96 offen offset:0 lds
    s_add_u32 m0, s74, 4096
    s_mov_b32 s96, 39936
    buffer_load_dwordx4 v2, s[40:43], s96 offen offset:1024 lds
    s_add_u32 m0, s74, 4096
    s_mov_b32 s96, 47104
    buffer_load_dwordx4 v1, s[40:43], s96 offen offset:2048 lds
    s_add_u32 m0, s74, 4096
    s_mov_b32 s96, 54272
    buffer_load_dwordx4 v2, s[40:43], s96 offen offset:3072 lds
    s_add_u32 m0, s75, 0
    s_mov_b32 s96, 0
    buffer_load_dwordx4 v3, s[44:47], s96 offen offset:0 lds
    s_add_u32 m0, s75, 0
    s_mov_b32 s96, 31744
    buffer_load_dwordx4 v3, s[44:47], s96 offen offset:1024 lds
    s_add_u32 m0, s75, 0
    s_mov_b32 s96, 63488
    buffer_load_dwordx4 v3, s[44:47], s96 offen offset:2048 lds
    s_add_u32 m0, s75, 0
    s_mov_b32 s96, 95232
    buffer_load_dwordx4 v3, s[44:47], s96 offen offset:3072 lds
    s_add_u32 m0, s74, 49152
    s_mov_b32 s96, 128
    buffer_load_dwordx4 v1, s[40:43], s96 offen offset:0 lds
    s_add_u32 m0, s74, 49152
    s_mov_b32 s96, 7296
    buffer_load_dwordx4 v2, s[40:43], s96 offen offset:1024 lds
    s_add_u32 m0, s74, 49152
    s_mov_b32 s96, 14464
    buffer_load_dwordx4 v1, s[40:43], s96 offen offset:2048 lds
    s_add_u32 m0, s74, 49152
    s_mov_b32 s96, 21632
    buffer_load_dwordx4 v2, s[40:43], s96 offen offset:3072 lds
    s_add_u32 m0, s74, 53248
    s_mov_b32 s96, 32896
    buffer_load_dwordx4 v1, s[40:43], s96 offen offset:0 lds
    s_add_u32 m0, s74, 53248
    s_mov_b32 s96, 40064
    buffer_load_dwordx4 v2, s[40:43], s96 offen offset:1024 lds
    s_add_u32 m0, s74, 53248
    s_mov_b32 s96, 47232
    buffer_load_dwordx4 v1, s[40:43], s96 offen offset:2048 lds
    s_add_u32 m0, s74, 53248
    s_mov_b32 s96, 54400
    buffer_load_dwordx4 v2, s[40:43], s96 offen offset:3072 lds
    s_add_u32 m0, s75, 49152
    s_mov_b32 s96, 524288
    buffer_load_dwordx4 v3, s[44:47], s96 offen offset:0 lds
    s_add_u32 m0, s75, 49152
    s_mov_b32 s96, 556032
    buffer_load_dwordx4 v3, s[44:47], s96 offen offset:1024 lds
    s_add_u32 m0, s75, 49152
    s_mov_b32 s96, 587776
    buffer_load_dwordx4 v3, s[44:47], s96 offen offset:2048 lds
    s_add_u32 m0, s75, 49152
    s_mov_b32 s96, 619520
    buffer_load_dwordx4 v3, s[44:47], s96 offen offset:3072 lds
    s_mov_b32 s48, s30
    s_and_b32 s49, s31, 0xffff
    s_mov_b32 s50, 4194304
    s_mov_b32 s51, 0x20000
    s_mov_b32 s68, s34
    s_and_b32 s69, s35, 0xffff
    s_mov_b32 s70, 268435456
    s_mov_b32 s71, 0x20000
    s_lshl_b32 s98, s4, 19
    s_lshl_b32 s99, s5, 3
    s_lshl_b32 s100, s3, 1
    s_add_u32 s99, s99, s100
    s_lshl_b32 s100, s99, 13
    s_add_u32 s98, s98, s100
    s_add_u32 s76, s98, 16777216
    s_add_u32 s80, s98, 33554432
    s_add_u32 s77, s98, 16781312
    s_add_u32 s81, s98, 33558528
    s_add_u32 s78, s98, 16785408
    s_add_u32 s82, s98, 33562624
    s_add_u32 s79, s98, 16789504
    s_add_u32 s83, s98, 33566720
    v_mov_b32 v76, 0
    s_mov_b32 s100, 0xffff0000
    s_waitcnt vmcnt(27)
    v_lshlrev_b32 v78, 16, v60
    v_and_b32 v79, s100, v60
    s_waitcnt vmcnt(25)
    v_lshlrev_b32 v80, 16, v68
    v_and_b32 v81, s100, v68
    v_mul_f32 v78, v78, v80
    v_mul_f32 v79, v79, v81
    v_cvt_pk_bf16_f32 v78, v78, v79
    v_lshlrev_b32 v79, 16, v78
    v_and_b32 v78, s100, v78
    v_add_f32 v76, v76, v79
    v_add_f32 v76, v76, v78
    v_lshlrev_b32 v78, 16, v61
    v_and_b32 v79, s100, v61
    v_lshlrev_b32 v80, 16, v69
    v_and_b32 v81, s100, v69
    v_mul_f32 v78, v78, v80
    v_mul_f32 v79, v79, v81
    v_cvt_pk_bf16_f32 v78, v78, v79
    v_lshlrev_b32 v79, 16, v78
    v_and_b32 v78, s100, v78
    v_add_f32 v76, v76, v79
    v_add_f32 v76, v76, v78
    v_lshlrev_b32 v78, 16, v62
    v_and_b32 v79, s100, v62
    v_lshlrev_b32 v80, 16, v70
    v_and_b32 v81, s100, v70
    v_mul_f32 v78, v78, v80
    v_mul_f32 v79, v79, v81
    v_cvt_pk_bf16_f32 v78, v78, v79
    v_lshlrev_b32 v79, 16, v78
    v_and_b32 v78, s100, v78
    v_add_f32 v76, v76, v79
    v_add_f32 v76, v76, v78
    v_lshlrev_b32 v78, 16, v63
    v_and_b32 v79, s100, v63
    v_lshlrev_b32 v80, 16, v71
    v_and_b32 v81, s100, v71
    v_mul_f32 v78, v78, v80
    v_mul_f32 v79, v79, v81
    v_cvt_pk_bf16_f32 v78, v78, v79
    v_lshlrev_b32 v79, 16, v78
    v_and_b32 v78, s100, v78
    v_add_f32 v76, v76, v79
    v_add_f32 v76, v76, v78
    v_lshlrev_b32 v78, 16, v64
    v_and_b32 v79, s100, v64
    s_waitcnt vmcnt(24)
    v_lshlrev_b32 v80, 16, v72
    v_and_b32 v81, s100, v72
    v_mul_f32 v78, v78, v80
    v_mul_f32 v79, v79, v81
    v_cvt_pk_bf16_f32 v78, v78, v79
    v_lshlrev_b32 v79, 16, v78
    v_and_b32 v78, s100, v78
    v_add_f32 v76, v76, v79
    v_add_f32 v76, v76, v78
    v_lshlrev_b32 v78, 16, v65
    v_and_b32 v79, s100, v65
    v_lshlrev_b32 v80, 16, v73
    v_and_b32 v81, s100, v73
    v_mul_f32 v78, v78, v80
    v_mul_f32 v79, v79, v81
    v_cvt_pk_bf16_f32 v78, v78, v79
    v_lshlrev_b32 v79, 16, v78
    v_and_b32 v78, s100, v78
    v_add_f32 v76, v76, v79
    v_add_f32 v76, v76, v78
    v_lshlrev_b32 v78, 16, v66
    v_and_b32 v79, s100, v66
    v_lshlrev_b32 v80, 16, v74
    v_and_b32 v81, s100, v74
    v_mul_f32 v78, v78, v80
    v_mul_f32 v79, v79, v81
    v_cvt_pk_bf16_f32 v78, v78, v79
    v_lshlrev_b32 v79, 16, v78
    v_and_b32 v78, s100, v78
    v_add_f32 v76, v76, v79
    v_add_f32 v76, v76, v78
    v_lshlrev_b32 v78, 16, v67
    v_and_b32 v79, s100, v67
    v_lshlrev_b32 v80, 16, v75
    v_and_b32 v81, s100, v75
    v_mul_f32 v78, v78, v80
    v_mul_f32 v79, v79, v81
    v_cvt_pk_bf16_f32 v78, v78, v79
    v_lshlrev_b32 v79, 16, v78
    v_and_b32 v78, s100, v78
    v_add_f32 v76, v76, v79
    v_add_f32 v76, v76, v78
    ds_swizzle_b32 v78, v76 offset:1055
    s_waitcnt lgkmcnt(0)
    v_add_f32 v76, v76, v78
    ds_swizzle_b32 v78, v76 offset:2079
    s_waitcnt lgkmcnt(0)
    v_add_f32 v76, v76, v78
    ds_swizzle_b32 v78, v76 offset:4127
    s_waitcnt lgkmcnt(0)
    v_add_f32 v76, v76, v78
    ds_swizzle_b32 v78, v76 offset:8223
    s_waitcnt lgkmcnt(0)
    v_add_f32 v76, v76, v78
    ds_swizzle_b32 v78, v76 offset:16415
    s_waitcnt lgkmcnt(0)
    v_add_f32 v76, v76, v78
    v_cvt_pk_bf16_f32 v76, v76, v76
    v_lshlrev_b32 v76, 16, v76
    v_mul_f32 v76, 0xbfb8aa3b, v76
    v_exp_f32 v76, v76
    s_nop 0
    v_add_f32 v76, 1.0, v76
    v_rcp_f32 v76, v76
    s_nop 0
    v_cvt_pk_bf16_f32 v76, v76, v76
    v_lshlrev_b32 v78, 16, v76
    v_sub_f32 v79, 1.0, v78
    v_cvt_pk_bf16_f32 v79, v79, v79
    v_lshlrev_b32 v79, 16, v79
    v_lshlrev_b32 v56, 3, v56
    v_cmp_eq_u32 vcc, 0, v59
    s_mov_b32 s100, 69337088
    s_and_saveexec_b64 s[98:99], vcc
    buffer_store_dwordx2 v[78:79], v56, s[68:71], s100 offen
    s_mov_b64 exec, s[98:99]
    s_waitcnt vmcnt(13)
    s_barrier
    ds_read_b128 a[0:3], v4 offset:0
    ds_read_b64_tr_b16 v[24:25], v8 offset:0
    ds_read_b64_tr_b16 v[26:27], v8 offset:1024
    ds_read_b128 a[4:7], v4 offset:4096
    ds_read_b64_tr_b16 v[28:29], v9 offset:0
    ds_read_b64_tr_b16 v[30:31], v9 offset:1024
    ds_read_b64_tr_b16 v[32:33], v10 offset:0
    ds_read_b64_tr_b16 v[34:35], v10 offset:1024
    ds_read_b64_tr_b16 v[36:37], v11 offset:0
    ds_read_b64_tr_b16 v[38:39], v11 offset:1024
    s_waitcnt lgkmcnt(0)
    v_mfma_f32_32x32x16_bf16 v[120:135], v[24:27], a[0:3], 0
    ds_read_b128 a[8:11], v5 offset:0
    ds_read_b64_tr_b16 v[40:41], v8 offset:4096
    ds_read_b64_tr_b16 v[42:43], v8 offset:5120
    v_mfma_f32_32x32x16_bf16 v[136:151], v[28:31], a[0:3], 0
    ds_read_b128 a[12:15], v5 offset:4096
    ds_read_b64_tr_b16 v[44:45], v9 offset:4096
    ds_read_b64_tr_b16 v[46:47], v9 offset:5120
    v_mfma_f32_32x32x16_bf16 v[152:167], v[32:35], a[0:3], 0
    ds_read_b64_tr_b16 v[48:49], v10 offset:4096
    ds_read_b64_tr_b16 v[50:51], v10 offset:5120
    ds_read_b64_tr_b16 v[52:53], v11 offset:4096
    v_mfma_f32_32x32x16_bf16 v[168:183], v[36:39], a[0:3], 0
    ds_read_b64_tr_b16 v[54:55], v11 offset:5120
    s_add_u32 m0, s74, 98304
    s_mov_b32 s96, 256
    buffer_load_dwordx4 v1, s[40:43], s96 offen offset:0 lds
    v_mfma_f32_32x32x16_bf16 v[184:199], v[24:27], a[4:7], 0
    s_add_u32 m0, s74, 98304
    s_mov_b32 s96, 7424
    buffer_load_dwordx4 v2, s[40:43], s96 offen offset:1024 lds
    s_add_u32 m0, s74, 98304
    s_mov_b32 s96, 14592
    buffer_load_dwordx4 v1, s[40:43], s96 offen offset:2048 lds
    v_mfma_f32_32x32x16_bf16 v[200:215], v[28:31], a[4:7], 0
    s_add_u32 m0, s74, 98304
    s_mov_b32 s96, 21760
    buffer_load_dwordx4 v2, s[40:43], s96 offen offset:3072 lds
    v_mfma_f32_32x32x16_bf16 v[216:231], v[32:35], a[4:7], 0
    s_add_u32 m0, s74, 102400
    s_mov_b32 s96, 33024
    buffer_load_dwordx4 v1, s[40:43], s96 offen offset:0 lds
    v_mfma_f32_32x32x16_bf16 v[232:247], v[36:39], a[4:7], 0
    s_add_u32 m0, s74, 102400
    s_mov_b32 s96, 40192
    buffer_load_dwordx4 v2, s[40:43], s96 offen offset:1024 lds
    s_waitcnt lgkmcnt(0)
    v_mfma_f32_32x32x16_bf16 v[120:135], v[40:43], a[8:11], v[120:135]
    ds_read_b128 a[16:19], v6 offset:0
    ds_read_b64_tr_b16 v[24:25], v8 offset:8192
    ds_read_b64_tr_b16 v[26:27], v8 offset:9216
    v_mfma_f32_32x32x16_bf16 v[136:151], v[44:47], a[8:11], v[136:151]
    ds_read_b128 a[20:23], v6 offset:4096
    ds_read_b64_tr_b16 v[28:29], v9 offset:8192
    ds_read_b64_tr_b16 v[30:31], v9 offset:9216
    v_mfma_f32_32x32x16_bf16 v[152:167], v[48:51], a[8:11], v[152:167]
    ds_read_b64_tr_b16 v[32:33], v10 offset:8192
    ds_read_b64_tr_b16 v[34:35], v10 offset:9216
    ds_read_b64_tr_b16 v[36:37], v11 offset:8192
    v_mfma_f32_32x32x16_bf16 v[168:183], v[52:55], a[8:11], v[168:183]
    ds_read_b64_tr_b16 v[38:39], v11 offset:9216
    s_add_u32 m0, s74, 102400
    s_mov_b32 s96, 47360
    buffer_load_dwordx4 v1, s[40:43], s96 offen offset:2048 lds
    v_mfma_f32_32x32x16_bf16 v[184:199], v[40:43], a[12:15], v[184:199]
    s_add_u32 m0, s74, 102400
    s_mov_b32 s96, 54528
    buffer_load_dwordx4 v2, s[40:43], s96 offen offset:3072 lds
    s_add_u32 m0, s75, 98304
    s_mov_b32 s96, 1048576
    buffer_load_dwordx4 v3, s[44:47], s96 offen offset:0 lds
    v_mfma_f32_32x32x16_bf16 v[200:215], v[44:47], a[12:15], v[200:215]
    s_add_u32 m0, s75, 98304
    s_mov_b32 s96, 1080320
    buffer_load_dwordx4 v3, s[44:47], s96 offen offset:1024 lds
    v_mfma_f32_32x32x16_bf16 v[216:231], v[48:51], a[12:15], v[216:231]
    v_mfma_f32_32x32x16_bf16 v[232:247], v[52:55], a[12:15], v[232:247]
    s_add_u32 m0, s75, 98304
    s_mov_b32 s96, 1112064
    buffer_load_dwordx4 v3, s[44:47], s96 offen offset:2048 lds
    s_waitcnt lgkmcnt(0)
    v_mfma_f32_32x32x16_bf16 v[120:135], v[24:27], a[16:19], v[120:135]
    ds_read_b128 a[24:27], v7 offset:0
    ds_read_b64_tr_b16 v[40:41], v8 offset:12288
    ds_read_b64_tr_b16 v[42:43], v8 offset:13312
    v_mfma_f32_32x32x16_bf16 v[136:151], v[28:31], a[16:19], v[136:151]
    ds_read_b128 a[28:31], v7 offset:4096
    ds_read_b64_tr_b16 v[44:45], v9 offset:12288
    ds_read_b64_tr_b16 v[46:47], v9 offset:13312
    v_mfma_f32_32x32x16_bf16 v[152:167], v[32:35], a[16:19], v[152:167]
    ds_read_b64_tr_b16 v[48:49], v10 offset:12288
    ds_read_b64_tr_b16 v[50:51], v10 offset:13312
    ds_read_b64_tr_b16 v[52:53], v11 offset:12288
    v_mfma_f32_32x32x16_bf16 v[168:183], v[36:39], a[16:19], v[168:183]
    ds_read_b64_tr_b16 v[54:55], v11 offset:13312
    s_add_u32 m0, s75, 98304
    s_mov_b32 s96, 1143808
    buffer_load_dwordx4 v3, s[44:47], s96 offen offset:3072 lds
    v_mfma_f32_32x32x16_bf16 v[184:199], v[24:27], a[20:23], v[184:199]
    v_mfma_f32_32x32x16_bf16 v[200:215], v[28:31], a[20:23], v[200:215]
    v_mfma_f32_32x32x16_bf16 v[216:231], v[32:35], a[20:23], v[216:231]
    s_waitcnt lgkmcnt(0)
    s_waitcnt vmcnt(13)
    s_barrier
    v_add_u32 v4, 49152, v14
    v_xor_b32 v5, 32, v4
    v_xor_b32 v6, 64, v4
    v_xor_b32 v7, 96, v4
    v_mfma_f32_32x32x16_bf16 v[232:247], v[36:39], a[20:23], v[232:247]
    v_add_u32 v8, 49152, v16
    v_add_u32 v9, 49152, v17
    v_add_u32 v10, 49152, v18
    v_add_u32 v11, 49152, v19
    v_mfma_f32_32x32x16_bf16 v[120:135], v[40:43], a[24:27], v[120:135]
    ds_read_b128 a[32:35], v4 offset:0
    ds_read_b64_tr_b16 v[24:25], v8 offset:0
    ds_read_b64_tr_b16 v[26:27], v8 offset:1024
    v_mfma_f32_32x32x16_bf16 v[136:151], v[44:47], a[24:27], v[136:151]
    ds_read_b128 a[36:39], v4 offset:4096
    ds_read_b64_tr_b16 v[28:29], v9 offset:0
    ds_read_b64_tr_b16 v[30:31], v9 offset:1024
    v_mfma_f32_32x32x16_bf16 v[152:167], v[48:51], a[24:27], v[152:167]
    ds_read_b64_tr_b16 v[32:33], v10 offset:0
    ds_read_b64_tr_b16 v[34:35], v10 offset:1024
    ds_read_b64_tr_b16 v[36:37], v11 offset:0
    v_mfma_f32_32x32x16_bf16 v[168:183], v[52:55], a[24:27], v[168:183]
    ds_read_b64_tr_b16 v[38:39], v11 offset:1024
    s_add_u32 m0, s74, 0
    s_mov_b32 s96, 384
    buffer_load_dwordx4 v1, s[40:43], s96 offen offset:0 lds
    v_mfma_f32_32x32x16_bf16 v[184:199], v[40:43], a[28:31], v[184:199]
    s_add_u32 m0, s74, 0
    s_mov_b32 s96, 7552
    buffer_load_dwordx4 v2, s[40:43], s96 offen offset:1024 lds
    s_add_u32 m0, s74, 0
    s_mov_b32 s96, 14720
    buffer_load_dwordx4 v1, s[40:43], s96 offen offset:2048 lds
    v_mfma_f32_32x32x16_bf16 v[200:215], v[44:47], a[28:31], v[200:215]
    s_add_u32 m0, s74, 0
    s_mov_b32 s96, 21888
    buffer_load_dwordx4 v2, s[40:43], s96 offen offset:3072 lds
    v_mfma_f32_32x32x16_bf16 v[216:231], v[48:51], a[28:31], v[216:231]
    v_mfma_f32_32x32x16_bf16 v[232:247], v[52:55], a[28:31], v[232:247]
    s_waitcnt lgkmcnt(0)
    v_mfma_f32_32x32x16_bf16 v[120:135], v[24:27], a[32:35], v[120:135]
    ds_read_b128 a[40:43], v5 offset:0
    ds_read_b64_tr_b16 v[40:41], v8 offset:4096
    ds_read_b64_tr_b16 v[42:43], v8 offset:5120
    v_mfma_f32_32x32x16_bf16 v[136:151], v[28:31], a[32:35], v[136:151]
    ds_read_b128 a[44:47], v5 offset:4096
    ds_read_b64_tr_b16 v[44:45], v9 offset:4096
    ds_read_b64_tr_b16 v[46:47], v9 offset:5120
    v_mfma_f32_32x32x16_bf16 v[152:167], v[32:35], a[32:35], v[152:167]
    ds_read_b64_tr_b16 v[48:49], v10 offset:4096
    ds_read_b64_tr_b16 v[50:51], v10 offset:5120
    ds_read_b64_tr_b16 v[52:53], v11 offset:4096
    v_mfma_f32_32x32x16_bf16 v[168:183], v[36:39], a[32:35], v[168:183]
    ds_read_b64_tr_b16 v[54:55], v11 offset:5120
    s_add_u32 m0, s74, 4096
    s_mov_b32 s96, 33152
    buffer_load_dwordx4 v1, s[40:43], s96 offen offset:0 lds
    v_mfma_f32_32x32x16_bf16 v[184:199], v[24:27], a[36:39], v[184:199]
    s_add_u32 m0, s74, 4096
    s_mov_b32 s96, 40320
    buffer_load_dwordx4 v2, s[40:43], s96 offen offset:1024 lds
    s_add_u32 m0, s74, 4096
    s_mov_b32 s96, 47488
    buffer_load_dwordx4 v1, s[40:43], s96 offen offset:2048 lds
    v_mfma_f32_32x32x16_bf16 v[200:215], v[28:31], a[36:39], v[200:215]
    v_mfma_f32_32x32x16_bf16 v[216:231], v[32:35], a[36:39], v[216:231]
    s_add_u32 m0, s74, 4096
    s_mov_b32 s96, 54656
    buffer_load_dwordx4 v2, s[40:43], s96 offen offset:3072 lds
    v_mfma_f32_32x32x16_bf16 v[232:247], v[36:39], a[36:39], v[232:247]
    s_waitcnt lgkmcnt(0)
    v_mfma_f32_32x32x16_bf16 v[120:135], v[40:43], a[40:43], v[120:135]
    ds_read_b128 a[48:51], v6 offset:0
    ds_read_b64_tr_b16 v[24:25], v8 offset:8192
    ds_read_b64_tr_b16 v[26:27], v8 offset:9216
    v_mfma_f32_32x32x16_bf16 v[136:151], v[44:47], a[40:43], v[136:151]
    ds_read_b128 a[52:55], v6 offset:4096
    ds_read_b64_tr_b16 v[28:29], v9 offset:8192
    ds_read_b64_tr_b16 v[30:31], v9 offset:9216
    v_mfma_f32_32x32x16_bf16 v[152:167], v[48:51], a[40:43], v[152:167]
    ds_read_b64_tr_b16 v[32:33], v10 offset:8192
    ds_read_b64_tr_b16 v[34:35], v10 offset:9216
    ds_read_b64_tr_b16 v[36:37], v11 offset:8192
    v_mfma_f32_32x32x16_bf16 v[168:183], v[52:55], a[40:43], v[168:183]
    ds_read_b64_tr_b16 v[38:39], v11 offset:9216
    s_add_u32 m0, s75, 0
    s_mov_b32 s96, 1572864
    buffer_load_dwordx4 v3, s[44:47], s96 offen offset:0 lds
    v_mfma_f32_32x32x16_bf16 v[184:199], v[40:43], a[44:47], v[184:199]
    s_add_u32 m0, s75, 0
    s_mov_b32 s96, 1604608
    buffer_load_dwordx4 v3, s[44:47], s96 offen offset:1024 lds
    v_mfma_f32_32x32x16_bf16 v[200:215], v[44:47], a[44:47], v[200:215]
    s_add_u32 m0, s75, 0
    s_mov_b32 s96, 1636352
    buffer_load_dwordx4 v3, s[44:47], s96 offen offset:2048 lds
    v_mfma_f32_32x32x16_bf16 v[216:231], v[48:51], a[44:47], v[216:231]
    v_mfma_f32_32x32x16_bf16 v[232:247], v[52:55], a[44:47], v[232:247]
    s_add_u32 m0, s75, 0
    s_mov_b32 s96, 1668096
    buffer_load_dwordx4 v3, s[44:47], s96 offen offset:3072 lds
    s_waitcnt lgkmcnt(0)
    v_mfma_f32_32x32x16_bf16 v[120:135], v[24:27], a[48:51], v[120:135]
    ds_read_b128 a[56:59], v7 offset:0
    ds_read_b64_tr_b16 v[40:41], v8 offset:12288
    ds_read_b64_tr_b16 v[42:43], v8 offset:13312
    v_mfma_f32_32x32x16_bf16 v[136:151], v[28:31], a[48:51], v[136:151]
    ds_read_b128 a[60:63], v7 offset:4096
    ds_read_b64_tr_b16 v[44:45], v9 offset:12288
    ds_read_b64_tr_b16 v[46:47], v9 offset:13312
    v_mfma_f32_32x32x16_bf16 v[152:167], v[32:35], a[48:51], v[152:167]
    ds_read_b64_tr_b16 v[48:49], v10 offset:12288
    ds_read_b64_tr_b16 v[50:51], v10 offset:13312
    ds_read_b64_tr_b16 v[52:53], v11 offset:12288
    v_mfma_f32_32x32x16_bf16 v[168:183], v[36:39], a[48:51], v[168:183]
    ds_read_b64_tr_b16 v[54:55], v11 offset:13312
    v_mfma_f32_32x32x16_bf16 v[184:199], v[24:27], a[52:55], v[184:199]
    v_mfma_f32_32x32x16_bf16 v[200:215], v[28:31], a[52:55], v[200:215]
    v_mfma_f32_32x32x16_bf16 v[216:231], v[32:35], a[52:55], v[216:231]
    s_waitcnt lgkmcnt(0)
    s_waitcnt vmcnt(12)
    s_barrier
    v_add_u32 v4, 98304, v14
    v_xor_b32 v5, 32, v4
    v_xor_b32 v6, 64, v4
    v_xor_b32 v7, 96, v4
    v_mfma_f32_32x32x16_bf16 v[232:247], v[36:39], a[52:55], v[232:247]
    v_add_u32 v8, 98304, v16
    v_add_u32 v9, 98304, v17
    v_add_u32 v10, 98304, v18
    v_add_u32 v11, 98304, v19
    v_mfma_f32_32x32x16_bf16 v[120:135], v[40:43], a[56:59], v[120:135]
    ds_read_b128 a[64:67], v4 offset:0
    ds_read_b64_tr_b16 v[24:25], v8 offset:0
    ds_read_b64_tr_b16 v[26:27], v8 offset:1024
    v_mfma_f32_32x32x16_bf16 v[136:151], v[44:47], a[56:59], v[136:151]
    ds_read_b128 a[68:71], v4 offset:4096
    ds_read_b64_tr_b16 v[28:29], v9 offset:0
    ds_read_b64_tr_b16 v[30:31], v9 offset:1024
    v_mfma_f32_32x32x16_bf16 v[152:167], v[48:51], a[56:59], v[152:167]
    ds_read_b64_tr_b16 v[32:33], v10 offset:0
    ds_read_b64_tr_b16 v[34:35], v10 offset:1024
    ds_read_b64_tr_b16 v[36:37], v11 offset:0
    v_mfma_f32_32x32x16_bf16 v[168:183], v[52:55], a[56:59], v[168:183]
    ds_read_b64_tr_b16 v[38:39], v11 offset:1024
    s_add_u32 m0, s74, 49152
    s_mov_b32 s96, 512
    buffer_load_dwordx4 v1, s[40:43], s96 offen offset:0 lds
    v_mfma_f32_32x32x16_bf16 v[184:199], v[40:43], a[60:63], v[184:199]
    s_add_u32 m0, s74, 49152
    s_mov_b32 s96, 7680
    buffer_load_dwordx4 v2, s[40:43], s96 offen offset:1024 lds
    s_add_u32 m0, s74, 49152
    s_mov_b32 s96, 14848
    buffer_load_dwordx4 v1, s[40:43], s96 offen offset:2048 lds
    v_mfma_f32_32x32x16_bf16 v[200:215], v[44:47], a[60:63], v[200:215]
    s_add_u32 m0, s74, 49152
    s_mov_b32 s96, 22016
    buffer_load_dwordx4 v2, s[40:43], s96 offen offset:3072 lds
    v_mfma_f32_32x32x16_bf16 v[216:231], v[48:51], a[60:63], v[216:231]
    v_mfma_f32_32x32x16_bf16 v[232:247], v[52:55], a[60:63], v[232:247]
    s_waitcnt lgkmcnt(0)
    v_mfma_f32_32x32x16_bf16 v[120:135], v[24:27], a[64:67], v[120:135]
    ds_read_b128 a[72:75], v5 offset:0
    ds_read_b64_tr_b16 v[40:41], v8 offset:4096
    ds_read_b64_tr_b16 v[42:43], v8 offset:5120
    v_mfma_f32_32x32x16_bf16 v[136:151], v[28:31], a[64:67], v[136:151]
    ds_read_b128 a[76:79], v5 offset:4096
    ds_read_b64_tr_b16 v[44:45], v9 offset:4096
    ds_read_b64_tr_b16 v[46:47], v9 offset:5120
    v_mfma_f32_32x32x16_bf16 v[152:167], v[32:35], a[64:67], v[152:167]
    ds_read_b64_tr_b16 v[48:49], v10 offset:4096
    ds_read_b64_tr_b16 v[50:51], v10 offset:5120
    ds_read_b64_tr_b16 v[52:53], v11 offset:4096
    v_mfma_f32_32x32x16_bf16 v[168:183], v[36:39], a[64:67], v[168:183]
    ds_read_b64_tr_b16 v[54:55], v11 offset:5120
    s_add_u32 m0, s74, 53248
    s_mov_b32 s96, 33280
    buffer_load_dwordx4 v1, s[40:43], s96 offen offset:0 lds
    v_mfma_f32_32x32x16_bf16 v[184:199], v[24:27], a[68:71], v[184:199]
    s_add_u32 m0, s74, 53248
    s_mov_b32 s96, 40448
    buffer_load_dwordx4 v2, s[40:43], s96 offen offset:1024 lds
    s_add_u32 m0, s74, 53248
    s_mov_b32 s96, 47616
    buffer_load_dwordx4 v1, s[40:43], s96 offen offset:2048 lds
    v_mfma_f32_32x32x16_bf16 v[200:215], v[28:31], a[68:71], v[200:215]
    v_mfma_f32_32x32x16_bf16 v[216:231], v[32:35], a[68:71], v[216:231]
    s_add_u32 m0, s74, 53248
    s_mov_b32 s96, 54784
    buffer_load_dwordx4 v2, s[40:43], s96 offen offset:3072 lds
    v_mfma_f32_32x32x16_bf16 v[232:247], v[36:39], a[68:71], v[232:247]
    s_waitcnt lgkmcnt(0)
    v_mfma_f32_32x32x16_bf16 v[120:135], v[40:43], a[72:75], v[120:135]
    ds_read_b128 a[80:83], v6 offset:0
    ds_read_b64_tr_b16 v[24:25], v8 offset:8192
    ds_read_b64_tr_b16 v[26:27], v8 offset:9216
    v_mfma_f32_32x32x16_bf16 v[136:151], v[44:47], a[72:75], v[136:151]
    ds_read_b128 a[84:87], v6 offset:4096
    ds_read_b64_tr_b16 v[28:29], v9 offset:8192
    ds_read_b64_tr_b16 v[30:31], v9 offset:9216
    v_mfma_f32_32x32x16_bf16 v[152:167], v[48:51], a[72:75], v[152:167]
    ds_read_b64_tr_b16 v[32:33], v10 offset:8192
    ds_read_b64_tr_b16 v[34:35], v10 offset:9216
    ds_read_b64_tr_b16 v[36:37], v11 offset:8192
    v_mfma_f32_32x32x16_bf16 v[168:183], v[52:55], a[72:75], v[168:183]
    ds_read_b64_tr_b16 v[38:39], v11 offset:9216
    s_add_u32 m0, s75, 49152
    s_mov_b32 s96, 2097152
    buffer_load_dwordx4 v3, s[44:47], s96 offen offset:0 lds
    v_mfma_f32_32x32x16_bf16 v[184:199], v[40:43], a[76:79], v[184:199]
    s_add_u32 m0, s75, 49152
    s_mov_b32 s96, 2128896
    buffer_load_dwordx4 v3, s[44:47], s96 offen offset:1024 lds
    v_mfma_f32_32x32x16_bf16 v[200:215], v[44:47], a[76:79], v[200:215]
    s_add_u32 m0, s75, 49152
    s_mov_b32 s96, 2160640
    buffer_load_dwordx4 v3, s[44:47], s96 offen offset:2048 lds
    v_mfma_f32_32x32x16_bf16 v[216:231], v[48:51], a[76:79], v[216:231]
    v_mfma_f32_32x32x16_bf16 v[232:247], v[52:55], a[76:79], v[232:247]
    s_add_u32 m0, s75, 49152
    s_mov_b32 s96, 2192384
    buffer_load_dwordx4 v3, s[44:47], s96 offen offset:3072 lds
    s_waitcnt lgkmcnt(0)
    v_mfma_f32_32x32x16_bf16 v[120:135], v[24:27], a[80:83], v[120:135]
    ds_read_b128 a[88:91], v7 offset:0
    ds_read_b64_tr_b16 v[40:41], v8 offset:12288
    ds_read_b64_tr_b16 v[42:43], v8 offset:13312
    v_mfma_f32_32x32x16_bf16 v[136:151], v[28:31], a[80:83], v[136:151]
    ds_read_b128 a[92:95], v7 offset:4096
    ds_read_b64_tr_b16 v[44:45], v9 offset:12288
    ds_read_b64_tr_b16 v[46:47], v9 offset:13312
    v_mfma_f32_32x32x16_bf16 v[152:167], v[32:35], a[80:83], v[152:167]
    ds_read_b64_tr_b16 v[48:49], v10 offset:12288
    ds_read_b64_tr_b16 v[50:51], v10 offset:13312
    ds_read_b64_tr_b16 v[52:53], v11 offset:12288
    v_mfma_f32_32x32x16_bf16 v[168:183], v[36:39], a[80:83], v[168:183]
    ds_read_b64_tr_b16 v[54:55], v11 offset:13312
    v_mfma_f32_32x32x16_bf16 v[184:199], v[24:27], a[84:87], v[184:199]
    v_mfma_f32_32x32x16_bf16 v[200:215], v[28:31], a[84:87], v[200:215]
    v_mfma_f32_32x32x16_bf16 v[216:231], v[32:35], a[84:87], v[216:231]
    s_waitcnt lgkmcnt(0)
    s_waitcnt vmcnt(12)
    s_barrier
    v_add_u32 v4, 0, v14
    v_xor_b32 v5, 32, v4
    v_xor_b32 v6, 64, v4
    v_xor_b32 v7, 96, v4
    v_mfma_f32_32x32x16_bf16 v[232:247], v[36:39], a[84:87], v[232:247]
    v_add_u32 v8, 0, v16
    v_add_u32 v9, 0, v17
    v_add_u32 v10, 0, v18
    v_add_u32 v11, 0, v19
    v_mfma_f32_32x32x16_bf16 v[120:135], v[40:43], a[88:91], v[120:135]
    ds_read_b128 a[96:99], v4 offset:0
    ds_read_b64_tr_b16 v[24:25], v8 offset:0
    ds_read_b64_tr_b16 v[26:27], v8 offset:1024
    v_mfma_f32_32x32x16_bf16 v[136:151], v[44:47], a[88:91], v[136:151]
    ds_read_b128 a[100:103], v4 offset:4096
    ds_read_b64_tr_b16 v[28:29], v9 offset:0
    ds_read_b64_tr_b16 v[30:31], v9 offset:1024
    v_mfma_f32_32x32x16_bf16 v[152:167], v[48:51], a[88:91], v[152:167]
    ds_read_b64_tr_b16 v[32:33], v10 offset:0
    ds_read_b64_tr_b16 v[34:35], v10 offset:1024
    ds_read_b64_tr_b16 v[36:37], v11 offset:0
    v_mfma_f32_32x32x16_bf16 v[168:183], v[52:55], a[88:91], v[168:183]
    ds_read_b64_tr_b16 v[38:39], v11 offset:1024
    s_add_u32 m0, s74, 98304
    s_mov_b32 s96, 640
    buffer_load_dwordx4 v1, s[40:43], s96 offen offset:0 lds
    v_mfma_f32_32x32x16_bf16 v[184:199], v[40:43], a[92:95], v[184:199]
    s_add_u32 m0, s74, 98304
    s_mov_b32 s96, 7808
    buffer_load_dwordx4 v2, s[40:43], s96 offen offset:1024 lds
    s_add_u32 m0, s74, 98304
    s_mov_b32 s96, 14976
    buffer_load_dwordx4 v1, s[40:43], s96 offen offset:2048 lds
    v_mfma_f32_32x32x16_bf16 v[200:215], v[44:47], a[92:95], v[200:215]
    s_add_u32 m0, s74, 98304
    s_mov_b32 s96, 22144
    buffer_load_dwordx4 v2, s[40:43], s96 offen offset:3072 lds
    v_mfma_f32_32x32x16_bf16 v[216:231], v[48:51], a[92:95], v[216:231]
    v_mfma_f32_32x32x16_bf16 v[232:247], v[52:55], a[92:95], v[232:247]
    s_waitcnt lgkmcnt(0)
    v_mfma_f32_32x32x16_bf16 v[120:135], v[24:27], a[96:99], v[120:135]
    ds_read_b128 a[104:107], v5 offset:0
    ds_read_b64_tr_b16 v[40:41], v8 offset:4096
    ds_read_b64_tr_b16 v[42:43], v8 offset:5120
    v_mfma_f32_32x32x16_bf16 v[136:151], v[28:31], a[96:99], v[136:151]
    ds_read_b128 a[108:111], v5 offset:4096
    ds_read_b64_tr_b16 v[44:45], v9 offset:4096
    ds_read_b64_tr_b16 v[46:47], v9 offset:5120
    v_mfma_f32_32x32x16_bf16 v[152:167], v[32:35], a[96:99], v[152:167]
    ds_read_b64_tr_b16 v[48:49], v10 offset:4096
    ds_read_b64_tr_b16 v[50:51], v10 offset:5120
    ds_read_b64_tr_b16 v[52:53], v11 offset:4096
    v_mfma_f32_32x32x16_bf16 v[168:183], v[36:39], a[96:99], v[168:183]
    ds_read_b64_tr_b16 v[54:55], v11 offset:5120
    s_add_u32 m0, s74, 102400
    s_mov_b32 s96, 33408
    buffer_load_dwordx4 v1, s[40:43], s96 offen offset:0 lds
    v_mfma_f32_32x32x16_bf16 v[184:199], v[24:27], a[100:103], v[184:199]
    s_add_u32 m0, s74, 102400
    s_mov_b32 s96, 40576
    buffer_load_dwordx4 v2, s[40:43], s96 offen offset:1024 lds
    s_add_u32 m0, s74, 102400
    s_mov_b32 s96, 47744
    buffer_load_dwordx4 v1, s[40:43], s96 offen offset:2048 lds
    v_mfma_f32_32x32x16_bf16 v[200:215], v[28:31], a[100:103], v[200:215]
    v_mfma_f32_32x32x16_bf16 v[216:231], v[32:35], a[100:103], v[216:231]
    s_add_u32 m0, s74, 102400
    s_mov_b32 s96, 54912
    buffer_load_dwordx4 v2, s[40:43], s96 offen offset:3072 lds
    v_mfma_f32_32x32x16_bf16 v[232:247], v[36:39], a[100:103], v[232:247]
    s_waitcnt lgkmcnt(0)
    v_mfma_f32_32x32x16_bf16 v[120:135], v[40:43], a[104:107], v[120:135]
    ds_read_b128 a[112:115], v6 offset:0
    ds_read_b64_tr_b16 v[24:25], v8 offset:8192
    ds_read_b64_tr_b16 v[26:27], v8 offset:9216
    v_mfma_f32_32x32x16_bf16 v[136:151], v[44:47], a[104:107], v[136:151]
    ds_read_b128 a[116:119], v6 offset:4096
    ds_read_b64_tr_b16 v[28:29], v9 offset:8192
    ds_read_b64_tr_b16 v[30:31], v9 offset:9216
    v_mfma_f32_32x32x16_bf16 v[152:167], v[48:51], a[104:107], v[152:167]
    ds_read_b64_tr_b16 v[32:33], v10 offset:8192
    ds_read_b64_tr_b16 v[34:35], v10 offset:9216
    ds_read_b64_tr_b16 v[36:37], v11 offset:8192
    v_mfma_f32_32x32x16_bf16 v[168:183], v[52:55], a[104:107], v[168:183]
    ds_read_b64_tr_b16 v[38:39], v11 offset:9216
    s_add_u32 m0, s75, 98304
    s_mov_b32 s96, 2621440
    buffer_load_dwordx4 v3, s[44:47], s96 offen offset:0 lds
    v_mfma_f32_32x32x16_bf16 v[184:199], v[40:43], a[108:111], v[184:199]
    s_add_u32 m0, s75, 98304
    s_mov_b32 s96, 2653184
    buffer_load_dwordx4 v3, s[44:47], s96 offen offset:1024 lds
    v_mfma_f32_32x32x16_bf16 v[200:215], v[44:47], a[108:111], v[200:215]
    s_add_u32 m0, s75, 98304
    s_mov_b32 s96, 2684928
    buffer_load_dwordx4 v3, s[44:47], s96 offen offset:2048 lds
    v_mfma_f32_32x32x16_bf16 v[216:231], v[48:51], a[108:111], v[216:231]
    v_mfma_f32_32x32x16_bf16 v[232:247], v[52:55], a[108:111], v[232:247]
    s_add_u32 m0, s75, 98304
    s_mov_b32 s96, 2716672
    buffer_load_dwordx4 v3, s[44:47], s96 offen offset:3072 lds
    s_waitcnt lgkmcnt(0)
    v_mfma_f32_32x32x16_bf16 v[120:135], v[24:27], a[112:115], v[120:135]
    ds_read_b128 a[120:123], v7 offset:0
    ds_read_b64_tr_b16 v[40:41], v8 offset:12288
    ds_read_b64_tr_b16 v[42:43], v8 offset:13312
    v_mfma_f32_32x32x16_bf16 v[136:151], v[28:31], a[112:115], v[136:151]
    ds_read_b128 a[124:127], v7 offset:4096
    ds_read_b64_tr_b16 v[44:45], v9 offset:12288
    ds_read_b64_tr_b16 v[46:47], v9 offset:13312
    v_mfma_f32_32x32x16_bf16 v[152:167], v[32:35], a[112:115], v[152:167]
    ds_read_b64_tr_b16 v[48:49], v10 offset:12288
    ds_read_b64_tr_b16 v[50:51], v10 offset:13312
    ds_read_b64_tr_b16 v[52:53], v11 offset:12288
    v_mfma_f32_32x32x16_bf16 v[168:183], v[36:39], a[112:115], v[168:183]
    ds_read_b64_tr_b16 v[54:55], v11 offset:13312
    v_mfma_f32_32x32x16_bf16 v[184:199], v[24:27], a[116:119], v[184:199]
    v_mfma_f32_32x32x16_bf16 v[200:215], v[28:31], a[116:119], v[200:215]
    v_mfma_f32_32x32x16_bf16 v[216:231], v[32:35], a[116:119], v[216:231]
    s_waitcnt lgkmcnt(0)
    s_waitcnt vmcnt(12)
    s_barrier
    v_add_u32 v4, 49152, v14
    v_xor_b32 v5, 32, v4
    v_xor_b32 v6, 64, v4
    v_xor_b32 v7, 96, v4
    v_mfma_f32_32x32x16_bf16 v[232:247], v[36:39], a[116:119], v[232:247]
    v_add_u32 v8, 49152, v16
    v_add_u32 v9, 49152, v17
    v_add_u32 v10, 49152, v18
    v_add_u32 v11, 49152, v19
    v_mfma_f32_32x32x16_bf16 v[120:135], v[40:43], a[120:123], v[120:135]
    ds_read_b128 a[128:131], v4 offset:0
    ds_read_b64_tr_b16 v[24:25], v8 offset:0
    ds_read_b64_tr_b16 v[26:27], v8 offset:1024
    v_mfma_f32_32x32x16_bf16 v[136:151], v[44:47], a[120:123], v[136:151]
    ds_read_b128 a[132:135], v4 offset:4096
    ds_read_b64_tr_b16 v[28:29], v9 offset:0
    ds_read_b64_tr_b16 v[30:31], v9 offset:1024
    v_mfma_f32_32x32x16_bf16 v[152:167], v[48:51], a[120:123], v[152:167]
    ds_read_b64_tr_b16 v[32:33], v10 offset:0
    ds_read_b64_tr_b16 v[34:35], v10 offset:1024
    ds_read_b64_tr_b16 v[36:37], v11 offset:0
    v_mfma_f32_32x32x16_bf16 v[168:183], v[52:55], a[120:123], v[168:183]
    ds_read_b64_tr_b16 v[38:39], v11 offset:1024
    s_add_u32 m0, s74, 0
    s_mov_b32 s96, 768
    buffer_load_dwordx4 v1, s[40:43], s96 offen offset:0 lds
    v_mfma_f32_32x32x16_bf16 v[184:199], v[40:43], a[124:127], v[184:199]
    s_add_u32 m0, s74, 0
    s_mov_b32 s96, 7936
    buffer_load_dwordx4 v2, s[40:43], s96 offen offset:1024 lds
    s_add_u32 m0, s74, 0
    s_mov_b32 s96, 15104
    buffer_load_dwordx4 v1, s[40:43], s96 offen offset:2048 lds
    v_mfma_f32_32x32x16_bf16 v[200:215], v[44:47], a[124:127], v[200:215]
    s_add_u32 m0, s74, 0
    s_mov_b32 s96, 22272
    buffer_load_dwordx4 v2, s[40:43], s96 offen offset:3072 lds
    v_mfma_f32_32x32x16_bf16 v[216:231], v[48:51], a[124:127], v[216:231]
    v_mfma_f32_32x32x16_bf16 v[232:247], v[52:55], a[124:127], v[232:247]
    s_waitcnt lgkmcnt(0)
    v_mfma_f32_32x32x16_bf16 v[120:135], v[24:27], a[128:131], v[120:135]
    ds_read_b128 a[136:139], v5 offset:0
    ds_read_b64_tr_b16 v[40:41], v8 offset:4096
    ds_read_b64_tr_b16 v[42:43], v8 offset:5120
    v_mfma_f32_32x32x16_bf16 v[136:151], v[28:31], a[128:131], v[136:151]
    ds_read_b128 a[140:143], v5 offset:4096
    ds_read_b64_tr_b16 v[44:45], v9 offset:4096
    ds_read_b64_tr_b16 v[46:47], v9 offset:5120
    v_mfma_f32_32x32x16_bf16 v[152:167], v[32:35], a[128:131], v[152:167]
    ds_read_b64_tr_b16 v[48:49], v10 offset:4096
    ds_read_b64_tr_b16 v[50:51], v10 offset:5120
    ds_read_b64_tr_b16 v[52:53], v11 offset:4096
    v_mfma_f32_32x32x16_bf16 v[168:183], v[36:39], a[128:131], v[168:183]
    ds_read_b64_tr_b16 v[54:55], v11 offset:5120
    s_add_u32 m0, s74, 4096
    s_mov_b32 s96, 33536
    buffer_load_dwordx4 v1, s[40:43], s96 offen offset:0 lds
    v_mfma_f32_32x32x16_bf16 v[184:199], v[24:27], a[132:135], v[184:199]
    s_add_u32 m0, s74, 4096
    s_mov_b32 s96, 40704
    buffer_load_dwordx4 v2, s[40:43], s96 offen offset:1024 lds
    s_add_u32 m0, s74, 4096
    s_mov_b32 s96, 47872
    buffer_load_dwordx4 v1, s[40:43], s96 offen offset:2048 lds
    v_mfma_f32_32x32x16_bf16 v[200:215], v[28:31], a[132:135], v[200:215]
    v_mfma_f32_32x32x16_bf16 v[216:231], v[32:35], a[132:135], v[216:231]
    s_add_u32 m0, s74, 4096
    s_mov_b32 s96, 55040
    buffer_load_dwordx4 v2, s[40:43], s96 offen offset:3072 lds
    v_mfma_f32_32x32x16_bf16 v[232:247], v[36:39], a[132:135], v[232:247]
    s_waitcnt lgkmcnt(0)
    v_mfma_f32_32x32x16_bf16 v[120:135], v[40:43], a[136:139], v[120:135]
    ds_read_b128 a[144:147], v6 offset:0
    ds_read_b64_tr_b16 v[24:25], v8 offset:8192
    ds_read_b64_tr_b16 v[26:27], v8 offset:9216
    v_mfma_f32_32x32x16_bf16 v[136:151], v[44:47], a[136:139], v[136:151]
    ds_read_b128 a[148:151], v6 offset:4096
    ds_read_b64_tr_b16 v[28:29], v9 offset:8192
    ds_read_b64_tr_b16 v[30:31], v9 offset:9216
    v_mfma_f32_32x32x16_bf16 v[152:167], v[48:51], a[136:139], v[152:167]
    ds_read_b64_tr_b16 v[32:33], v10 offset:8192
    ds_read_b64_tr_b16 v[34:35], v10 offset:9216
    ds_read_b64_tr_b16 v[36:37], v11 offset:8192
    v_mfma_f32_32x32x16_bf16 v[168:183], v[52:55], a[136:139], v[168:183]
    ds_read_b64_tr_b16 v[38:39], v11 offset:9216
    s_add_u32 m0, s75, 0
    s_mov_b32 s96, 3145728
    buffer_load_dwordx4 v3, s[44:47], s96 offen offset:0 lds
    v_mfma_f32_32x32x16_bf16 v[184:199], v[40:43], a[140:143], v[184:199]
    s_add_u32 m0, s75, 0
    s_mov_b32 s96, 3177472
    buffer_load_dwordx4 v3, s[44:47], s96 offen offset:1024 lds
    v_mfma_f32_32x32x16_bf16 v[200:215], v[44:47], a[140:143], v[200:215]
    s_add_u32 m0, s75, 0
    s_mov_b32 s96, 3209216
    buffer_load_dwordx4 v3, s[44:47], s96 offen offset:2048 lds
    v_mfma_f32_32x32x16_bf16 v[216:231], v[48:51], a[140:143], v[216:231]
    v_mfma_f32_32x32x16_bf16 v[232:247], v[52:55], a[140:143], v[232:247]
    s_add_u32 m0, s75, 0
    s_mov_b32 s96, 3240960
    buffer_load_dwordx4 v3, s[44:47], s96 offen offset:3072 lds
    s_waitcnt lgkmcnt(0)
    v_mfma_f32_32x32x16_bf16 v[120:135], v[24:27], a[144:147], v[120:135]
    ds_read_b128 a[152:155], v7 offset:0
    ds_read_b64_tr_b16 v[40:41], v8 offset:12288
    ds_read_b64_tr_b16 v[42:43], v8 offset:13312
    v_mfma_f32_32x32x16_bf16 v[136:151], v[28:31], a[144:147], v[136:151]
    ds_read_b128 a[156:159], v7 offset:4096
    ds_read_b64_tr_b16 v[44:45], v9 offset:12288
    ds_read_b64_tr_b16 v[46:47], v9 offset:13312
    v_mfma_f32_32x32x16_bf16 v[152:167], v[32:35], a[144:147], v[152:167]
    ds_read_b64_tr_b16 v[48:49], v10 offset:12288
    ds_read_b64_tr_b16 v[50:51], v10 offset:13312
    ds_read_b64_tr_b16 v[52:53], v11 offset:12288
    v_mfma_f32_32x32x16_bf16 v[168:183], v[36:39], a[144:147], v[168:183]
    ds_read_b64_tr_b16 v[54:55], v11 offset:13312
    v_mfma_f32_32x32x16_bf16 v[184:199], v[24:27], a[148:151], v[184:199]
    v_mfma_f32_32x32x16_bf16 v[200:215], v[28:31], a[148:151], v[200:215]
    v_mfma_f32_32x32x16_bf16 v[216:231], v[32:35], a[148:151], v[216:231]
    s_waitcnt lgkmcnt(0)
    s_waitcnt vmcnt(12)
    s_barrier
    v_add_u32 v4, 98304, v14
    v_xor_b32 v5, 32, v4
    v_xor_b32 v6, 64, v4
    v_xor_b32 v7, 96, v4
    v_mfma_f32_32x32x16_bf16 v[232:247], v[36:39], a[148:151], v[232:247]
    v_add_u32 v8, 98304, v16
    v_add_u32 v9, 98304, v17
    v_add_u32 v10, 98304, v18
    v_add_u32 v11, 98304, v19
    v_mfma_f32_32x32x16_bf16 v[120:135], v[40:43], a[152:155], v[120:135]
    ds_read_b128 a[160:163], v4 offset:0
    ds_read_b64_tr_b16 v[24:25], v8 offset:0
    ds_read_b64_tr_b16 v[26:27], v8 offset:1024
    v_mfma_f32_32x32x16_bf16 v[136:151], v[44:47], a[152:155], v[136:151]
    ds_read_b128 a[164:167], v4 offset:4096
    ds_read_b64_tr_b16 v[28:29], v9 offset:0
    ds_read_b64_tr_b16 v[30:31], v9 offset:1024
    v_mfma_f32_32x32x16_bf16 v[152:167], v[48:51], a[152:155], v[152:167]
    ds_read_b64_tr_b16 v[32:33], v10 offset:0
    ds_read_b64_tr_b16 v[34:35], v10 offset:1024
    ds_read_b64_tr_b16 v[36:37], v11 offset:0
    v_mfma_f32_32x32x16_bf16 v[168:183], v[52:55], a[152:155], v[168:183]
    ds_read_b64_tr_b16 v[38:39], v11 offset:1024
    s_add_u32 m0, s74, 49152
    s_mov_b32 s96, 896
    buffer_load_dwordx4 v1, s[40:43], s96 offen offset:0 lds
    v_mfma_f32_32x32x16_bf16 v[184:199], v[40:43], a[156:159], v[184:199]
    s_add_u32 m0, s74, 49152
    s_mov_b32 s96, 8064
    buffer_load_dwordx4 v2, s[40:43], s96 offen offset:1024 lds
    s_add_u32 m0, s74, 49152
    s_mov_b32 s96, 15232
    buffer_load_dwordx4 v1, s[40:43], s96 offen offset:2048 lds
    v_mfma_f32_32x32x16_bf16 v[200:215], v[44:47], a[156:159], v[200:215]
    s_add_u32 m0, s74, 49152
    s_mov_b32 s96, 22400
    buffer_load_dwordx4 v2, s[40:43], s96 offen offset:3072 lds
    v_mfma_f32_32x32x16_bf16 v[216:231], v[48:51], a[156:159], v[216:231]
    v_mfma_f32_32x32x16_bf16 v[232:247], v[52:55], a[156:159], v[232:247]
    s_waitcnt lgkmcnt(0)
    v_mfma_f32_32x32x16_bf16 v[120:135], v[24:27], a[160:163], v[120:135]
    ds_read_b128 a[168:171], v5 offset:0
    ds_read_b64_tr_b16 v[40:41], v8 offset:4096
    ds_read_b64_tr_b16 v[42:43], v8 offset:5120
    v_mfma_f32_32x32x16_bf16 v[136:151], v[28:31], a[160:163], v[136:151]
    ds_read_b128 a[172:175], v5 offset:4096
    ds_read_b64_tr_b16 v[44:45], v9 offset:4096
    ds_read_b64_tr_b16 v[46:47], v9 offset:5120
    v_mfma_f32_32x32x16_bf16 v[152:167], v[32:35], a[160:163], v[152:167]
    ds_read_b64_tr_b16 v[48:49], v10 offset:4096
    ds_read_b64_tr_b16 v[50:51], v10 offset:5120
    ds_read_b64_tr_b16 v[52:53], v11 offset:4096
    v_mfma_f32_32x32x16_bf16 v[168:183], v[36:39], a[160:163], v[168:183]
    ds_read_b64_tr_b16 v[54:55], v11 offset:5120
    s_add_u32 m0, s74, 53248
    s_mov_b32 s96, 33664
    buffer_load_dwordx4 v1, s[40:43], s96 offen offset:0 lds
    v_mfma_f32_32x32x16_bf16 v[184:199], v[24:27], a[164:167], v[184:199]
    s_add_u32 m0, s74, 53248
    s_mov_b32 s96, 40832
    buffer_load_dwordx4 v2, s[40:43], s96 offen offset:1024 lds
    s_add_u32 m0, s74, 53248
    s_mov_b32 s96, 48000
    buffer_load_dwordx4 v1, s[40:43], s96 offen offset:2048 lds
    v_mfma_f32_32x32x16_bf16 v[200:215], v[28:31], a[164:167], v[200:215]
    v_mfma_f32_32x32x16_bf16 v[216:231], v[32:35], a[164:167], v[216:231]
    s_add_u32 m0, s74, 53248
    s_mov_b32 s96, 55168
    buffer_load_dwordx4 v2, s[40:43], s96 offen offset:3072 lds
    v_mfma_f32_32x32x16_bf16 v[232:247], v[36:39], a[164:167], v[232:247]
    s_waitcnt lgkmcnt(0)
    v_mfma_f32_32x32x16_bf16 v[120:135], v[40:43], a[168:171], v[120:135]
    ds_read_b128 a[176:179], v6 offset:0
    ds_read_b64_tr_b16 v[24:25], v8 offset:8192
    ds_read_b64_tr_b16 v[26:27], v8 offset:9216
    v_mfma_f32_32x32x16_bf16 v[136:151], v[44:47], a[168:171], v[136:151]
    ds_read_b128 a[180:183], v6 offset:4096
    ds_read_b64_tr_b16 v[28:29], v9 offset:8192
    ds_read_b64_tr_b16 v[30:31], v9 offset:9216
    v_mfma_f32_32x32x16_bf16 v[152:167], v[48:51], a[168:171], v[152:167]
    ds_read_b64_tr_b16 v[32:33], v10 offset:8192
    ds_read_b64_tr_b16 v[34:35], v10 offset:9216
    ds_read_b64_tr_b16 v[36:37], v11 offset:8192
    v_mfma_f32_32x32x16_bf16 v[168:183], v[52:55], a[168:171], v[168:183]
    ds_read_b64_tr_b16 v[38:39], v11 offset:9216
    s_add_u32 m0, s75, 49152
    s_mov_b32 s96, 3670016
    buffer_load_dwordx4 v3, s[44:47], s96 offen offset:0 lds
    v_mfma_f32_32x32x16_bf16 v[184:199], v[40:43], a[172:175], v[184:199]
    s_add_u32 m0, s75, 49152
    s_mov_b32 s96, 3701760
    buffer_load_dwordx4 v3, s[44:47], s96 offen offset:1024 lds
    v_mfma_f32_32x32x16_bf16 v[200:215], v[44:47], a[172:175], v[200:215]
    s_add_u32 m0, s75, 49152
    s_mov_b32 s96, 3733504
    buffer_load_dwordx4 v3, s[44:47], s96 offen offset:2048 lds
    v_mfma_f32_32x32x16_bf16 v[216:231], v[48:51], a[172:175], v[216:231]
    v_mfma_f32_32x32x16_bf16 v[232:247], v[52:55], a[172:175], v[232:247]
    s_add_u32 m0, s75, 49152
    s_mov_b32 s96, 3765248
    buffer_load_dwordx4 v3, s[44:47], s96 offen offset:3072 lds
    s_waitcnt lgkmcnt(0)
    v_mfma_f32_32x32x16_bf16 v[120:135], v[24:27], a[176:179], v[120:135]
    ds_read_b128 a[184:187], v7 offset:0
    ds_read_b64_tr_b16 v[40:41], v8 offset:12288
    ds_read_b64_tr_b16 v[42:43], v8 offset:13312
    v_mfma_f32_32x32x16_bf16 v[136:151], v[28:31], a[176:179], v[136:151]
    ds_read_b128 a[188:191], v7 offset:4096
    ds_read_b64_tr_b16 v[44:45], v9 offset:12288
    ds_read_b64_tr_b16 v[46:47], v9 offset:13312
    v_mfma_f32_32x32x16_bf16 v[152:167], v[32:35], a[176:179], v[152:167]
    ds_read_b64_tr_b16 v[48:49], v10 offset:12288
    ds_read_b64_tr_b16 v[50:51], v10 offset:13312
    ds_read_b64_tr_b16 v[52:53], v11 offset:12288
    v_mfma_f32_32x32x16_bf16 v[168:183], v[36:39], a[176:179], v[168:183]
    ds_read_b64_tr_b16 v[54:55], v11 offset:13312
    v_mfma_f32_32x32x16_bf16 v[184:199], v[24:27], a[180:183], v[184:199]
    v_mfma_f32_32x32x16_bf16 v[200:215], v[28:31], a[180:183], v[200:215]
    v_mfma_f32_32x32x16_bf16 v[216:231], v[32:35], a[180:183], v[216:231]
    s_waitcnt lgkmcnt(0)
    s_waitcnt vmcnt(12)
    s_barrier
    v_add_u32 v4, 0, v14
    v_xor_b32 v5, 32, v4
    v_xor_b32 v6, 64, v4
    v_xor_b32 v7, 96, v4
    v_mfma_f32_32x32x16_bf16 v[232:247], v[36:39], a[180:183], v[232:247]
    v_add_u32 v8, 0, v16
    v_add_u32 v9, 0, v17
    v_add_u32 v10, 0, v18
    v_add_u32 v11, 0, v19
    v_mfma_f32_32x32x16_bf16 v[120:135], v[40:43], a[184:187], v[120:135]
    ds_read_b128 a[192:195], v4 offset:0
    ds_read_b64_tr_b16 v[24:25], v8 offset:0
    ds_read_b64_tr_b16 v[26:27], v8 offset:1024
    v_mfma_f32_32x32x16_bf16 v[136:151], v[44:47], a[184:187], v[136:151]
    ds_read_b128 a[196:199], v4 offset:4096
    ds_read_b64_tr_b16 v[28:29], v9 offset:0
    ds_read_b64_tr_b16 v[30:31], v9 offset:1024
    v_mfma_f32_32x32x16_bf16 v[152:167], v[48:51], a[184:187], v[152:167]
    ds_read_b64_tr_b16 v[32:33], v10 offset:0
    ds_read_b64_tr_b16 v[34:35], v10 offset:1024
    ds_read_b64_tr_b16 v[36:37], v11 offset:0
    v_mfma_f32_32x32x16_bf16 v[168:183], v[52:55], a[184:187], v[168:183]
    ds_read_b64_tr_b16 v[38:39], v11 offset:1024
    s_add_u32 m0, s75, 65536
    s_mov_b32 s96, 0
    buffer_load_dwordx4 v3, s[48:51], s96 offen offset:0 lds
    v_mfma_f32_32x32x16_bf16 v[184:199], v[40:43], a[188:191], v[184:199]
    s_add_u32 m0, s75, 65536
    s_mov_b32 s96, 31744
    buffer_load_dwordx4 v3, s[48:51], s96 offen offset:1024 lds
    s_add_u32 m0, s75, 65536
    s_mov_b32 s96, 63488
    buffer_load_dwordx4 v3, s[48:51], s96 offen offset:2048 lds
    v_mfma_f32_32x32x16_bf16 v[200:215], v[44:47], a[188:191], v[200:215]
    s_add_u32 m0, s75, 65536
    s_mov_b32 s96, 95232
    buffer_load_dwordx4 v3, s[48:51], s96 offen offset:3072 lds
    v_mfma_f32_32x32x16_bf16 v[216:231], v[48:51], a[188:191], v[216:231]
    v_mfma_f32_32x32x16_bf16 v[232:247], v[52:55], a[188:191], v[232:247]
    s_waitcnt lgkmcnt(0)
    v_mfma_f32_32x32x16_bf16 v[120:135], v[24:27], a[192:195], v[120:135]
    ds_read_b128 a[200:203], v5 offset:0
    ds_read_b64_tr_b16 v[40:41], v8 offset:4096
    ds_read_b64_tr_b16 v[42:43], v8 offset:5120
    v_mfma_f32_32x32x16_bf16 v[136:151], v[28:31], a[192:195], v[136:151]
    ds_read_b128 a[204:207], v5 offset:4096
    ds_read_b64_tr_b16 v[44:45], v9 offset:4096
    ds_read_b64_tr_b16 v[46:47], v9 offset:5120
    v_mfma_f32_32x32x16_bf16 v[152:167], v[32:35], a[192:195], v[152:167]
    ds_read_b64_tr_b16 v[48:49], v10 offset:4096
    ds_read_b64_tr_b16 v[50:51], v10 offset:5120
    ds_read_b64_tr_b16 v[52:53], v11 offset:4096
    v_mfma_f32_32x32x16_bf16 v[168:183], v[36:39], a[192:195], v[168:183]
    ds_read_b64_tr_b16 v[54:55], v11 offset:5120
    s_add_u32 m0, s75, 81920
    s_mov_b32 s96, 524288
    buffer_load_dwordx4 v3, s[48:51], s96 offen offset:0 lds
    v_mfma_f32_32x32x16_bf16 v[184:199], v[24:27], a[196:199], v[184:199]
    s_add_u32 m0, s75, 81920
    s_mov_b32 s96, 556032
    buffer_load_dwordx4 v3, s[48:51], s96 offen offset:1024 lds
    s_add_u32 m0, s75, 81920
    s_mov_b32 s96, 587776
    buffer_load_dwordx4 v3, s[48:51], s96 offen offset:2048 lds
    v_mfma_f32_32x32x16_bf16 v[200:215], v[28:31], a[196:199], v[200:215]
    v_mfma_f32_32x32x16_bf16 v[216:231], v[32:35], a[196:199], v[216:231]
    s_add_u32 m0, s75, 81920
    s_mov_b32 s96, 619520
    buffer_load_dwordx4 v3, s[48:51], s96 offen offset:3072 lds
    v_mfma_f32_32x32x16_bf16 v[232:247], v[36:39], a[196:199], v[232:247]
    s_waitcnt lgkmcnt(0)
    v_mfma_f32_32x32x16_bf16 v[120:135], v[40:43], a[200:203], v[120:135]
    ds_read_b128 a[208:211], v6 offset:0
    ds_read_b64_tr_b16 v[24:25], v8 offset:8192
    ds_read_b64_tr_b16 v[26:27], v8 offset:9216
    v_mfma_f32_32x32x16_bf16 v[136:151], v[44:47], a[200:203], v[136:151]
    ds_read_b128 a[212:215], v6 offset:4096
    ds_read_b64_tr_b16 v[28:29], v9 offset:8192
    ds_read_b64_tr_b16 v[30:31], v9 offset:9216
    v_mfma_f32_32x32x16_bf16 v[152:167], v[48:51], a[200:203], v[152:167]
    ds_read_b64_tr_b16 v[32:33], v10 offset:8192
    ds_read_b64_tr_b16 v[34:35], v10 offset:9216
    ds_read_b64_tr_b16 v[36:37], v11 offset:8192
    v_mfma_f32_32x32x16_bf16 v[168:183], v[52:55], a[200:203], v[168:183]
    ds_read_b64_tr_b16 v[38:39], v11 offset:9216
    s_add_u32 m0, s75, 98304
    s_mov_b32 s96, 1048576
    buffer_load_dwordx4 v3, s[48:51], s96 offen offset:0 lds
    v_mfma_f32_32x32x16_bf16 v[184:199], v[40:43], a[204:207], v[184:199]
    s_add_u32 m0, s75, 98304
    s_mov_b32 s96, 1080320
    buffer_load_dwordx4 v3, s[48:51], s96 offen offset:1024 lds
    v_mfma_f32_32x32x16_bf16 v[200:215], v[44:47], a[204:207], v[200:215]
    s_add_u32 m0, s75, 98304
    s_mov_b32 s96, 1112064
    buffer_load_dwordx4 v3, s[48:51], s96 offen offset:2048 lds
    v_mfma_f32_32x32x16_bf16 v[216:231], v[48:51], a[204:207], v[216:231]
    v_mfma_f32_32x32x16_bf16 v[232:247], v[52:55], a[204:207], v[232:247]
    s_add_u32 m0, s75, 98304
    s_mov_b32 s96, 1143808
    buffer_load_dwordx4 v3, s[48:51], s96 offen offset:3072 lds
    s_waitcnt lgkmcnt(0)
    v_mfma_f32_32x32x16_bf16 v[120:135], v[24:27], a[208:211], v[120:135]
    ds_read_b128 a[216:219], v7 offset:0
    ds_read_b64_tr_b16 v[40:41], v8 offset:12288
    ds_read_b64_tr_b16 v[42:43], v8 offset:13312
    v_mfma_f32_32x32x16_bf16 v[136:151], v[28:31], a[208:211], v[136:151]
    ds_read_b128 a[220:223], v7 offset:4096
    ds_read_b64_tr_b16 v[44:45], v9 offset:12288
    ds_read_b64_tr_b16 v[46:47], v9 offset:13312
    v_mfma_f32_32x32x16_bf16 v[152:167], v[32:35], a[208:211], v[152:167]
    ds_read_b64_tr_b16 v[48:49], v10 offset:12288
    ds_read_b64_tr_b16 v[50:51], v10 offset:13312
    ds_read_b64_tr_b16 v[52:53], v11 offset:12288
    v_mfma_f32_32x32x16_bf16 v[168:183], v[36:39], a[208:211], v[168:183]
    ds_read_b64_tr_b16 v[54:55], v11 offset:13312
    v_mfma_f32_32x32x16_bf16 v[184:199], v[24:27], a[212:215], v[184:199]
    v_mfma_f32_32x32x16_bf16 v[200:215], v[28:31], a[212:215], v[200:215]
    v_mfma_f32_32x32x16_bf16 v[216:231], v[32:35], a[212:215], v[216:231]
    s_waitcnt lgkmcnt(0)
    s_waitcnt vmcnt(12)
    s_barrier
    v_add_u32 v4, 49152, v14
    v_xor_b32 v5, 32, v4
    v_xor_b32 v6, 64, v4
    v_xor_b32 v7, 96, v4
    v_mfma_f32_32x32x16_bf16 v[232:247], v[36:39], a[212:215], v[232:247]
    v_add_u32 v8, 49152, v16
    v_add_u32 v9, 49152, v17
    v_add_u32 v10, 49152, v18
    v_add_u32 v11, 49152, v19
    v_mfma_f32_32x32x16_bf16 v[120:135], v[40:43], a[216:219], v[120:135]
    ds_read_b128 a[224:227], v4 offset:0
    ds_read_b64_tr_b16 v[24:25], v8 offset:0
    ds_read_b64_tr_b16 v[26:27], v8 offset:1024
    v_mfma_f32_32x32x16_bf16 v[136:151], v[44:47], a[216:219], v[136:151]
    ds_read_b128 a[228:231], v4 offset:4096
    ds_read_b64_tr_b16 v[28:29], v9 offset:0
    ds_read_b64_tr_b16 v[30:31], v9 offset:1024
    v_mfma_f32_32x32x16_bf16 v[152:167], v[48:51], a[216:219], v[152:167]
    ds_read_b64_tr_b16 v[32:33], v10 offset:0
    ds_read_b64_tr_b16 v[34:35], v10 offset:1024
    ds_read_b64_tr_b16 v[36:37], v11 offset:0
    v_mfma_f32_32x32x16_bf16 v[168:183], v[52:55], a[216:219], v[168:183]
    ds_read_b64_tr_b16 v[38:39], v11 offset:1024
    s_add_u32 m0, s75, 4294934528
    s_mov_b32 s96, 1572864
    buffer_load_dwordx4 v3, s[48:51], s96 offen offset:0 lds
    v_mfma_f32_32x32x16_bf16 v[184:199], v[40:43], a[220:223], v[184:199]
    s_add_u32 m0, s75, 4294934528
    s_mov_b32 s96, 1604608
    buffer_load_dwordx4 v3, s[48:51], s96 offen offset:1024 lds
    s_add_u32 m0, s75, 4294934528
    s_mov_b32 s96, 1636352
    buffer_load_dwordx4 v3, s[48:51], s96 offen offset:2048 lds
    v_mfma_f32_32x32x16_bf16 v[200:215], v[44:47], a[220:223], v[200:215]
    s_add_u32 m0, s75, 4294934528
    s_mov_b32 s96, 1668096
    buffer_load_dwordx4 v3, s[48:51], s96 offen offset:3072 lds
    v_mfma_f32_32x32x16_bf16 v[216:231], v[48:51], a[220:223], v[216:231]
    v_mfma_f32_32x32x16_bf16 v[232:247], v[52:55], a[220:223], v[232:247]
    s_waitcnt lgkmcnt(0)
    v_mfma_f32_32x32x16_bf16 v[120:135], v[24:27], a[224:227], v[120:135]
    ds_read_b128 a[232:235], v5 offset:0
    ds_read_b64_tr_b16 v[40:41], v8 offset:4096
    ds_read_b64_tr_b16 v[42:43], v8 offset:5120
    v_mfma_f32_32x32x16_bf16 v[136:151], v[28:31], a[224:227], v[136:151]
    ds_read_b128 a[236:239], v5 offset:4096
    ds_read_b64_tr_b16 v[44:45], v9 offset:4096
    ds_read_b64_tr_b16 v[46:47], v9 offset:5120
    v_mfma_f32_32x32x16_bf16 v[152:167], v[32:35], a[224:227], v[152:167]
    ds_read_b64_tr_b16 v[48:49], v10 offset:4096
    ds_read_b64_tr_b16 v[50:51], v10 offset:5120
    ds_read_b64_tr_b16 v[52:53], v11 offset:4096
    v_mfma_f32_32x32x16_bf16 v[168:183], v[36:39], a[224:227], v[168:183]
    ds_read_b64_tr_b16 v[54:55], v11 offset:5120
    s_add_u32 m0, s75, 4294950912
    s_mov_b32 s96, 2097152
    buffer_load_dwordx4 v3, s[48:51], s96 offen offset:0 lds
    v_mfma_f32_32x32x16_bf16 v[184:199], v[24:27], a[228:231], v[184:199]
    s_add_u32 m0, s75, 4294950912
    s_mov_b32 s96, 2128896
    buffer_load_dwordx4 v3, s[48:51], s96 offen offset:1024 lds
    s_add_u32 m0, s75, 4294950912
    s_mov_b32 s96, 2160640
    buffer_load_dwordx4 v3, s[48:51], s96 offen offset:2048 lds
    v_mfma_f32_32x32x16_bf16 v[200:215], v[28:31], a[228:231], v[200:215]
    v_mfma_f32_32x32x16_bf16 v[216:231], v[32:35], a[228:231], v[216:231]
    s_add_u32 m0, s75, 4294950912
    s_mov_b32 s96, 2192384
    buffer_load_dwordx4 v3, s[48:51], s96 offen offset:3072 lds
    v_mfma_f32_32x32x16_bf16 v[232:247], v[36:39], a[228:231], v[232:247]
    s_waitcnt lgkmcnt(0)
    v_mfma_f32_32x32x16_bf16 v[120:135], v[40:43], a[232:235], v[120:135]
    ds_read_b128 a[240:243], v6 offset:0
    ds_read_b64_tr_b16 v[24:25], v8 offset:8192
    ds_read_b64_tr_b16 v[26:27], v8 offset:9216
    v_mfma_f32_32x32x16_bf16 v[136:151], v[44:47], a[232:235], v[136:151]
    ds_read_b128 a[244:247], v6 offset:4096
    ds_read_b64_tr_b16 v[28:29], v9 offset:8192
    ds_read_b64_tr_b16 v[30:31], v9 offset:9216
    v_mfma_f32_32x32x16_bf16 v[152:167], v[48:51], a[232:235], v[152:167]
    ds_read_b64_tr_b16 v[32:33], v10 offset:8192
    ds_read_b64_tr_b16 v[34:35], v10 offset:9216
    ds_read_b64_tr_b16 v[36:37], v11 offset:8192
    v_mfma_f32_32x32x16_bf16 v[168:183], v[52:55], a[232:235], v[168:183]
    ds_read_b64_tr_b16 v[38:39], v11 offset:9216
    s_add_u32 m0, s75, 0
    s_mov_b32 s96, 2621440
    buffer_load_dwordx4 v3, s[48:51], s96 offen offset:0 lds
    v_mfma_f32_32x32x16_bf16 v[184:199], v[40:43], a[236:239], v[184:199]
    s_add_u32 m0, s75, 0
    s_mov_b32 s96, 2653184
    buffer_load_dwordx4 v3, s[48:51], s96 offen offset:1024 lds
    v_mfma_f32_32x32x16_bf16 v[200:215], v[44:47], a[236:239], v[200:215]
    s_add_u32 m0, s75, 0
    s_mov_b32 s96, 2684928
    buffer_load_dwordx4 v3, s[48:51], s96 offen offset:2048 lds
    v_mfma_f32_32x32x16_bf16 v[216:231], v[48:51], a[236:239], v[216:231]
    v_mfma_f32_32x32x16_bf16 v[232:247], v[52:55], a[236:239], v[232:247]
    s_add_u32 m0, s75, 0
    s_mov_b32 s96, 2716672
    buffer_load_dwordx4 v3, s[48:51], s96 offen offset:3072 lds
    s_waitcnt lgkmcnt(0)
    v_mfma_f32_32x32x16_bf16 v[120:135], v[24:27], a[240:243], v[120:135]
    ds_read_b128 a[248:251], v7 offset:0
    ds_read_b64_tr_b16 v[40:41], v8 offset:12288
    ds_read_b64_tr_b16 v[42:43], v8 offset:13312
    v_mfma_f32_32x32x16_bf16 v[136:151], v[28:31], a[240:243], v[136:151]
    ds_read_b128 a[252:255], v7 offset:4096
    ds_read_b64_tr_b16 v[44:45], v9 offset:12288
    ds_read_b64_tr_b16 v[46:47], v9 offset:13312
    v_mfma_f32_32x32x16_bf16 v[152:167], v[32:35], a[240:243], v[152:167]
    ds_read_b64_tr_b16 v[48:49], v10 offset:12288
    ds_read_b64_tr_b16 v[50:51], v10 offset:13312
    ds_read_b64_tr_b16 v[52:53], v11 offset:12288
    v_mfma_f32_32x32x16_bf16 v[168:183], v[36:39], a[240:243], v[168:183]
    ds_read_b64_tr_b16 v[54:55], v11 offset:13312
    v_mfma_f32_32x32x16_bf16 v[184:199], v[24:27], a[244:247], v[184:199]
    v_mfma_f32_32x32x16_bf16 v[200:215], v[28:31], a[244:247], v[200:215]
    v_mfma_f32_32x32x16_bf16 v[216:231], v[32:35], a[244:247], v[216:231]
    s_waitcnt lgkmcnt(0)
    s_waitcnt vmcnt(20)
    s_barrier
    v_add_u32 v8, 65536, v16
    v_add_u32 v9, 65536, v17
    v_add_u32 v10, 65536, v18
    v_add_u32 v11, 65536, v19
    v_mfma_f32_32x32x16_bf16 v[232:247], v[36:39], a[244:247], v[232:247]
    s_add_u32 m0, s75, 16384
    s_mov_b32 s96, 3145728
    buffer_load_dwordx4 v3, s[48:51], s96 offen offset:0 lds
    v_mfma_f32_32x32x16_bf16 v[120:135], v[40:43], a[248:251], v[120:135]
    ds_read_b64_tr_b16 v[24:25], v8 offset:0
    ds_read_b64_tr_b16 v[26:27], v8 offset:1024
    ds_read_b64_tr_b16 v[28:29], v9 offset:0
    v_mfma_f32_32x32x16_bf16 v[136:151], v[44:47], a[248:251], v[136:151]
    ds_read_b64_tr_b16 v[30:31], v9 offset:1024
    ds_read_b64_tr_b16 v[32:33], v10 offset:0
    ds_read_b64_tr_b16 v[34:35], v10 offset:1024
    v_mfma_f32_32x32x16_bf16 v[152:167], v[48:51], a[248:251], v[152:167]
    ds_read_b64_tr_b16 v[36:37], v11 offset:0
    ds_read_b64_tr_b16 v[38:39], v11 offset:1024
    v_mfma_f32_32x32x16_bf16 v[168:183], v[52:55], a[248:251], v[168:183]
    s_add_u32 m0, s75, 16384
    s_mov_b32 s96, 3177472
    buffer_load_dwordx4 v3, s[48:51], s96 offen offset:1024 lds
    v_mfma_f32_32x32x16_bf16 v[184:199], v[40:43], a[252:255], v[184:199]
    v_mfma_f32_32x32x16_bf16 v[200:215], v[44:47], a[252:255], v[200:215]
    v_mfma_f32_32x32x16_bf16 v[216:231], v[48:51], a[252:255], v[216:231]
    v_mfma_f32_32x32x16_bf16 v[232:247], v[52:55], a[252:255], v[232:247]
    s_waitcnt lgkmcnt(0)
    v_cvt_pk_bf16_f32 v56, v120, v121
    v_cvt_pk_bf16_f32 v57, v122, v123
    v_cvt_pk_bf16_f32 v58, v124, v125
    v_cvt_pk_bf16_f32 v59, v126, v127
    v_cvt_pk_bf16_f32 v60, v128, v129
    v_cvt_pk_bf16_f32 v61, v130, v131
    v_cvt_pk_bf16_f32 v62, v132, v133
    v_cvt_pk_bf16_f32 v63, v134, v135
    v_mfma_f32_32x32x16_bf16 v[120:135], a[0:3], v[24:27], 0
    ds_read_b64_tr_b16 v[40:41], v8 offset:4096
    ds_read_b64_tr_b16 v[42:43], v8 offset:5120
    ds_read_b64_tr_b16 v[44:45], v9 offset:4096
    v_cvt_pk_bf16_f32 v64, v136, v137
    v_cvt_pk_bf16_f32 v65, v138, v139
    v_cvt_pk_bf16_f32 v66, v140, v141
    v_cvt_pk_bf16_f32 v67, v142, v143
    v_cvt_pk_bf16_f32 v68, v144, v145
    v_cvt_pk_bf16_f32 v69, v146, v147
    v_cvt_pk_bf16_f32 v70, v148, v149
    v_cvt_pk_bf16_f32 v71, v150, v151
    v_mfma_f32_32x32x16_bf16 v[136:151], a[0:3], v[28:31], 0
    ds_read_b64_tr_b16 v[46:47], v9 offset:5120
    ds_read_b64_tr_b16 v[48:49], v10 offset:4096
    ds_read_b64_tr_b16 v[50:51], v10 offset:5120
    v_cvt_pk_bf16_f32 v72, v152, v153
    v_cvt_pk_bf16_f32 v73, v154, v155
    v_cvt_pk_bf16_f32 v74, v156, v157
    v_cvt_pk_bf16_f32 v75, v158, v159
    v_cvt_pk_bf16_f32 v76, v160, v161
    v_cvt_pk_bf16_f32 v77, v162, v163
    v_cvt_pk_bf16_f32 v78, v164, v165
    v_cvt_pk_bf16_f32 v79, v166, v167
    v_mfma_f32_32x32x16_bf16 v[152:167], a[0:3], v[32:35], 0
    ds_read_b64_tr_b16 v[52:53], v11 offset:4096
    ds_read_b64_tr_b16 v[54:55], v11 offset:5120
    v_cvt_pk_bf16_f32 v80, v168, v169
    v_cvt_pk_bf16_f32 v81, v170, v171
    v_cvt_pk_bf16_f32 v82, v172, v173
    v_cvt_pk_bf16_f32 v83, v174, v175
    v_cvt_pk_bf16_f32 v84, v176, v177
    v_cvt_pk_bf16_f32 v85, v178, v179
    v_cvt_pk_bf16_f32 v86, v180, v181
    v_cvt_pk_bf16_f32 v87, v182, v183
    v_mfma_f32_32x32x16_bf16 v[168:183], a[0:3], v[36:39], 0
    s_add_u32 m0, s75, 16384
    s_mov_b32 s96, 3209216
    buffer_load_dwordx4 v3, s[48:51], s96 offen offset:2048 lds
    s_add_u32 m0, s75, 16384
    s_mov_b32 s96, 3240960
    buffer_load_dwordx4 v3, s[48:51], s96 offen offset:3072 lds
    v_cvt_pk_bf16_f32 v88, v184, v185
    v_cvt_pk_bf16_f32 v89, v186, v187
    v_cvt_pk_bf16_f32 v90, v188, v189
    v_cvt_pk_bf16_f32 v91, v190, v191
    v_cvt_pk_bf16_f32 v92, v192, v193
    v_cvt_pk_bf16_f32 v93, v194, v195
    v_cvt_pk_bf16_f32 v94, v196, v197
    v_cvt_pk_bf16_f32 v95, v198, v199
    v_mfma_f32_32x32x16_bf16 v[184:199], a[4:7], v[24:27], 0
    v_cvt_pk_bf16_f32 v96, v200, v201
    v_cvt_pk_bf16_f32 v97, v202, v203
    v_cvt_pk_bf16_f32 v98, v204, v205
    v_cvt_pk_bf16_f32 v99, v206, v207
    v_cvt_pk_bf16_f32 v100, v208, v209
    v_cvt_pk_bf16_f32 v101, v210, v211
    v_cvt_pk_bf16_f32 v102, v212, v213
    v_cvt_pk_bf16_f32 v103, v214, v215
    v_mfma_f32_32x32x16_bf16 v[200:215], a[4:7], v[28:31], 0
    s_lshl_b32 s99, s3, 12
    s_add_u32 m0, s99, 147456
    v_add_u32 v23, 0, v22
    global_load_lds_dwordx4 v23, s[52:53] offset:0
    v_cvt_pk_bf16_f32 v104, v216, v217
    v_cvt_pk_bf16_f32 v105, v218, v219
    v_cvt_pk_bf16_f32 v106, v220, v221
    v_cvt_pk_bf16_f32 v107, v222, v223
    v_cvt_pk_bf16_f32 v108, v224, v225
    v_cvt_pk_bf16_f32 v109, v226, v227
    v_cvt_pk_bf16_f32 v110, v228, v229
    v_cvt_pk_bf16_f32 v111, v230, v231
    v_mfma_f32_32x32x16_bf16 v[216:231], a[4:7], v[32:35], 0
    s_add_u32 m0, s75, 32768
    s_mov_b32 s96, 3670016
    buffer_load_dwordx4 v3, s[48:51], s96 offen offset:0 lds
    v_cvt_pk_bf16_f32 v112, v232, v233
    v_cvt_pk_bf16_f32 v113, v234, v235
    v_cvt_pk_bf16_f32 v114, v236, v237
    v_cvt_pk_bf16_f32 v115, v238, v239
    v_cvt_pk_bf16_f32 v116, v240, v241
    v_cvt_pk_bf16_f32 v117, v242, v243
    v_cvt_pk_bf16_f32 v118, v244, v245
    v_cvt_pk_bf16_f32 v119, v246, v247
    v_mfma_f32_32x32x16_bf16 v[232:247], a[4:7], v[36:39], 0
    s_waitcnt lgkmcnt(0)
    v_mfma_f32_32x32x16_bf16 v[120:135], a[8:11], v[40:43], v[120:135]
    ds_read_b64_tr_b16 v[24:25], v8 offset:8192
    ds_read_b64_tr_b16 v[26:27], v8 offset:9216
    ds_read_b64_tr_b16 v[28:29], v9 offset:8192
    v_mfma_f32_32x32x16_bf16 v[136:151], a[8:11], v[44:47], v[136:151]
    ds_read_b64_tr_b16 v[30:31], v9 offset:9216
    ds_read_b64_tr_b16 v[32:33], v10 offset:8192
    ds_read_b64_tr_b16 v[34:35], v10 offset:9216
    v_mfma_f32_32x32x16_bf16 v[152:167], a[8:11], v[48:51], v[152:167]
    ds_read_b64_tr_b16 v[36:37], v11 offset:8192
    ds_read_b64_tr_b16 v[38:39], v11 offset:9216
    buffer_store_dwordx4 v[56:59], v12, s[68:71], s76 offen offset:0 sc1
    v_mfma_f32_32x32x16_bf16 v[168:183], a[8:11], v[52:55], v[168:183]
    s_add_u32 m0, s75, 32768
    s_mov_b32 s96, 3701760
    buffer_load_dwordx4 v3, s[48:51], s96 offen offset:1024 lds
    v_mfma_f32_32x32x16_bf16 v[184:199], a[12:15], v[40:43], v[184:199]
    s_add_u32 m0, s75, 32768
    s_mov_b32 s96, 3733504
    buffer_load_dwordx4 v3, s[48:51], s96 offen offset:2048 lds
    v_mfma_f32_32x32x16_bf16 v[200:215], a[12:15], v[44:47], v[200:215]
    s_lshl_b32 s99, s3, 12
    s_add_u32 m0, s99, 147456
    v_add_u32 v23, 3072, v22
    global_load_lds_dwordx4 v23, s[52:53] offset:1024
    v_mfma_f32_32x32x16_bf16 v[216:231], a[12:15], v[48:51], v[216:231]
    s_lshl_b32 s99, s3, 12
    s_add_u32 m0, s99, 81920
    s_lshr_b32 s99, s2, 5
    s_lshl_b32 s99, s99, 19
    v_subrev_u32 v23, s99, v22
    v_add_u32 v23, 0, v23
    global_load_lds_dwordx4 v23, s[56:57] offset:0
    v_mfma_f32_32x32x16_bf16 v[232:247], a[12:15], v[52:55], v[232:247]
    s_add_u32 m0, s75, 32768
    s_mov_b32 s96, 3765248
    buffer_load_dwordx4 v3, s[48:51], s96 offen offset:3072 lds
    s_waitcnt lgkmcnt(0)
    v_mfma_f32_32x32x16_bf16 v[120:135], a[16:19], v[24:27], v[120:135]
    ds_read_b64_tr_b16 v[40:41], v8 offset:12288
    ds_read_b64_tr_b16 v[42:43], v8 offset:13312
    ds_read_b64_tr_b16 v[44:45], v9 offset:12288
    v_mfma_f32_32x32x16_bf16 v[136:151], a[16:19], v[28:31], v[136:151]
    ds_read_b64_tr_b16 v[46:47], v9 offset:13312
    ds_read_b64_tr_b16 v[48:49], v10 offset:12288
    ds_read_b64_tr_b16 v[50:51], v10 offset:13312
    v_mfma_f32_32x32x16_bf16 v[152:167], a[16:19], v[32:35], v[152:167]
    ds_read_b64_tr_b16 v[52:53], v11 offset:12288
    ds_read_b64_tr_b16 v[54:55], v11 offset:13312
    v_mfma_f32_32x32x16_bf16 v[168:183], a[16:19], v[36:39], v[168:183]
    s_lshl_b32 s99, s3, 12
    s_add_u32 m0, s99, 147456
    v_add_u32 v23, 6144, v22
    global_load_lds_dwordx4 v23, s[52:53] offset:2048
    v_mfma_f32_32x32x16_bf16 v[184:199], a[20:23], v[24:27], v[184:199]
    s_lshl_b32 s99, s3, 12
    s_add_u32 m0, s99, 81920
    s_lshr_b32 s99, s2, 5
    s_lshl_b32 s99, s99, 19
    v_subrev_u32 v23, s99, v22
    v_add_u32 v23, 3072, v23
    global_load_lds_dwordx4 v23, s[56:57] offset:1024
    v_mfma_f32_32x32x16_bf16 v[200:215], a[20:23], v[28:31], v[200:215]
    s_lshl_b32 s99, s3, 12
    s_add_u32 m0, s99, 81920
    s_lshr_b32 s99, s2, 5
    s_lshl_b32 s99, s99, 19
    v_subrev_u32 v23, s99, v22
    v_add_u32 v23, 6144, v23
    global_load_lds_dwordx4 v23, s[56:57] offset:2048
    v_mfma_f32_32x32x16_bf16 v[216:231], a[20:23], v[32:35], v[216:231]
    s_waitcnt lgkmcnt(0)
    s_waitcnt vmcnt(31)
    s_barrier
    v_add_u32 v8, 81920, v16
    v_add_u32 v9, 81920, v17
    v_add_u32 v10, 81920, v18
    v_add_u32 v11, 81920, v19
    v_mfma_f32_32x32x16_bf16 v[232:247], a[20:23], v[36:39], v[232:247]
    s_lshl_b32 s99, s3, 12
    s_add_u32 m0, s99, 147456
    v_add_u32 v23, 9216, v22
    global_load_lds_dwordx4 v23, s[52:53] offset:3072
    v_mfma_f32_32x32x16_bf16 v[120:135], a[24:27], v[40:43], v[120:135]
    ds_read_b64_tr_b16 v[24:25], v8 offset:0
    ds_read_b64_tr_b16 v[26:27], v8 offset:1024
    ds_read_b64_tr_b16 v[28:29], v9 offset:0
    v_mfma_f32_32x32x16_bf16 v[136:151], a[24:27], v[44:47], v[136:151]
    ds_read_b64_tr_b16 v[30:31], v9 offset:1024
    ds_read_b64_tr_b16 v[32:33], v10 offset:0
    ds_read_b64_tr_b16 v[34:35], v10 offset:1024
    v_mfma_f32_32x32x16_bf16 v[152:167], a[24:27], v[48:51], v[152:167]
    ds_read_b64_tr_b16 v[36:37], v11 offset:0
    ds_read_b64_tr_b16 v[38:39], v11 offset:1024
    buffer_store_dwordx4 v[60:63], v12, s[68:71], s76 offen offset:1024 sc1
    v_mfma_f32_32x32x16_bf16 v[168:183], a[24:27], v[52:55], v[168:183]
    s_lshl_b32 s99, s3, 12
    s_add_u32 m0, s99, 81920
    s_lshr_b32 s99, s2, 5
    s_lshl_b32 s99, s99, 19
    v_subrev_u32 v23, s99, v22
    v_add_u32 v23, 9216, v23
    global_load_lds_dwordx4 v23, s[56:57] offset:3072
    v_mfma_f32_32x32x16_bf16 v[184:199], a[28:31], v[40:43], v[184:199]
    v_mfma_f32_32x32x16_bf16 v[200:215], a[28:31], v[44:47], v[200:215]
    v_mfma_f32_32x32x16_bf16 v[216:231], a[28:31], v[48:51], v[216:231]
    v_mfma_f32_32x32x16_bf16 v[232:247], a[28:31], v[52:55], v[232:247]
    s_waitcnt lgkmcnt(0)
    v_mfma_f32_32x32x16_bf16 v[120:135], a[32:35], v[24:27], v[120:135]
    ds_read_b64_tr_b16 v[40:41], v8 offset:4096
    ds_read_b64_tr_b16 v[42:43], v8 offset:5120
    ds_read_b64_tr_b16 v[44:45], v9 offset:4096
    v_mfma_f32_32x32x16_bf16 v[136:151], a[32:35], v[28:31], v[136:151]
    ds_read_b64_tr_b16 v[46:47], v9 offset:5120
    ds_read_b64_tr_b16 v[48:49], v10 offset:4096
    ds_read_b64_tr_b16 v[50:51], v10 offset:5120
    v_mfma_f32_32x32x16_bf16 v[152:167], a[32:35], v[32:35], v[152:167]
    ds_read_b64_tr_b16 v[52:53], v11 offset:4096
    ds_read_b64_tr_b16 v[54:55], v11 offset:5120
    v_mfma_f32_32x32x16_bf16 v[168:183], a[32:35], v[36:39], v[168:183]
    v_mfma_f32_32x32x16_bf16 v[184:199], a[36:39], v[24:27], v[184:199]
    s_lshl_b32 s98, s2, 2
    s_add_u32 s98, s98, s3
    s_lshl_b32 s99, s98, 11
    v_and_b32 v23, 15, v0
    v_lshlrev_b32 v23, 7, v23
    v_add_u32 v23, s99, v23
    global_load_dword v13, v23, s[16:17]
    v_mfma_f32_32x32x16_bf16 v[200:215], a[36:39], v[28:31], v[200:215]
    v_mfma_f32_32x32x16_bf16 v[216:231], a[36:39], v[32:35], v[216:231]
    v_mfma_f32_32x32x16_bf16 v[232:247], a[36:39], v[36:39], v[232:247]
    s_waitcnt lgkmcnt(0)
    v_mfma_f32_32x32x16_bf16 v[120:135], a[40:43], v[40:43], v[120:135]
    ds_read_b64_tr_b16 v[24:25], v8 offset:8192
    ds_read_b64_tr_b16 v[26:27], v8 offset:9216
    ds_read_b64_tr_b16 v[28:29], v9 offset:8192
    v_mfma_f32_32x32x16_bf16 v[136:151], a[40:43], v[44:47], v[136:151]
    ds_read_b64_tr_b16 v[30:31], v9 offset:9216
    ds_read_b64_tr_b16 v[32:33], v10 offset:8192
    ds_read_b64_tr_b16 v[34:35], v10 offset:9216
    v_mfma_f32_32x32x16_bf16 v[152:167], a[40:43], v[48:51], v[152:167]
    ds_read_b64_tr_b16 v[36:37], v11 offset:8192
    ds_read_b64_tr_b16 v[38:39], v11 offset:9216
    buffer_store_dwordx4 v[64:67], v12, s[68:71], s76 offen offset:2048 sc1
    v_mfma_f32_32x32x16_bf16 v[168:183], a[40:43], v[52:55], v[168:183]
    v_mfma_f32_32x32x16_bf16 v[184:199], a[44:47], v[40:43], v[184:199]
    s_lshl_b32 s99, s98, 12
    v_and_b32 v23, 31, v0
    v_lshlrev_b32 v23, 7, v23
    v_add_u32 v23, s99, v23
    global_load_dword v13, v23, s[26:27]
    v_mfma_f32_32x32x16_bf16 v[200:215], a[44:47], v[44:47], v[200:215]
    v_mfma_f32_32x32x16_bf16 v[216:231], a[44:47], v[48:51], v[216:231]
    v_mfma_f32_32x32x16_bf16 v[232:247], a[44:47], v[52:55], v[232:247]
    s_waitcnt lgkmcnt(0)
    v_mfma_f32_32x32x16_bf16 v[120:135], a[48:51], v[24:27], v[120:135]
    ds_read_b64_tr_b16 v[40:41], v8 offset:12288
    ds_read_b64_tr_b16 v[42:43], v8 offset:13312
    ds_read_b64_tr_b16 v[44:45], v9 offset:12288
    v_mfma_f32_32x32x16_bf16 v[136:151], a[48:51], v[28:31], v[136:151]
    ds_read_b64_tr_b16 v[46:47], v9 offset:13312
    ds_read_b64_tr_b16 v[48:49], v10 offset:12288
    ds_read_b64_tr_b16 v[50:51], v10 offset:13312
    v_mfma_f32_32x32x16_bf16 v[152:167], a[48:51], v[32:35], v[152:167]
    ds_read_b64_tr_b16 v[52:53], v11 offset:12288
    ds_read_b64_tr_b16 v[54:55], v11 offset:13312
    v_mfma_f32_32x32x16_bf16 v[168:183], a[48:51], v[36:39], v[168:183]
    v_mfma_f32_32x32x16_bf16 v[184:199], a[52:55], v[24:27], v[184:199]
    s_lshl_b32 s99, s98, 9
    v_and_b32 v23, 3, v0
    v_lshlrev_b32 v23, 7, v23
    v_add_u32 v23, s99, v23
    global_load_dword v13, v23, s[18:19]
    v_mfma_f32_32x32x16_bf16 v[200:215], a[52:55], v[28:31], v[200:215]
    v_mfma_f32_32x32x16_bf16 v[216:231], a[52:55], v[32:35], v[216:231]
    s_waitcnt lgkmcnt(0)
    s_waitcnt vmcnt(34)
    s_barrier
    v_add_u32 v8, 98304, v16
    v_add_u32 v9, 98304, v17
    v_add_u32 v10, 98304, v18
    v_add_u32 v11, 98304, v19
    v_mfma_f32_32x32x16_bf16 v[232:247], a[52:55], v[36:39], v[232:247]
    v_mfma_f32_32x32x16_bf16 v[120:135], a[56:59], v[40:43], v[120:135]
    ds_read_b64_tr_b16 v[24:25], v8 offset:0
    ds_read_b64_tr_b16 v[26:27], v8 offset:1024
    ds_read_b64_tr_b16 v[28:29], v9 offset:0
    v_mfma_f32_32x32x16_bf16 v[136:151], a[56:59], v[44:47], v[136:151]
    ds_read_b64_tr_b16 v[30:31], v9 offset:1024
    ds_read_b64_tr_b16 v[32:33], v10 offset:0
    ds_read_b64_tr_b16 v[34:35], v10 offset:1024
    v_mfma_f32_32x32x16_bf16 v[152:167], a[56:59], v[48:51], v[152:167]
    ds_read_b64_tr_b16 v[36:37], v11 offset:0
    ds_read_b64_tr_b16 v[38:39], v11 offset:1024
    buffer_store_dwordx4 v[68:71], v12, s[68:71], s76 offen offset:3072 sc1
    v_mfma_f32_32x32x16_bf16 v[168:183], a[56:59], v[52:55], v[168:183]
    v_mfma_f32_32x32x16_bf16 v[184:199], a[60:63], v[40:43], v[184:199]
    v_mfma_f32_32x32x16_bf16 v[200:215], a[60:63], v[44:47], v[200:215]
    v_mfma_f32_32x32x16_bf16 v[216:231], a[60:63], v[48:51], v[216:231]
    v_mfma_f32_32x32x16_bf16 v[232:247], a[60:63], v[52:55], v[232:247]
    s_waitcnt lgkmcnt(0)
    v_mfma_f32_32x32x16_bf16 v[120:135], a[64:67], v[24:27], v[120:135]
    ds_read_b64_tr_b16 v[40:41], v8 offset:4096
    ds_read_b64_tr_b16 v[42:43], v8 offset:5120
    ds_read_b64_tr_b16 v[44:45], v9 offset:4096
    v_mfma_f32_32x32x16_bf16 v[136:151], a[64:67], v[28:31], v[136:151]
    ds_read_b64_tr_b16 v[46:47], v9 offset:5120
    ds_read_b64_tr_b16 v[48:49], v10 offset:4096
    ds_read_b64_tr_b16 v[50:51], v10 offset:5120
    v_mfma_f32_32x32x16_bf16 v[152:167], a[64:67], v[32:35], v[152:167]
    ds_read_b64_tr_b16 v[52:53], v11 offset:4096
    ds_read_b64_tr_b16 v[54:55], v11 offset:5120
    v_mfma_f32_32x32x16_bf16 v[168:183], a[64:67], v[36:39], v[168:183]
    v_mfma_f32_32x32x16_bf16 v[184:199], a[68:71], v[24:27], v[184:199]
    v_mfma_f32_32x32x16_bf16 v[200:215], a[68:71], v[28:31], v[200:215]
    v_mfma_f32_32x32x16_bf16 v[216:231], a[68:71], v[32:35], v[216:231]
    v_mfma_f32_32x32x16_bf16 v[232:247], a[68:71], v[36:39], v[232:247]
    s_waitcnt lgkmcnt(0)
    v_mfma_f32_32x32x16_bf16 v[120:135], a[72:75], v[40:43], v[120:135]
    ds_read_b64_tr_b16 v[24:25], v8 offset:8192
    ds_read_b64_tr_b16 v[26:27], v8 offset:9216
    ds_read_b64_tr_b16 v[28:29], v9 offset:8192
    v_mfma_f32_32x32x16_bf16 v[136:151], a[72:75], v[44:47], v[136:151]
    ds_read_b64_tr_b16 v[30:31], v9 offset:9216
    ds_read_b64_tr_b16 v[32:33], v10 offset:8192
    ds_read_b64_tr_b16 v[34:35], v10 offset:9216
    v_mfma_f32_32x32x16_bf16 v[152:167], a[72:75], v[48:51], v[152:167]
    ds_read_b64_tr_b16 v[36:37], v11 offset:8192
    ds_read_b64_tr_b16 v[38:39], v11 offset:9216
    buffer_store_dwordx4 v[72:75], v12, s[68:71], s77 offen offset:0 sc1
    v_mfma_f32_32x32x16_bf16 v[168:183], a[72:75], v[52:55], v[168:183]
    v_mfma_f32_32x32x16_bf16 v[184:199], a[76:79], v[40:43], v[184:199]
    v_mfma_f32_32x32x16_bf16 v[200:215], a[76:79], v[44:47], v[200:215]
    v_mfma_f32_32x32x16_bf16 v[216:231], a[76:79], v[48:51], v[216:231]
    v_mfma_f32_32x32x16_bf16 v[232:247], a[76:79], v[52:55], v[232:247]
    s_waitcnt lgkmcnt(0)
    v_mfma_f32_32x32x16_bf16 v[120:135], a[80:83], v[24:27], v[120:135]
    ds_read_b64_tr_b16 v[40:41], v8 offset:12288
    ds_read_b64_tr_b16 v[42:43], v8 offset:13312
    ds_read_b64_tr_b16 v[44:45], v9 offset:12288
    v_mfma_f32_32x32x16_bf16 v[136:151], a[80:83], v[28:31], v[136:151]
    ds_read_b64_tr_b16 v[46:47], v9 offset:13312
    ds_read_b64_tr_b16 v[48:49], v10 offset:12288
    ds_read_b64_tr_b16 v[50:51], v10 offset:13312
    v_mfma_f32_32x32x16_bf16 v[152:167], a[80:83], v[32:35], v[152:167]
    ds_read_b64_tr_b16 v[52:53], v11 offset:12288
    ds_read_b64_tr_b16 v[54:55], v11 offset:13312
    v_mfma_f32_32x32x16_bf16 v[168:183], a[80:83], v[36:39], v[168:183]
    v_mfma_f32_32x32x16_bf16 v[184:199], a[84:87], v[24:27], v[184:199]
    v_mfma_f32_32x32x16_bf16 v[200:215], a[84:87], v[28:31], v[200:215]
    v_mfma_f32_32x32x16_bf16 v[216:231], a[84:87], v[32:35], v[216:231]
    s_waitcnt lgkmcnt(0)
    s_waitcnt vmcnt(32)
    s_barrier
    v_add_u32 v8, 4294934528, v16
    v_add_u32 v9, 4294934528, v17
    v_add_u32 v10, 4294934528, v18
    v_add_u32 v11, 4294934528, v19
    v_mfma_f32_32x32x16_bf16 v[232:247], a[84:87], v[36:39], v[232:247]
    v_mfma_f32_32x32x16_bf16 v[120:135], a[88:91], v[40:43], v[120:135]
    ds_read_b64_tr_b16 v[24:25], v8 offset:0
    ds_read_b64_tr_b16 v[26:27], v8 offset:1024
    ds_read_b64_tr_b16 v[28:29], v9 offset:0
    v_mfma_f32_32x32x16_bf16 v[136:151], a[88:91], v[44:47], v[136:151]
    ds_read_b64_tr_b16 v[30:31], v9 offset:1024
    ds_read_b64_tr_b16 v[32:33], v10 offset:0
    ds_read_b64_tr_b16 v[34:35], v10 offset:1024
    v_mfma_f32_32x32x16_bf16 v[152:167], a[88:91], v[48:51], v[152:167]
    ds_read_b64_tr_b16 v[36:37], v11 offset:0
    ds_read_b64_tr_b16 v[38:39], v11 offset:1024
    buffer_store_dwordx4 v[76:79], v12, s[68:71], s77 offen offset:1024 sc1
    v_mfma_f32_32x32x16_bf16 v[168:183], a[88:91], v[52:55], v[168:183]
    v_mfma_f32_32x32x16_bf16 v[184:199], a[92:95], v[40:43], v[184:199]
    v_mfma_f32_32x32x16_bf16 v[200:215], a[92:95], v[44:47], v[200:215]
    v_mfma_f32_32x32x16_bf16 v[216:231], a[92:95], v[48:51], v[216:231]
    v_mfma_f32_32x32x16_bf16 v[232:247], a[92:95], v[52:55], v[232:247]
    s_mov_b32 s44, s26
    s_and_b32 s45, s27, 0xffff
    s_mov_b32 s46, 4194304
    s_mov_b32 s47, 0x20000
    s_bitcmp1_b32 s4, 0
    s_cselect_b32 s98, s22, s20
    s_cselect_b32 s99, s23, s21
    s_cmp_lt_u32 s3, 2
    s_cselect_b32 s98, s18, s98
    s_cselect_b32 s99, s19, s99
    s_cselect_b32 s100, 10, 5
    s_lshl_b32 s84, 64, s100
    s_lshl_b32 s101, 0x200, s100
    s_mov_b32 s40, s98
    s_and_b32 s41, s99, 0xffff
    s_mov_b32 s42, s101
    s_mov_b32 s43, 0x20000
    s_lshl_b32 s98, s4, 5
    s_and_b32 s99, s3, 1
    s_lshl_b32 s99, s99, 5
    v_lshrrev_b32 v251, 1, v0
    v_add_u32 v251, s99, v251
    v_lshlrev_b32 v251, s100, v251
    v_and_b32 v252, 1, v0
    v_lshl_add_u32 v251, v252, 4, v251
    s_cmp_lt_u32 s3, 2
    s_cselect_b32 s98, s98, 0
    v_add_u32 v251, s98, v251
    v_bfe_u32 v252, v0, 2, 2
    v_lshrrev_b32 v253, 5, v0
    v_lshl_add_u32 v252, v253, 3, v252
    v_and_b32 v253, 3, v0
    v_lshlrev_b32 v253, 3, v253
    v_lshl_add_u32 v252, v252, 5, v253
    v_bfe_u32 v253, v0, 4, 1
    v_lshl_add_u32 v252, v253, 11, v252
    v_add_u32 v250, 147456, v252
    s_sub_u32 s98, 15, s5
    s_cmp_lt_u32 s3, 2
    s_cselect_b32 s98, s98, s5
    s_lshl_b32 s98, s98, 7
    s_and_b32 s99, s3, 1
    s_lshl_b32 s99, s99, 6
    s_add_u32 s98, s98, s99
    s_lshl_b32 s99, s5, 8
    s_lshl_b32 s100, s3, 6
    s_add_u32 s99, s99, s100
    s_sub_i32 s98, s98, s99
    s_lshl_b32 s98, s98, 10
    v_add_u32 v248, s98, v1
    v_xor_b32 v249, 64, v248
    s_waitcnt lgkmcnt(0)
    v_mfma_f32_32x32x16_bf16 v[120:135], a[96:99], v[24:27], v[120:135]
    ds_read_b64_tr_b16 v[40:41], v8 offset:4096
    ds_read_b64_tr_b16 v[42:43], v8 offset:5120
    ds_read_b64_tr_b16 v[44:45], v9 offset:4096
    v_mfma_f32_32x32x16_bf16 v[136:151], a[96:99], v[28:31], v[136:151]
    ds_read_b64_tr_b16 v[46:47], v9 offset:5120
    ds_read_b64_tr_b16 v[48:49], v10 offset:4096
    ds_read_b64_tr_b16 v[50:51], v10 offset:5120
    v_mfma_f32_32x32x16_bf16 v[152:167], a[96:99], v[32:35], v[152:167]
    ds_read_b64_tr_b16 v[52:53], v11 offset:4096
    ds_read_b64_tr_b16 v[54:55], v11 offset:5120
    v_mfma_f32_32x32x16_bf16 v[168:183], a[96:99], v[36:39], v[168:183]
    v_mfma_f32_32x32x16_bf16 v[184:199], a[100:103], v[24:27], v[184:199]
    v_mfma_f32_32x32x16_bf16 v[200:215], a[100:103], v[28:31], v[200:215]
    v_mfma_f32_32x32x16_bf16 v[216:231], a[100:103], v[32:35], v[216:231]
    v_mfma_f32_32x32x16_bf16 v[232:247], a[100:103], v[36:39], v[232:247]
    s_waitcnt lgkmcnt(0)
    v_mfma_f32_32x32x16_bf16 v[120:135], a[104:107], v[40:43], v[120:135]
    ds_read_b64_tr_b16 v[24:25], v8 offset:8192
    ds_read_b64_tr_b16 v[26:27], v8 offset:9216
    ds_read_b64_tr_b16 v[28:29], v9 offset:8192
    v_mfma_f32_32x32x16_bf16 v[136:151], a[104:107], v[44:47], v[136:151]
    ds_read_b64_tr_b16 v[30:31], v9 offset:9216
    ds_read_b64_tr_b16 v[32:33], v10 offset:8192
    ds_read_b64_tr_b16 v[34:35], v10 offset:9216
    v_mfma_f32_32x32x16_bf16 v[152:167], a[104:107], v[48:51], v[152:167]
    ds_read_b64_tr_b16 v[36:37], v11 offset:8192
    ds_read_b64_tr_b16 v[38:39], v11 offset:9216
    buffer_store_dwordx4 v[80:83], v12, s[68:71], s77 offen offset:2048 sc1
    v_mfma_f32_32x32x16_bf16 v[168:183], a[104:107], v[52:55], v[168:183]
    v_mfma_f32_32x32x16_bf16 v[184:199], a[108:111], v[40:43], v[184:199]
    v_mfma_f32_32x32x16_bf16 v[200:215], a[108:111], v[44:47], v[200:215]
    v_mfma_f32_32x32x16_bf16 v[216:231], a[108:111], v[48:51], v[216:231]
    v_mfma_f32_32x32x16_bf16 v[232:247], a[108:111], v[52:55], v[232:247]
    s_waitcnt lgkmcnt(0)
    v_mfma_f32_32x32x16_bf16 v[120:135], a[112:115], v[24:27], v[120:135]
    ds_read_b64_tr_b16 v[40:41], v8 offset:12288
    ds_read_b64_tr_b16 v[42:43], v8 offset:13312
    ds_read_b64_tr_b16 v[44:45], v9 offset:12288
    v_mfma_f32_32x32x16_bf16 v[136:151], a[112:115], v[28:31], v[136:151]
    ds_read_b64_tr_b16 v[46:47], v9 offset:13312
    ds_read_b64_tr_b16 v[48:49], v10 offset:12288
    ds_read_b64_tr_b16 v[50:51], v10 offset:13312
    v_mfma_f32_32x32x16_bf16 v[152:167], a[112:115], v[32:35], v[152:167]
    ds_read_b64_tr_b16 v[52:53], v11 offset:12288
    ds_read_b64_tr_b16 v[54:55], v11 offset:13312
    v_mfma_f32_32x32x16_bf16 v[168:183], a[112:115], v[36:39], v[168:183]
    v_mfma_f32_32x32x16_bf16 v[184:199], a[116:119], v[24:27], v[184:199]
    v_mfma_f32_32x32x16_bf16 v[200:215], a[116:119], v[28:31], v[200:215]
    v_mfma_f32_32x32x16_bf16 v[216:231], a[116:119], v[32:35], v[216:231]
    s_waitcnt lgkmcnt(0)
    s_waitcnt vmcnt(30)
    s_barrier
    v_add_u32 v8, 4294950912, v16
    v_add_u32 v9, 4294950912, v17
    v_add_u32 v10, 4294950912, v18
    v_add_u32 v11, 4294950912, v19
    v_mfma_f32_32x32x16_bf16 v[232:247], a[116:119], v[36:39], v[232:247]
    s_add_u32 m0, s74, 98304
    s_mov_b32 s96, 0
    buffer_load_dwordx4 v248, s[36:39], s96 offen offset:0 lds
    v_mfma_f32_32x32x16_bf16 v[120:135], a[120:123], v[40:43], v[120:135]
    ds_read_b64_tr_b16 v[24:25], v8 offset:0
    ds_read_b64_tr_b16 v[26:27], v8 offset:1024
    ds_read_b64_tr_b16 v[28:29], v9 offset:0
    v_mfma_f32_32x32x16_bf16 v[136:151], a[120:123], v[44:47], v[136:151]
    ds_read_b64_tr_b16 v[30:31], v9 offset:1024
    ds_read_b64_tr_b16 v[32:33], v10 offset:0
    ds_read_b64_tr_b16 v[34:35], v10 offset:1024
    v_mfma_f32_32x32x16_bf16 v[152:167], a[120:123], v[48:51], v[152:167]
    ds_read_b64_tr_b16 v[36:37], v11 offset:0
    ds_read_b64_tr_b16 v[38:39], v11 offset:1024
    buffer_store_dwordx4 v[84:87], v12, s[68:71], s77 offen offset:3072 sc1
    v_mfma_f32_32x32x16_bf16 v[168:183], a[120:123], v[52:55], v[168:183]
    s_add_u32 m0, s74, 98304
    s_mov_b32 s96, 7168
    buffer_load_dwordx4 v249, s[36:39], s96 offen offset:1024 lds
    s_add_u32 m0, s74, 98304
    s_mov_b32 s96, 14336
    buffer_load_dwordx4 v248, s[36:39], s96 offen offset:2048 lds
    v_mfma_f32_32x32x16_bf16 v[184:199], a[124:127], v[40:43], v[184:199]
    v_mfma_f32_32x32x16_bf16 v[200:215], a[124:127], v[44:47], v[200:215]
    s_add_u32 m0, s74, 98304
    s_mov_b32 s96, 21504
    buffer_load_dwordx4 v249, s[36:39], s96 offen offset:3072 lds
    v_mfma_f32_32x32x16_bf16 v[216:231], a[124:127], v[48:51], v[216:231]
    v_mfma_f32_32x32x16_bf16 v[232:247], a[124:127], v[52:55], v[232:247]
    s_waitcnt lgkmcnt(0)
    v_mfma_f32_32x32x16_bf16 v[120:135], a[128:131], v[24:27], v[120:135]
    ds_read_b64_tr_b16 v[40:41], v8 offset:4096
    ds_read_b64_tr_b16 v[42:43], v8 offset:5120
    ds_read_b64_tr_b16 v[44:45], v9 offset:4096
    v_mfma_f32_32x32x16_bf16 v[136:151], a[128:131], v[28:31], v[136:151]
    ds_read_b64_tr_b16 v[46:47], v9 offset:5120
    ds_read_b64_tr_b16 v[48:49], v10 offset:4096
    ds_read_b64_tr_b16 v[50:51], v10 offset:5120
    v_mfma_f32_32x32x16_bf16 v[152:167], a[128:131], v[32:35], v[152:167]
    ds_read_b64_tr_b16 v[52:53], v11 offset:4096
    ds_read_b64_tr_b16 v[54:55], v11 offset:5120
    v_mfma_f32_32x32x16_bf16 v[168:183], a[128:131], v[36:39], v[168:183]
    s_add_u32 m0, s74, 102400
    s_mov_b32 s96, 32768
    buffer_load_dwordx4 v248, s[36:39], s96 offen offset:0 lds
    s_add_u32 m0, s74, 102400
    s_mov_b32 s96, 39936
    buffer_load_dwordx4 v249, s[36:39], s96 offen offset:1024 lds
    v_mfma_f32_32x32x16_bf16 v[184:199], a[132:135], v[24:27], v[184:199]
    s_add_u32 m0, s74, 102400
    s_mov_b32 s96, 47104
    buffer_load_dwordx4 v248, s[36:39], s96 offen offset:2048 lds
    v_mfma_f32_32x32x16_bf16 v[200:215], a[132:135], v[28:31], v[200:215]
    v_mfma_f32_32x32x16_bf16 v[216:231], a[132:135], v[32:35], v[216:231]
    s_add_u32 m0, s74, 102400
    s_mov_b32 s96, 54272
    buffer_load_dwordx4 v249, s[36:39], s96 offen offset:3072 lds
    v_mfma_f32_32x32x16_bf16 v[232:247], a[132:135], v[36:39], v[232:247]
    s_waitcnt lgkmcnt(0)
    v_mfma_f32_32x32x16_bf16 v[120:135], a[136:139], v[40:43], v[120:135]
    ds_read_b64_tr_b16 v[24:25], v8 offset:8192
    ds_read_b64_tr_b16 v[26:27], v8 offset:9216
    ds_read_b64_tr_b16 v[28:29], v9 offset:8192
    v_mfma_f32_32x32x16_bf16 v[136:151], a[136:139], v[44:47], v[136:151]
    ds_read_b64_tr_b16 v[30:31], v9 offset:9216
    ds_read_b64_tr_b16 v[32:33], v10 offset:8192
    ds_read_b64_tr_b16 v[34:35], v10 offset:9216
    v_mfma_f32_32x32x16_bf16 v[152:167], a[136:139], v[48:51], v[152:167]
    ds_read_b64_tr_b16 v[36:37], v11 offset:8192
    ds_read_b64_tr_b16 v[38:39], v11 offset:9216
    buffer_store_dwordx4 v[88:91], v12, s[68:71], s78 offen offset:0 sc1
    v_mfma_f32_32x32x16_bf16 v[168:183], a[136:139], v[52:55], v[168:183]
    s_add_u32 m0, s75, 98304
    s_mov_b32 s96, 0
    buffer_load_dwordx4 v3, s[44:47], s96 offen offset:0 lds
    s_add_u32 m0, s75, 98304
    s_mov_b32 s96, 31744
    buffer_load_dwordx4 v3, s[44:47], s96 offen offset:1024 lds
    v_mfma_f32_32x32x16_bf16 v[184:199], a[140:143], v[40:43], v[184:199]
    v_mfma_f32_32x32x16_bf16 v[200:215], a[140:143], v[44:47], v[200:215]
    s_add_u32 m0, s75, 98304
    s_mov_b32 s96, 63488
    buffer_load_dwordx4 v3, s[44:47], s96 offen offset:2048 lds
    v_mfma_f32_32x32x16_bf16 v[216:231], a[140:143], v[48:51], v[216:231]
    v_mfma_f32_32x32x16_bf16 v[232:247], a[140:143], v[52:55], v[232:247]
    s_add_u32 m0, s75, 98304
    s_mov_b32 s96, 95232
    buffer_load_dwordx4 v3, s[44:47], s96 offen offset:3072 lds
    s_waitcnt lgkmcnt(0)
    v_mfma_f32_32x32x16_bf16 v[120:135], a[144:147], v[24:27], v[120:135]
    ds_read_b64_tr_b16 v[40:41], v8 offset:12288
    ds_read_b64_tr_b16 v[42:43], v8 offset:13312
    ds_read_b64_tr_b16 v[44:45], v9 offset:12288
    v_mfma_f32_32x32x16_bf16 v[136:151], a[144:147], v[28:31], v[136:151]
    ds_read_b64_tr_b16 v[46:47], v9 offset:13312
    ds_read_b64_tr_b16 v[48:49], v10 offset:12288
    ds_read_b64_tr_b16 v[50:51], v10 offset:13312
    v_mfma_f32_32x32x16_bf16 v[152:167], a[144:147], v[32:35], v[152:167]
    ds_read_b64_tr_b16 v[52:53], v11 offset:12288
    ds_read_b64_tr_b16 v[54:55], v11 offset:13312
    v_mfma_f32_32x32x16_bf16 v[168:183], a[144:147], v[36:39], v[168:183]
    v_mfma_f32_32x32x16_bf16 v[184:199], a[148:151], v[24:27], v[184:199]
    v_mfma_f32_32x32x16_bf16 v[200:215], a[148:151], v[28:31], v[200:215]
    v_mfma_f32_32x32x16_bf16 v[216:231], a[148:151], v[32:35], v[216:231]
    s_waitcnt lgkmcnt(0)
    s_waitcnt vmcnt(40)
    s_barrier
    v_add_u32 v8, 0, v16
    v_add_u32 v9, 0, v17
    v_add_u32 v10, 0, v18
    v_add_u32 v11, 0, v19
    v_mfma_f32_32x32x16_bf16 v[232:247], a[148:151], v[36:39], v[232:247]
    v_mfma_f32_32x32x16_bf16 v[120:135], a[152:155], v[40:43], v[120:135]
    ds_read_b64_tr_b16 v[24:25], v8 offset:0
    ds_read_b64_tr_b16 v[26:27], v8 offset:1024
    ds_read_b64_tr_b16 v[28:29], v9 offset:0
    v_mfma_f32_32x32x16_bf16 v[136:151], a[152:155], v[44:47], v[136:151]
    ds_read_b64_tr_b16 v[30:31], v9 offset:1024
    ds_read_b64_tr_b16 v[32:33], v10 offset:0
    ds_read_b64_tr_b16 v[34:35], v10 offset:1024
    v_mfma_f32_32x32x16_bf16 v[152:167], a[152:155], v[48:51], v[152:167]
    ds_read_b64_tr_b16 v[36:37], v11 offset:0
    ds_read_b64_tr_b16 v[38:39], v11 offset:1024
    buffer_store_dwordx4 v[92:95], v12, s[68:71], s78 offen offset:1024 sc1
    v_mfma_f32_32x32x16_bf16 v[168:183], a[152:155], v[52:55], v[168:183]
    v_mfma_f32_32x32x16_bf16 v[184:199], a[156:159], v[40:43], v[184:199]
    v_mfma_f32_32x32x16_bf16 v[200:215], a[156:159], v[44:47], v[200:215]
    v_mfma_f32_32x32x16_bf16 v[216:231], a[156:159], v[48:51], v[216:231]
    v_mfma_f32_32x32x16_bf16 v[232:247], a[156:159], v[52:55], v[232:247]
    s_waitcnt lgkmcnt(0)
    v_mfma_f32_32x32x16_bf16 v[120:135], a[160:163], v[24:27], v[120:135]
    ds_read_b64_tr_b16 v[40:41], v8 offset:4096
    ds_read_b64_tr_b16 v[42:43], v8 offset:5120
    ds_read_b64_tr_b16 v[44:45], v9 offset:4096
    v_mfma_f32_32x32x16_bf16 v[136:151], a[160:163], v[28:31], v[136:151]
    ds_read_b64_tr_b16 v[46:47], v9 offset:5120
    ds_read_b64_tr_b16 v[48:49], v10 offset:4096
    ds_read_b64_tr_b16 v[50:51], v10 offset:5120
    v_mfma_f32_32x32x16_bf16 v[152:167], a[160:163], v[32:35], v[152:167]
    ds_read_b64_tr_b16 v[52:53], v11 offset:4096
    ds_read_b64_tr_b16 v[54:55], v11 offset:5120
    v_mfma_f32_32x32x16_bf16 v[168:183], a[160:163], v[36:39], v[168:183]
    v_mfma_f32_32x32x16_bf16 v[184:199], a[164:167], v[24:27], v[184:199]
    v_mfma_f32_32x32x16_bf16 v[200:215], a[164:167], v[28:31], v[200:215]
    v_mfma_f32_32x32x16_bf16 v[216:231], a[164:167], v[32:35], v[216:231]
    v_mfma_f32_32x32x16_bf16 v[232:247], a[164:167], v[36:39], v[232:247]
    s_waitcnt lgkmcnt(0)
    v_mfma_f32_32x32x16_bf16 v[120:135], a[168:171], v[40:43], v[120:135]
    ds_read_b64_tr_b16 v[24:25], v8 offset:8192
    ds_read_b64_tr_b16 v[26:27], v8 offset:9216
    ds_read_b64_tr_b16 v[28:29], v9 offset:8192
    v_mfma_f32_32x32x16_bf16 v[136:151], a[168:171], v[44:47], v[136:151]
    ds_read_b64_tr_b16 v[30:31], v9 offset:9216
    ds_read_b64_tr_b16 v[32:33], v10 offset:8192
    ds_read_b64_tr_b16 v[34:35], v10 offset:9216
    v_mfma_f32_32x32x16_bf16 v[152:167], a[168:171], v[48:51], v[152:167]
    ds_read_b64_tr_b16 v[36:37], v11 offset:8192
    ds_read_b64_tr_b16 v[38:39], v11 offset:9216
    buffer_store_dwordx4 v[96:99], v12, s[68:71], s78 offen offset:2048 sc1
    v_mfma_f32_32x32x16_bf16 v[168:183], a[168:171], v[52:55], v[168:183]
    v_mfma_f32_32x32x16_bf16 v[184:199], a[172:175], v[40:43], v[184:199]
    v_mfma_f32_32x32x16_bf16 v[200:215], a[172:175], v[44:47], v[200:215]
    v_mfma_f32_32x32x16_bf16 v[216:231], a[172:175], v[48:51], v[216:231]
    v_mfma_f32_32x32x16_bf16 v[232:247], a[172:175], v[52:55], v[232:247]
    s_waitcnt lgkmcnt(0)
    v_mfma_f32_32x32x16_bf16 v[120:135], a[176:179], v[24:27], v[120:135]
    ds_read_b64_tr_b16 v[40:41], v8 offset:12288
    ds_read_b64_tr_b16 v[42:43], v8 offset:13312
    ds_read_b64_tr_b16 v[44:45], v9 offset:12288
    v_mfma_f32_32x32x16_bf16 v[136:151], a[176:179], v[28:31], v[136:151]
    ds_read_b64_tr_b16 v[46:47], v9 offset:13312
    ds_read_b64_tr_b16 v[48:49], v10 offset:12288
    ds_read_b64_tr_b16 v[50:51], v10 offset:13312
    v_mfma_f32_32x32x16_bf16 v[152:167], a[176:179], v[32:35], v[152:167]
    ds_read_b64_tr_b16 v[52:53], v11 offset:12288
    ds_read_b64_tr_b16 v[54:55], v11 offset:13312
    v_mfma_f32_32x32x16_bf16 v[168:183], a[176:179], v[36:39], v[168:183]
    v_mfma_f32_32x32x16_bf16 v[184:199], a[180:183], v[24:27], v[184:199]
    v_mfma_f32_32x32x16_bf16 v[200:215], a[180:183], v[28:31], v[200:215]
    v_mfma_f32_32x32x16_bf16 v[216:231], a[180:183], v[32:35], v[216:231]
    s_waitcnt lgkmcnt(0)
    s_waitcnt vmcnt(38)
    s_barrier
    v_add_u32 v8, 16384, v16
    v_add_u32 v9, 16384, v17
    v_add_u32 v10, 16384, v18
    v_add_u32 v11, 16384, v19
    v_mfma_f32_32x32x16_bf16 v[232:247], a[180:183], v[36:39], v[232:247]
    s_add_u32 m0, s74, 0
    s_mov_b32 s96, 128
    buffer_load_dwordx4 v248, s[36:39], s96 offen offset:0 lds
    v_mfma_f32_32x32x16_bf16 v[120:135], a[184:187], v[40:43], v[120:135]
    ds_read_b64_tr_b16 v[24:25], v8 offset:0
    ds_read_b64_tr_b16 v[26:27], v8 offset:1024
    ds_read_b64_tr_b16 v[28:29], v9 offset:0
    v_mfma_f32_32x32x16_bf16 v[136:151], a[184:187], v[44:47], v[136:151]
    ds_read_b64_tr_b16 v[30:31], v9 offset:1024
    ds_read_b64_tr_b16 v[32:33], v10 offset:0
    ds_read_b64_tr_b16 v[34:35], v10 offset:1024
    v_mfma_f32_32x32x16_bf16 v[152:167], a[184:187], v[48:51], v[152:167]
    ds_read_b64_tr_b16 v[36:37], v11 offset:0
    ds_read_b64_tr_b16 v[38:39], v11 offset:1024
    buffer_store_dwordx4 v[100:103], v12, s[68:71], s78 offen offset:3072 sc1
    v_mfma_f32_32x32x16_bf16 v[168:183], a[184:187], v[52:55], v[168:183]
    s_add_u32 m0, s74, 0
    s_mov_b32 s96, 7296
    buffer_load_dwordx4 v249, s[36:39], s96 offen offset:1024 lds
    s_add_u32 m0, s74, 0
    s_mov_b32 s96, 14464
    buffer_load_dwordx4 v248, s[36:39], s96 offen offset:2048 lds
    v_mfma_f32_32x32x16_bf16 v[184:199], a[188:191], v[40:43], v[184:199]
    v_mfma_f32_32x32x16_bf16 v[200:215], a[188:191], v[44:47], v[200:215]
    s_add_u32 m0, s74, 0
    s_mov_b32 s96, 21632
    buffer_load_dwordx4 v249, s[36:39], s96 offen offset:3072 lds
    v_mfma_f32_32x32x16_bf16 v[216:231], a[188:191], v[48:51], v[216:231]
    v_mfma_f32_32x32x16_bf16 v[232:247], a[188:191], v[52:55], v[232:247]
    v_bfe_u32 v88, v0, 2, 2
    v_and_b32 v89, 3, v0
    v_bfe_u32 v90, v0, 4, 1
    v_lshrrev_b32 v91, 5, v0
    v_lshlrev_b32 v92, 1, v89
    v_lshrrev_b32 v93, 1, v89
    v_or_b32 v92, v92, v93
    v_and_b32 v92, 3, v92
    v_lshlrev_b32 v92, 3, v92
    v_lshl_add_u32 v92, v90, 5, v92
    v_lshl_add_u32 v93, v91, 2, v88
    v_lshl_add_u32 v92, v93, 8, v92
    s_lshl_b32 s99, s3, 12
    s_add_u32 s98, s99, 147456
    v_add_u32 v92, s98, v92
    s_lshl_b32 s98, s2, 14
    s_add_u32 s98, s98, s99
    s_add_u32 s98, s98, 83886080
    s_waitcnt vmcnt(31)
    v_xor_b32 v93, 0, v88
    v_lshl_add_u32 v93, v93, 6, v92
    ds_read_b64_tr_b16 v[56:57], v93
    ds_read_b64_tr_b16 v[58:59], v93 offset:2048
    v_xor_b32 v93, 1, v88
    v_lshl_add_u32 v93, v93, 6, v92
    ds_read_b64_tr_b16 v[60:61], v93
    ds_read_b64_tr_b16 v[62:63], v93 offset:2048
    v_xor_b32 v93, 2, v88
    v_lshl_add_u32 v93, v93, 6, v92
    ds_read_b64_tr_b16 v[64:65], v93
    ds_read_b64_tr_b16 v[66:67], v93 offset:2048
    v_xor_b32 v93, 3, v88
    v_lshl_add_u32 v93, v93, 6, v92
    ds_read_b64_tr_b16 v[68:69], v93
    ds_read_b64_tr_b16 v[70:71], v93 offset:2048
    s_waitcnt lgkmcnt(6)
    buffer_store_dwordx4 v[56:59], v12, s[68:71], s98 offen offset:0
    s_waitcnt lgkmcnt(4)
    buffer_store_dwordx4 v[60:63], v12, s[68:71], s98 offen offset:1024
    s_waitcnt lgkmcnt(2)
    buffer_store_dwordx4 v[64:67], v12, s[68:71], s98 offen offset:2048
    s_waitcnt lgkmcnt(0)
    buffer_store_dwordx4 v[68:71], v12, s[68:71], s98 offen offset:3072
    v_bfe_u32 v252, v0, 2, 2
    v_and_b32 v253, 3, v0
    v_lshlrev_b32 v254, 1, v253
    v_lshrrev_b32 v253, 1, v253
    v_or_b32 v254, v254, v253
    v_and_b32 v254, 3, v254
    v_lshlrev_b32 v254, 3, v254
    v_bfe_u32 v253, v0, 4, 1
    v_lshl_add_u32 v254, v253, 5, v254
    v_lshrrev_b32 v253, 5, v0
    v_lshl_add_u32 v253, v253, 3, v252
    v_lshl_add_u32 v254, v253, 8, v254
    s_lshl_b32 s99, s3, 12
    s_add_u32 s98, s99, 81920
    v_add_u32 v254, s98, v254
    s_lshl_b32 s98, s2, 14
    s_add_u32 s98, s98, s99
    s_add_u32 s98, s98, 88080384
    s_waitcnt vmcnt(33)
    v_xor_b32 v253, 0, v252
    v_lshl_add_u32 v253, v253, 6, v254
    ds_read_b64_tr_b16 v[72:73], v253
    ds_read_b64_tr_b16 v[74:75], v253 offset:1024
    v_xor_b32 v253, 1, v252
    v_lshl_add_u32 v253, v253, 6, v254
    ds_read_b64_tr_b16 v[76:77], v253
    ds_read_b64_tr_b16 v[78:79], v253 offset:1024
    v_xor_b32 v253, 2, v252
    v_lshl_add_u32 v253, v253, 6, v254
    ds_read_b64_tr_b16 v[80:81], v253
    ds_read_b64_tr_b16 v[82:83], v253 offset:1024
    v_xor_b32 v253, 3, v252
    v_lshl_add_u32 v253, v253, 6, v254
    ds_read_b64_tr_b16 v[84:85], v253
    ds_read_b64_tr_b16 v[86:87], v253 offset:1024
    s_waitcnt lgkmcnt(0)
    s_cmp_ge_u32 s2, 32
    s_cbranch_scc1 L1_NOWO2
    buffer_store_dwordx4 v[72:75], v12, s[68:71], s98 offen offset:0
    buffer_store_dwordx4 v[76:79], v12, s[68:71], s98 offen offset:1024
    buffer_store_dwordx4 v[80:83], v12, s[68:71], s98 offen offset:2048
    buffer_store_dwordx4 v[84:87], v12, s[68:71], s98 offen offset:3072
    v_mov_b32 v252, 0
    v_mov_b32 v253, 0
    v_mov_b32 v254, 0
    v_mov_b32 v255, 0
    s_mov_b32 s98, 89128960
    buffer_store_dwordx4 v[252:255], v12, s[68:71], s98 offen
    buffer_store_dwordx4 v[252:255], v12, s[68:71], s98 offen offset:1024
    s_nop 1
L1_NOWO2:
    v_mfma_f32_32x32x16_bf16 v[120:135], a[192:195], v[24:27], v[120:135]
    ds_read_b64_tr_b16 v[40:41], v8 offset:4096
    ds_read_b64_tr_b16 v[42:43], v8 offset:5120
    ds_read_b64_tr_b16 v[44:45], v9 offset:4096
    v_mfma_f32_32x32x16_bf16 v[136:151], a[192:195], v[28:31], v[136:151]
    ds_read_b64_tr_b16 v[46:47], v9 offset:5120
    ds_read_b64_tr_b16 v[48:49], v10 offset:4096
    ds_read_b64_tr_b16 v[50:51], v10 offset:5120
    v_mfma_f32_32x32x16_bf16 v[152:167], a[192:195], v[32:35], v[152:167]
    ds_read_b64_tr_b16 v[52:53], v11 offset:4096
    ds_read_b64_tr_b16 v[54:55], v11 offset:5120
    v_mfma_f32_32x32x16_bf16 v[168:183], a[192:195], v[36:39], v[168:183]
    s_add_u32 m0, s74, 4096
    s_mov_b32 s96, 32896
    buffer_load_dwordx4 v248, s[36:39], s96 offen offset:0 lds
    s_add_u32 m0, s74, 4096
    s_mov_b32 s96, 40064
    buffer_load_dwordx4 v249, s[36:39], s96 offen offset:1024 lds
    v_mfma_f32_32x32x16_bf16 v[184:199], a[196:199], v[24:27], v[184:199]
    s_add_u32 m0, s74, 4096
    s_mov_b32 s96, 47232
    buffer_load_dwordx4 v248, s[36:39], s96 offen offset:2048 lds
    v_mfma_f32_32x32x16_bf16 v[200:215], a[196:199], v[28:31], v[200:215]
    v_mfma_f32_32x32x16_bf16 v[216:231], a[196:199], v[32:35], v[216:231]
    s_add_u32 m0, s74, 4096
    s_mov_b32 s96, 54400
    buffer_load_dwordx4 v249, s[36:39], s96 offen offset:3072 lds
    v_mfma_f32_32x32x16_bf16 v[232:247], a[196:199], v[36:39], v[232:247]
    s_waitcnt lgkmcnt(0)
    v_mfma_f32_32x32x16_bf16 v[120:135], a[200:203], v[40:43], v[120:135]
    ds_read_b64_tr_b16 v[24:25], v8 offset:8192
    ds_read_b64_tr_b16 v[26:27], v8 offset:9216
    ds_read_b64_tr_b16 v[28:29], v9 offset:8192
    v_mfma_f32_32x32x16_bf16 v[136:151], a[200:203], v[44:47], v[136:151]
    ds_read_b64_tr_b16 v[30:31], v9 offset:9216
    ds_read_b64_tr_b16 v[32:33], v10 offset:8192
    ds_read_b64_tr_b16 v[34:35], v10 offset:9216
    v_mfma_f32_32x32x16_bf16 v[152:167], a[200:203], v[48:51], v[152:167]
    ds_read_b64_tr_b16 v[36:37], v11 offset:8192
    ds_read_b64_tr_b16 v[38:39], v11 offset:9216
    buffer_store_dwordx4 v[104:107], v12, s[68:71], s79 offen offset:0 sc1
    v_mfma_f32_32x32x16_bf16 v[168:183], a[200:203], v[52:55], v[168:183]
    s_add_u32 m0, s75, 0
    s_mov_b32 s96, 524288
    buffer_load_dwordx4 v3, s[44:47], s96 offen offset:0 lds
    s_add_u32 m0, s75, 0
    s_mov_b32 s96, 556032
    buffer_load_dwordx4 v3, s[44:47], s96 offen offset:1024 lds
    v_mfma_f32_32x32x16_bf16 v[184:199], a[204:207], v[40:43], v[184:199]
    v_mfma_f32_32x32x16_bf16 v[200:215], a[204:207], v[44:47], v[200:215]
    s_add_u32 m0, s75, 0
    s_mov_b32 s96, 587776
    buffer_load_dwordx4 v3, s[44:47], s96 offen offset:2048 lds
    v_mfma_f32_32x32x16_bf16 v[216:231], a[204:207], v[48:51], v[216:231]
    v_mfma_f32_32x32x16_bf16 v[232:247], a[204:207], v[52:55], v[232:247]
    s_add_u32 m0, s75, 0
    s_mov_b32 s96, 619520
    buffer_load_dwordx4 v3, s[44:47], s96 offen offset:3072 lds
    s_waitcnt lgkmcnt(0)
    v_mfma_f32_32x32x16_bf16 v[120:135], a[208:211], v[24:27], v[120:135]
    ds_read_b64_tr_b16 v[40:41], v8 offset:12288
    ds_read_b64_tr_b16 v[42:43], v8 offset:13312
    ds_read_b64_tr_b16 v[44:45], v9 offset:12288
    v_mfma_f32_32x32x16_bf16 v[136:151], a[208:211], v[28:31], v[136:151]
    ds_read_b64_tr_b16 v[46:47], v9 offset:13312
    ds_read_b64_tr_b16 v[48:49], v10 offset:12288
    ds_read_b64_tr_b16 v[50:51], v10 offset:13312
    v_mfma_f32_32x32x16_bf16 v[152:167], a[208:211], v[32:35], v[152:167]
    ds_read_b64_tr_b16 v[52:53], v11 offset:12288
    ds_read_b64_tr_b16 v[54:55], v11 offset:13312
    v_mfma_f32_32x32x16_bf16 v[168:183], a[208:211], v[36:39], v[168:183]
    v_mfma_f32_32x32x16_bf16 v[184:199], a[212:215], v[24:27], v[184:199]
    v_mfma_f32_32x32x16_bf16 v[200:215], a[212:215], v[28:31], v[200:215]
    v_mfma_f32_32x32x16_bf16 v[216:231], a[212:215], v[32:35], v[216:231]
    s_waitcnt lgkmcnt(0)
    s_barrier
    v_add_u32 v8, 32768, v16
    v_add_u32 v9, 32768, v17
    v_add_u32 v10, 32768, v18
    v_add_u32 v11, 32768, v19
    v_mfma_f32_32x32x16_bf16 v[232:247], a[212:215], v[36:39], v[232:247]
    s_lshl_b32 s96, s3, 10
    s_add_u32 m0, s96, 147456
    s_mul_i32 s96, s84, 0
    buffer_load_dwordx4 v251, s[40:43], s96 offen lds
    v_mfma_f32_32x32x16_bf16 v[120:135], a[216:219], v[40:43], v[120:135]
    ds_read_b64_tr_b16 v[24:25], v8 offset:0
    ds_read_b64_tr_b16 v[26:27], v8 offset:1024
    ds_read_b64_tr_b16 v[28:29], v9 offset:0
    v_mfma_f32_32x32x16_bf16 v[136:151], a[216:219], v[44:47], v[136:151]
    ds_read_b64_tr_b16 v[30:31], v9 offset:1024
    ds_read_b64_tr_b16 v[32:33], v10 offset:0
    ds_read_b64_tr_b16 v[34:35], v10 offset:1024
    v_mfma_f32_32x32x16_bf16 v[152:167], a[216:219], v[48:51], v[152:167]
    ds_read_b64_tr_b16 v[36:37], v11 offset:0
    ds_read_b64_tr_b16 v[38:39], v11 offset:1024
    buffer_store_dwordx4 v[108:111], v12, s[68:71], s79 offen offset:1024 sc1
    v_mfma_f32_32x32x16_bf16 v[168:183], a[216:219], v[52:55], v[168:183]
    s_lshl_b32 s96, s3, 10
    s_add_u32 m0, s96, 151552
    s_mul_i32 s96, s84, 1
    buffer_load_dwordx4 v251, s[40:43], s96 offen lds
    v_mfma_f32_32x32x16_bf16 v[184:199], a[220:223], v[40:43], v[184:199]
    v_mfma_f32_32x32x16_bf16 v[200:215], a[220:223], v[44:47], v[200:215]
    v_mfma_f32_32x32x16_bf16 v[216:231], a[220:223], v[48:51], v[216:231]
    v_mfma_f32_32x32x16_bf16 v[232:247], a[220:223], v[52:55], v[232:247]
    s_waitcnt lgkmcnt(0)
    v_mfma_f32_32x32x16_bf16 v[120:135], a[224:227], v[24:27], v[120:135]
    ds_read_b64_tr_b16 v[40:41], v8 offset:4096
    ds_read_b64_tr_b16 v[42:43], v8 offset:5120
    ds_read_b64_tr_b16 v[44:45], v9 offset:4096
    s_nop 0
    v_mfma_f32_32x32x16_bf16 v[136:151], a[224:227], v[28:31], v[136:151]
    ds_read_b64_tr_b16 v[46:47], v9 offset:5120
    ds_read_b64_tr_b16 v[48:49], v10 offset:4096
    ds_read_b64_tr_b16 v[50:51], v10 offset:5120
    v_mfma_f32_32x32x16_bf16 v[152:167], a[224:227], v[32:35], v[152:167]
    ds_read_b64_tr_b16 v[52:53], v11 offset:4096
    ds_read_b64_tr_b16 v[54:55], v11 offset:5120
    v_mfma_f32_32x32x16_bf16 v[168:183], a[224:227], v[36:39], v[168:183]
    v_mfma_f32_32x32x16_bf16 v[184:199], a[228:231], v[24:27], v[184:199]
    s_nop 0
    v_mfma_f32_32x32x16_bf16 v[200:215], a[228:231], v[28:31], v[200:215]
    v_mfma_f32_32x32x16_bf16 v[216:231], a[228:231], v[32:35], v[216:231]
    v_mfma_f32_32x32x16_bf16 v[232:247], a[228:231], v[36:39], v[232:247]
    s_waitcnt lgkmcnt(0)
    v_mfma_f32_32x32x16_bf16 v[120:135], a[232:235], v[40:43], v[120:135]
    ds_read_b64_tr_b16 v[24:25], v8 offset:8192
    ds_read_b64_tr_b16 v[26:27], v8 offset:9216
    ds_read_b64_tr_b16 v[28:29], v9 offset:8192
    v_mfma_f32_32x32x16_bf16 v[136:151], a[232:235], v[44:47], v[136:151]
    ds_read_b64_tr_b16 v[30:31], v9 offset:9216
    ds_read_b64_tr_b16 v[32:33], v10 offset:8192
    ds_read_b64_tr_b16 v[34:35], v10 offset:9216
    s_nop 0
    v_mfma_f32_32x32x16_bf16 v[152:167], a[232:235], v[48:51], v[152:167]
    ds_read_b64_tr_b16 v[36:37], v11 offset:8192
    ds_read_b64_tr_b16 v[38:39], v11 offset:9216
    buffer_store_dwordx4 v[112:115], v12, s[68:71], s79 offen offset:2048 sc1
    v_mfma_f32_32x32x16_bf16 v[168:183], a[232:235], v[52:55], v[168:183]
    v_mfma_f32_32x32x16_bf16 v[184:199], a[236:239], v[40:43], v[184:199]
    v_mfma_f32_32x32x16_bf16 v[200:215], a[236:239], v[44:47], v[200:215]
    s_nop 0
    v_mfma_f32_32x32x16_bf16 v[216:231], a[236:239], v[48:51], v[216:231]
    v_mfma_f32_32x32x16_bf16 v[232:247], a[236:239], v[52:55], v[232:247]
    s_waitcnt lgkmcnt(0)
    v_mfma_f32_32x32x16_bf16 v[120:135], a[240:243], v[24:27], v[120:135]
    ds_read_b64_tr_b16 v[40:41], v8 offset:12288
    ds_read_b64_tr_b16 v[42:43], v8 offset:13312
    ds_read_b64_tr_b16 v[44:45], v9 offset:12288
    v_mfma_f32_32x32x16_bf16 v[136:151], a[240:243], v[28:31], v[136:151]
    ds_read_b64_tr_b16 v[46:47], v9 offset:13312
    ds_read_b64_tr_b16 v[48:49], v10 offset:12288
    ds_read_b64_tr_b16 v[50:51], v10 offset:13312
    v_mfma_f32_32x32x16_bf16 v[152:167], a[240:243], v[32:35], v[152:167]
    ds_read_b64_tr_b16 v[52:53], v11 offset:12288
    ds_read_b64_tr_b16 v[54:55], v11 offset:13312
    v_mfma_f32_32x32x16_bf16 v[168:183], a[240:243], v[36:39], v[168:183]
    v_mfma_f32_32x32x16_bf16 v[184:199], a[244:247], v[24:27], v[184:199]
    v_mfma_f32_32x32x16_bf16 v[200:215], a[244:247], v[28:31], v[200:215]
    v_mfma_f32_32x32x16_bf16 v[216:231], a[244:247], v[32:35], v[216:231]
    s_waitcnt lgkmcnt(0)
    s_waitcnt vmcnt(3)
    s_barrier
    v_add_u32 v4, 98304, v14
    v_xor_b32 v5, 32, v4
    v_xor_b32 v6, 64, v4
    v_xor_b32 v7, 96, v4
    v_mfma_f32_32x32x16_bf16 v[232:247], a[244:247], v[36:39], v[232:247]
    v_add_u32 v8, 98304, v16
    v_add_u32 v9, 98304, v17
    v_add_u32 v10, 98304, v18
    v_add_u32 v11, 98304, v19
    v_mfma_f32_32x32x16_bf16 v[120:135], a[248:251], v[40:43], v[120:135]
    ds_read_b128 a[192:195], v4 offset:0
    ds_read_b64_tr_b16 v[24:25], v8 offset:0
    ds_read_b64_tr_b16 v[26:27], v8 offset:1024
    v_mfma_f32_32x32x16_bf16 v[136:151], a[248:251], v[44:47], v[136:151]
    ds_read_b128 a[196:199], v4 offset:4096
    ds_read_b64_tr_b16 v[28:29], v9 offset:0
    ds_read_b64_tr_b16 v[30:31], v9 offset:1024
    v_mfma_f32_32x32x16_bf16 v[152:167], a[248:251], v[48:51], v[152:167]
    ds_read_b64_tr_b16 v[32:33], v10 offset:0
    ds_read_b64_tr_b16 v[34:35], v10 offset:1024
    ds_read_b64_tr_b16 v[36:37], v11 offset:0
    v_mfma_f32_32x32x16_bf16 v[168:183], a[248:251], v[52:55], v[168:183]
    ds_read_b64_tr_b16 v[38:39], v11 offset:1024
    ds_read_b64_tr_b16 a[208:209], v250 offset:0
    ds_read_b64_tr_b16 a[210:211], v250 offset:128
    v_mfma_f32_32x32x16_bf16 v[184:199], a[252:255], v[40:43], v[184:199]
    s_add_u32 m0, s74, 49152
    s_mov_b32 s96, 256
    buffer_load_dwordx4 v248, s[36:39], s96 offen offset:0 lds
    s_add_u32 m0, s74, 49152
    s_mov_b32 s96, 7424
    buffer_load_dwordx4 v249, s[36:39], s96 offen offset:1024 lds
    v_mfma_f32_32x32x16_bf16 v[200:215], a[252:255], v[44:47], v[200:215]
    s_add_u32 m0, s74, 49152
    s_mov_b32 s96, 14592
    buffer_load_dwordx4 v248, s[36:39], s96 offen offset:2048 lds
    s_add_u32 m0, s74, 49152
    s_mov_b32 s96, 21760
    buffer_load_dwordx4 v249, s[36:39], s96 offen offset:3072 lds
    v_mfma_f32_32x32x16_bf16 v[216:231], a[252:255], v[48:51], v[216:231]
    buffer_store_dwordx4 v[116:119], v12, s[68:71], s79 offen offset:3072 sc1
    v_mfma_f32_32x32x16_bf16 v[232:247], a[252:255], v[52:55], v[232:247]
    s_waitcnt lgkmcnt(0)
    v_cvt_pk_bf16_f32 v56, v120, v121
    v_cvt_pk_bf16_f32 v57, v122, v123
    v_cvt_pk_bf16_f32 v58, v124, v125
    v_cvt_pk_bf16_f32 v59, v126, v127
    v_cvt_pk_bf16_f32 v60, v128, v129
    v_cvt_pk_bf16_f32 v61, v130, v131
    v_cvt_pk_bf16_f32 v62, v132, v133
    v_cvt_pk_bf16_f32 v63, v134, v135
    v_mfma_f32_32x32x16_bf16 v[120:135], v[24:27], a[192:195], 0
    ds_read_b128 a[200:203], v5 offset:0
    ds_read_b64_tr_b16 v[40:41], v8 offset:4096
    ds_read_b64_tr_b16 v[42:43], v8 offset:5120
    v_cvt_pk_bf16_f32 v64, v136, v137
    v_cvt_pk_bf16_f32 v65, v138, v139
    v_cvt_pk_bf16_f32 v66, v140, v141
    v_cvt_pk_bf16_f32 v67, v142, v143
    v_cvt_pk_bf16_f32 v68, v144, v145
    v_cvt_pk_bf16_f32 v69, v146, v147
    v_cvt_pk_bf16_f32 v70, v148, v149
    v_cvt_pk_bf16_f32 v71, v150, v151
    v_mfma_f32_32x32x16_bf16 v[136:151], v[28:31], a[192:195], 0
    ds_read_b128 a[204:207], v5 offset:4096
    ds_read_b64_tr_b16 v[44:45], v9 offset:4096
    ds_read_b64_tr_b16 v[46:47], v9 offset:5120
    v_cvt_pk_bf16_f32 v72, v152, v153
    v_cvt_pk_bf16_f32 v73, v154, v155
    v_cvt_pk_bf16_f32 v74, v156, v157
    v_cvt_pk_bf16_f32 v75, v158, v159
    v_cvt_pk_bf16_f32 v76, v160, v161
    v_cvt_pk_bf16_f32 v77, v162, v163
    v_cvt_pk_bf16_f32 v78, v164, v165
    v_cvt_pk_bf16_f32 v79, v166, v167
    v_mfma_f32_32x32x16_bf16 v[152:167], v[32:35], a[192:195], 0
    ds_read_b64_tr_b16 v[48:49], v10 offset:4096
    ds_read_b64_tr_b16 v[50:51], v10 offset:5120
    ds_read_b64_tr_b16 v[52:53], v11 offset:4096
    v_cvt_pk_bf16_f32 v80, v168, v169
    v_cvt_pk_bf16_f32 v81, v170, v171
    v_cvt_pk_bf16_f32 v82, v172, v173
    v_cvt_pk_bf16_f32 v83, v174, v175
    v_cvt_pk_bf16_f32 v84, v176, v177
    v_cvt_pk_bf16_f32 v85, v178, v179
    v_cvt_pk_bf16_f32 v86, v180, v181
    v_cvt_pk_bf16_f32 v87, v182, v183
    v_mfma_f32_32x32x16_bf16 v[168:183], v[36:39], a[192:195], 0
    ds_read_b64_tr_b16 v[54:55], v11 offset:5120
    ds_read_b64_tr_b16 a[212:213], v250 offset:512
    ds_read_b64_tr_b16 a[214:215], v250 offset:640
    v_cvt_pk_bf16_f32 v88, v184, v185
    v_cvt_pk_bf16_f32 v89, v186, v187
    v_cvt_pk_bf16_f32 v90, v188, v189
    v_cvt_pk_bf16_f32 v91, v190, v191
    v_cvt_pk_bf16_f32 v92, v192, v193
    v_cvt_pk_bf16_f32 v93, v194, v195
    v_cvt_pk_bf16_f32 v94, v196, v197
    v_cvt_pk_bf16_f32 v95, v198, v199
    v_mfma_f32_32x32x16_bf16 v[184:199], v[24:27], a[196:199], 0
    s_add_u32 m0, s74, 53248
    s_mov_b32 s96, 33024
    buffer_load_dwordx4 v248, s[36:39], s96 offen offset:0 lds
    s_add_u32 m0, s74, 53248
    s_mov_b32 s96, 40192
    buffer_load_dwordx4 v249, s[36:39], s96 offen offset:1024 lds
    v_cvt_pk_bf16_f32 v96, v200, v201
    v_cvt_pk_bf16_f32 v97, v202, v203
    v_cvt_pk_bf16_f32 v98, v204, v205
    v_cvt_pk_bf16_f32 v99, v206, v207
    v_cvt_pk_bf16_f32 v100, v208, v209
    v_cvt_pk_bf16_f32 v101, v210, v211
    v_cvt_pk_bf16_f32 v102, v212, v213
    v_cvt_pk_bf16_f32 v103, v214, v215
    v_mfma_f32_32x32x16_bf16 v[200:215], v[28:31], a[196:199], 0
    s_add_u32 m0, s74, 53248
    s_mov_b32 s96, 47360
    buffer_load_dwordx4 v248, s[36:39], s96 offen offset:2048 lds
    v_cvt_pk_bf16_f32 v104, v216, v217
    v_cvt_pk_bf16_f32 v105, v218, v219
    v_cvt_pk_bf16_f32 v106, v220, v221
    v_cvt_pk_bf16_f32 v107, v222, v223
    v_cvt_pk_bf16_f32 v108, v224, v225
    v_cvt_pk_bf16_f32 v109, v226, v227
    v_cvt_pk_bf16_f32 v110, v228, v229
    v_cvt_pk_bf16_f32 v111, v230, v231
    v_mfma_f32_32x32x16_bf16 v[216:231], v[32:35], a[196:199], 0
    v_cvt_pk_bf16_f32 v112, v232, v233
    v_cvt_pk_bf16_f32 v113, v234, v235
    v_cvt_pk_bf16_f32 v114, v236, v237
    v_cvt_pk_bf16_f32 v115, v238, v239
    v_cvt_pk_bf16_f32 v116, v240, v241
    v_cvt_pk_bf16_f32 v117, v242, v243
    v_cvt_pk_bf16_f32 v118, v244, v245
    v_cvt_pk_bf16_f32 v119, v246, v247
    v_mfma_f32_32x32x16_bf16 v[232:247], v[36:39], a[196:199], 0
    v_mfma_f32_32x32x16_bf16 a[128:143], a[208:211], a[192:195], 0
    s_add_u32 m0, s74, 53248
    s_mov_b32 s96, 54528
    buffer_load_dwordx4 v249, s[36:39], s96 offen offset:3072 lds
    v_mfma_f32_32x32x16_bf16 a[144:159], a[208:211], a[196:199], 0
    s_waitcnt lgkmcnt(0)
    v_mfma_f32_32x32x16_bf16 v[120:135], v[40:43], a[200:203], v[120:135]
    ds_read_b128 a[192:195], v6 offset:0
    ds_read_b64_tr_b16 v[24:25], v8 offset:8192
    ds_read_b64_tr_b16 v[26:27], v8 offset:9216
    v_mfma_f32_32x32x16_bf16 v[136:151], v[44:47], a[200:203], v[136:151]
    ds_read_b128 a[196:199], v6 offset:4096
    ds_read_b64_tr_b16 v[28:29], v9 offset:8192
    ds_read_b64_tr_b16 v[30:31], v9 offset:9216
    v_mfma_f32_32x32x16_bf16 v[152:167], v[48:51], a[200:203], v[152:167]
    ds_read_b64_tr_b16 v[32:33], v10 offset:8192
    ds_read_b64_tr_b16 v[34:35], v10 offset:9216
    ds_read_b64_tr_b16 v[36:37], v11 offset:8192
    v_mfma_f32_32x32x16_bf16 v[168:183], v[52:55], a[200:203], v[168:183]
    ds_read_b64_tr_b16 v[38:39], v11 offset:9216
    ds_read_b64_tr_b16 a[208:209], v250 offset:1024
    ds_read_b64_tr_b16 a[210:211], v250 offset:1152
    v_mfma_f32_32x32x16_bf16 v[184:199], v[40:43], a[204:207], v[184:199]
    s_lshl_b32 s96, s3, 10
    s_add_u32 m0, s96, 155648
    s_mul_i32 s96, s84, 2
    buffer_load_dwordx4 v251, s[40:43], s96 offen lds
    buffer_store_dwordx4 v[56:59], v12, s[68:71], s80 offen offset:0 sc1
    v_mfma_f32_32x32x16_bf16 v[200:215], v[44:47], a[204:207], v[200:215]
    s_add_u32 m0, s75, 49152
    s_mov_b32 s96, 1048576
    buffer_load_dwordx4 v3, s[44:47], s96 offen offset:0 lds
    buffer_store_dwordx4 v[60:63], v12, s[68:71], s81 offen offset:0 sc1
    v_mfma_f32_32x32x16_bf16 v[216:231], v[48:51], a[204:207], v[216:231]
    s_add_u32 m0, s75, 49152
    s_mov_b32 s96, 1080320
    buffer_load_dwordx4 v3, s[44:47], s96 offen offset:1024 lds
    buffer_store_dwordx4 v[64:67], v12, s[68:71], s80 offen offset:1024 sc1
    v_mfma_f32_32x32x16_bf16 v[232:247], v[52:55], a[204:207], v[232:247]
    v_mfma_f32_32x32x16_bf16 a[128:143], a[212:215], a[200:203], a[128:143]
    s_add_u32 m0, s75, 49152
    s_mov_b32 s96, 1112064
    buffer_load_dwordx4 v3, s[44:47], s96 offen offset:2048 lds
    v_mfma_f32_32x32x16_bf16 a[144:159], a[212:215], a[204:207], a[144:159]
    buffer_store_dwordx4 v[68:71], v12, s[68:71], s81 offen offset:1024 sc1
    s_waitcnt lgkmcnt(0)
    v_mfma_f32_32x32x16_bf16 v[120:135], v[24:27], a[192:195], v[120:135]
    ds_read_b128 a[200:203], v7 offset:0
    ds_read_b64_tr_b16 v[40:41], v8 offset:12288
    ds_read_b64_tr_b16 v[42:43], v8 offset:13312
    v_mfma_f32_32x32x16_bf16 v[136:151], v[28:31], a[192:195], v[136:151]
    ds_read_b128 a[204:207], v7 offset:4096
    ds_read_b64_tr_b16 v[44:45], v9 offset:12288
    ds_read_b64_tr_b16 v[46:47], v9 offset:13312
    v_mfma_f32_32x32x16_bf16 v[152:167], v[32:35], a[192:195], v[152:167]
    ds_read_b64_tr_b16 v[48:49], v10 offset:12288
    ds_read_b64_tr_b16 v[50:51], v10 offset:13312
    ds_read_b64_tr_b16 v[52:53], v11 offset:12288
    v_mfma_f32_32x32x16_bf16 v[168:183], v[36:39], a[192:195], v[168:183]
    ds_read_b64_tr_b16 v[54:55], v11 offset:13312
    ds_read_b64_tr_b16 a[212:213], v250 offset:1536
    ds_read_b64_tr_b16 a[214:215], v250 offset:1664
    v_mfma_f32_32x32x16_bf16 v[184:199], v[24:27], a[196:199], v[184:199]
    s_add_u32 m0, s75, 49152
    s_mov_b32 s96, 1143808
    buffer_load_dwordx4 v3, s[44:47], s96 offen offset:3072 lds
    buffer_store_dwordx4 v[72:75], v12, s[68:71], s80 offen offset:2048 sc1
    v_mfma_f32_32x32x16_bf16 v[200:215], v[28:31], a[196:199], v[200:215]
    buffer_store_dwordx4 v[76:79], v12, s[68:71], s81 offen offset:2048 sc1
    v_mfma_f32_32x32x16_bf16 v[216:231], v[32:35], a[196:199], v[216:231]
    v_mfma_f32_32x32x16_bf16 v[232:247], v[36:39], a[196:199], v[232:247]
    v_mfma_f32_32x32x16_bf16 a[128:143], a[208:211], a[192:195], a[128:143]
    s_waitcnt lgkmcnt(0)
    s_waitcnt vmcnt(21)
    s_barrier
    v_add_u32 v4, 0, v14
    v_xor_b32 v5, 32, v4
    v_xor_b32 v6, 64, v4
    v_xor_b32 v7, 96, v4
    v_mfma_f32_32x32x16_bf16 a[144:159], a[208:211], a[196:199], a[144:159]
    v_add_u32 v8, 0, v16
    v_add_u32 v9, 0, v17
    v_add_u32 v10, 0, v18
    v_add_u32 v11, 0, v19
    buffer_store_dwordx4 v[80:83], v12, s[68:71], s80 offen offset:3072 sc1
    v_mfma_f32_32x32x16_bf16 v[120:135], v[40:43], a[200:203], v[120:135]
    ds_read_b128 a[192:195], v4 offset:0
    ds_read_b64_tr_b16 v[24:25], v8 offset:0
    ds_read_b64_tr_b16 v[26:27], v8 offset:1024
    v_mfma_f32_32x32x16_bf16 v[136:151], v[44:47], a[200:203], v[136:151]
    ds_read_b128 a[196:199], v4 offset:4096
    ds_read_b64_tr_b16 v[28:29], v9 offset:0
    ds_read_b64_tr_b16 v[30:31], v9 offset:1024
    v_mfma_f32_32x32x16_bf16 v[152:167], v[48:51], a[200:203], v[152:167]
    ds_read_b64_tr_b16 v[32:33], v10 offset:0
    ds_read_b64_tr_b16 v[34:35], v10 offset:1024
    ds_read_b64_tr_b16 v[36:37], v11 offset:0
    v_mfma_f32_32x32x16_bf16 v[168:183], v[52:55], a[200:203], v[168:183]
    ds_read_b64_tr_b16 v[38:39], v11 offset:1024
    ds_read_b64_tr_b16 a[208:209], v250 offset:4096
    ds_read_b64_tr_b16 a[210:211], v250 offset:4224
    v_mfma_f32_32x32x16_bf16 v[184:199], v[40:43], a[204:207], v[184:199]
    s_add_u32 m0, s74, 98304
    s_mov_b32 s96, 384
    buffer_load_dwordx4 v248, s[36:39], s96 offen offset:0 lds
    s_add_u32 m0, s74, 98304
    s_mov_b32 s96, 7552
    buffer_load_dwordx4 v249, s[36:39], s96 offen offset:1024 lds
    v_mfma_f32_32x32x16_bf16 v[200:215], v[44:47], a[204:207], v[200:215]
    s_add_u32 m0, s74, 98304
    s_mov_b32 s96, 14720
    buffer_load_dwordx4 v248, s[36:39], s96 offen offset:2048 lds
    s_add_u32 m0, s74, 98304
    s_mov_b32 s96, 21888
    buffer_load_dwordx4 v249, s[36:39], s96 offen offset:3072 lds
    v_mfma_f32_32x32x16_bf16 v[216:231], v[48:51], a[204:207], v[216:231]
    buffer_store_dwordx4 v[84:87], v12, s[68:71], s81 offen offset:3072 sc1
    v_mfma_f32_32x32x16_bf16 v[232:247], v[52:55], a[204:207], v[232:247]
    v_mfma_f32_32x32x16_bf16 a[128:143], a[212:215], a[200:203], a[128:143]
    v_mfma_f32_32x32x16_bf16 a[144:159], a[212:215], a[204:207], a[144:159]
    s_waitcnt lgkmcnt(0)
    v_mfma_f32_32x32x16_bf16 v[120:135], v[24:27], a[192:195], v[120:135]
    ds_read_b128 a[200:203], v5 offset:0
    ds_read_b64_tr_b16 v[40:41], v8 offset:4096
    ds_read_b64_tr_b16 v[42:43], v8 offset:5120
    v_mfma_f32_32x32x16_bf16 v[136:151], v[28:31], a[192:195], v[136:151]
    ds_read_b128 a[204:207], v5 offset:4096
    ds_read_b64_tr_b16 v[44:45], v9 offset:4096
    ds_read_b64_tr_b16 v[46:47], v9 offset:5120
    v_mfma_f32_32x32x16_bf16 v[152:167], v[32:35], a[192:195], v[152:167]
    ds_read_b64_tr_b16 v[48:49], v10 offset:4096
    ds_read_b64_tr_b16 v[50:51], v10 offset:5120
    ds_read_b64_tr_b16 v[52:53], v11 offset:4096
    v_mfma_f32_32x32x16_bf16 v[168:183], v[36:39], a[192:195], v[168:183]
    ds_read_b64_tr_b16 v[54:55], v11 offset:5120
    ds_read_b64_tr_b16 a[212:213], v250 offset:4608
    ds_read_b64_tr_b16 a[214:215], v250 offset:4736
    v_mfma_f32_32x32x16_bf16 v[184:199], v[24:27], a[196:199], v[184:199]
    s_add_u32 m0, s74, 102400
    s_mov_b32 s96, 33152
    buffer_load_dwordx4 v248, s[36:39], s96 offen offset:0 lds
    s_add_u32 m0, s74, 102400
    s_mov_b32 s96, 40320
    buffer_load_dwordx4 v249, s[36:39], s96 offen offset:1024 lds
    v_mfma_f32_32x32x16_bf16 v[200:215], v[28:31], a[196:199], v[200:215]
    s_add_u32 m0, s74, 102400
    s_mov_b32 s96, 47488
    buffer_load_dwordx4 v248, s[36:39], s96 offen offset:2048 lds
    buffer_store_dwordx4 v[88:91], v12, s[68:71], s82 offen offset:0 sc1
    v_mfma_f32_32x32x16_bf16 v[216:231], v[32:35], a[196:199], v[216:231]
    buffer_store_dwordx4 v[92:95], v12, s[68:71], s83 offen offset:0 sc1
    buffer_store_dwordx4 v[96:99], v12, s[68:71], s82 offen offset:1024 sc1
    v_mfma_f32_32x32x16_bf16 v[232:247], v[36:39], a[196:199], v[232:247]
    v_mfma_f32_32x32x16_bf16 a[128:143], a[208:211], a[192:195], a[128:143]
    s_add_u32 m0, s74, 102400
    s_mov_b32 s96, 54656
    buffer_load_dwordx4 v249, s[36:39], s96 offen offset:3072 lds
    v_mfma_f32_32x32x16_bf16 a[144:159], a[208:211], a[196:199], a[144:159]
    buffer_store_dwordx4 v[100:103], v12, s[68:71], s83 offen offset:1024 sc1
    s_waitcnt lgkmcnt(0)
    v_mfma_f32_32x32x16_bf16 v[120:135], v[40:43], a[200:203], v[120:135]
    ds_read_b128 a[192:195], v6 offset:0
    ds_read_b64_tr_b16 v[24:25], v8 offset:8192
    ds_read_b64_tr_b16 v[26:27], v8 offset:9216
    v_mfma_f32_32x32x16_bf16 v[136:151], v[44:47], a[200:203], v[136:151]
    ds_read_b128 a[196:199], v6 offset:4096
    ds_read_b64_tr_b16 v[28:29], v9 offset:8192
    ds_read_b64_tr_b16 v[30:31], v9 offset:9216
    v_mfma_f32_32x32x16_bf16 v[152:167], v[48:51], a[200:203], v[152:167]
    ds_read_b64_tr_b16 v[32:33], v10 offset:8192
    ds_read_b64_tr_b16 v[34:35], v10 offset:9216
    ds_read_b64_tr_b16 v[36:37], v11 offset:8192
    v_mfma_f32_32x32x16_bf16 v[168:183], v[52:55], a[200:203], v[168:183]
    ds_read_b64_tr_b16 v[38:39], v11 offset:9216
    ds_read_b64_tr_b16 a[208:209], v250 offset:5120
    ds_read_b64_tr_b16 a[210:211], v250 offset:5248
    v_mfma_f32_32x32x16_bf16 v[184:199], v[40:43], a[204:207], v[184:199]
    s_lshl_b32 s96, s3, 10
    s_add_u32 m0, s96, 159744
    s_mul_i32 s96, s84, 3
    buffer_load_dwordx4 v251, s[40:43], s96 offen lds
    buffer_store_dwordx4 v[104:107], v12, s[68:71], s82 offen offset:2048 sc1
    v_mfma_f32_32x32x16_bf16 v[200:215], v[44:47], a[204:207], v[200:215]
    s_add_u32 m0, s75, 98304
    s_mov_b32 s96, 1572864
    buffer_load_dwordx4 v3, s[44:47], s96 offen offset:0 lds
    buffer_store_dwordx4 v[108:111], v12, s[68:71], s83 offen offset:2048 sc1
    v_mfma_f32_32x32x16_bf16 v[216:231], v[48:51], a[204:207], v[216:231]
    s_add_u32 m0, s75, 98304
    s_mov_b32 s96, 1604608
    buffer_load_dwordx4 v3, s[44:47], s96 offen offset:1024 lds
    v_mfma_f32_32x32x16_bf16 v[232:247], v[52:55], a[204:207], v[232:247]
    v_mfma_f32_32x32x16_bf16 a[128:143], a[212:215], a[200:203], a[128:143]
    s_add_u32 m0, s75, 98304
    s_mov_b32 s96, 1636352
    buffer_load_dwordx4 v3, s[44:47], s96 offen offset:2048 lds
    buffer_store_dwordx4 v[112:115], v12, s[68:71], s82 offen offset:3072 sc1
    v_mfma_f32_32x32x16_bf16 a[144:159], a[212:215], a[204:207], a[144:159]
    s_waitcnt lgkmcnt(0)
    v_mfma_f32_32x32x16_bf16 v[120:135], v[24:27], a[192:195], v[120:135]
    ds_read_b128 a[200:203], v7 offset:0
    ds_read_b64_tr_b16 v[40:41], v8 offset:12288
    ds_read_b64_tr_b16 v[42:43], v8 offset:13312
    v_mfma_f32_32x32x16_bf16 v[136:151], v[28:31], a[192:195], v[136:151]
    ds_read_b128 a[204:207], v7 offset:4096
    ds_read_b64_tr_b16 v[44:45], v9 offset:12288
    ds_read_b64_tr_b16 v[46:47], v9 offset:13312
    v_mfma_f32_32x32x16_bf16 v[152:167], v[32:35], a[192:195], v[152:167]
    ds_read_b64_tr_b16 v[48:49], v10 offset:12288
    ds_read_b64_tr_b16 v[50:51], v10 offset:13312
    ds_read_b64_tr_b16 v[52:53], v11 offset:12288
    v_mfma_f32_32x32x16_bf16 v[168:183], v[36:39], a[192:195], v[168:183]
    ds_read_b64_tr_b16 v[54:55], v11 offset:13312
    ds_read_b64_tr_b16 a[212:213], v250 offset:5632
    ds_read_b64_tr_b16 a[214:215], v250 offset:5760
    v_mfma_f32_32x32x16_bf16 v[184:199], v[24:27], a[196:199], v[184:199]
    s_add_u32 m0, s75, 98304
    s_mov_b32 s96, 1668096
    buffer_load_dwordx4 v3, s[44:47], s96 offen offset:3072 lds
    buffer_store_dwordx4 v[116:119], v12, s[68:71], s83 offen offset:3072 sc1
    v_mfma_f32_32x32x16_bf16 v[200:215], v[28:31], a[196:199], v[200:215]
    v_mfma_f32_32x32x16_bf16 v[216:231], v[32:35], a[196:199], v[216:231]
    v_mfma_f32_32x32x16_bf16 v[232:247], v[36:39], a[196:199], v[232:247]
    v_mfma_f32_32x32x16_bf16 a[128:143], a[208:211], a[192:195], a[128:143]
    s_waitcnt lgkmcnt(0)
    s_waitcnt vmcnt(25)
    s_barrier
    v_add_u32 v4, 49152, v14
    v_xor_b32 v5, 32, v4
    v_xor_b32 v6, 64, v4
    v_xor_b32 v7, 96, v4
    v_mfma_f32_32x32x16_bf16 a[144:159], a[208:211], a[196:199], a[144:159]
    v_add_u32 v8, 49152, v16
    v_add_u32 v9, 49152, v17
    v_add_u32 v10, 49152, v18
    v_add_u32 v11, 49152, v19
    v_mfma_f32_32x32x16_bf16 v[120:135], v[40:43], a[200:203], v[120:135]
    ds_read_b128 a[192:195], v4 offset:0
    ds_read_b64_tr_b16 v[24:25], v8 offset:0
    ds_read_b64_tr_b16 v[26:27], v8 offset:1024
    v_mfma_f32_32x32x16_bf16 v[136:151], v[44:47], a[200:203], v[136:151]
    ds_read_b128 a[196:199], v4 offset:4096
    ds_read_b64_tr_b16 v[28:29], v9 offset:0
    ds_read_b64_tr_b16 v[30:31], v9 offset:1024
    v_mfma_f32_32x32x16_bf16 v[152:167], v[48:51], a[200:203], v[152:167]
    ds_read_b64_tr_b16 v[32:33], v10 offset:0
    ds_read_b64_tr_b16 v[34:35], v10 offset:1024
    ds_read_b64_tr_b16 v[36:37], v11 offset:0
    v_mfma_f32_32x32x16_bf16 v[168:183], v[52:55], a[200:203], v[168:183]
    ds_read_b64_tr_b16 v[38:39], v11 offset:1024
    ds_read_b64_tr_b16 a[208:209], v250 offset:8192
    ds_read_b64_tr_b16 a[210:211], v250 offset:8320
    v_mfma_f32_32x32x16_bf16 v[184:199], v[40:43], a[204:207], v[184:199]
    s_add_u32 m0, s74, 0
    s_mov_b32 s96, 512
    buffer_load_dwordx4 v248, s[36:39], s96 offen offset:0 lds
    s_add_u32 m0, s74, 0
    s_mov_b32 s96, 7680
    buffer_load_dwordx4 v249, s[36:39], s96 offen offset:1024 lds
    v_mfma_f32_32x32x16_bf16 v[200:215], v[44:47], a[204:207], v[200:215]
    s_add_u32 m0, s74, 0
    s_mov_b32 s96, 14848
    buffer_load_dwordx4 v248, s[36:39], s96 offen offset:2048 lds
    s_add_u32 m0, s74, 0
    s_mov_b32 s96, 22016
    buffer_load_dwordx4 v249, s[36:39], s96 offen offset:3072 lds
    v_mfma_f32_32x32x16_bf16 v[216:231], v[48:51], a[204:207], v[216:231]
    v_mfma_f32_32x32x16_bf16 v[232:247], v[52:55], a[204:207], v[232:247]
    v_mfma_f32_32x32x16_bf16 a[128:143], a[212:215], a[200:203], a[128:143]
    v_mfma_f32_32x32x16_bf16 a[144:159], a[212:215], a[204:207], a[144:159]
    s_waitcnt lgkmcnt(0)
    v_mfma_f32_32x32x16_bf16 v[120:135], v[24:27], a[192:195], v[120:135]
    ds_read_b128 a[200:203], v5 offset:0
    ds_read_b64_tr_b16 v[40:41], v8 offset:4096
    ds_read_b64_tr_b16 v[42:43], v8 offset:5120
    v_mfma_f32_32x32x16_bf16 v[136:151], v[28:31], a[192:195], v[136:151]
    ds_read_b128 a[204:207], v5 offset:4096
    ds_read_b64_tr_b16 v[44:45], v9 offset:4096
    ds_read_b64_tr_b16 v[46:47], v9 offset:5120
    v_mfma_f32_32x32x16_bf16 v[152:167], v[32:35], a[192:195], v[152:167]
    ds_read_b64_tr_b16 v[48:49], v10 offset:4096
    ds_read_b64_tr_b16 v[50:51], v10 offset:5120
    ds_read_b64_tr_b16 v[52:53], v11 offset:4096
    v_mfma_f32_32x32x16_bf16 v[168:183], v[36:39], a[192:195], v[168:183]
    ds_read_b64_tr_b16 v[54:55], v11 offset:5120
    ds_read_b64_tr_b16 a[212:213], v250 offset:8704
    ds_read_b64_tr_b16 a[214:215], v250 offset:8832
    v_mfma_f32_32x32x16_bf16 v[184:199], v[24:27], a[196:199], v[184:199]
    s_add_u32 m0, s74, 4096
    s_mov_b32 s96, 33280
    buffer_load_dwordx4 v248, s[36:39], s96 offen offset:0 lds
    s_add_u32 m0, s74, 4096
    s_mov_b32 s96, 40448
    buffer_load_dwordx4 v249, s[36:39], s96 offen offset:1024 lds
    v_mfma_f32_32x32x16_bf16 v[200:215], v[28:31], a[196:199], v[200:215]
    s_add_u32 m0, s74, 4096
    s_mov_b32 s96, 47616
    buffer_load_dwordx4 v248, s[36:39], s96 offen offset:2048 lds
    v_accvgpr_write_b32 a0, 0
    v_accvgpr_write_b32 a1, 0
    v_accvgpr_write_b32 a2, 0
    v_mfma_f32_32x32x16_bf16 v[216:231], v[32:35], a[196:199], v[216:231]
    v_accvgpr_write_b32 a3, 0
    v_accvgpr_write_b32 a4, 0
    v_accvgpr_write_b32 a5, 0
    v_accvgpr_write_b32 a6, 0
    v_accvgpr_write_b32 a7, 0
    v_accvgpr_write_b32 a8, 0
    v_mfma_f32_32x32x16_bf16 v[232:247], v[36:39], a[196:199], v[232:247]
    v_accvgpr_write_b32 a9, 0
    v_accvgpr_write_b32 a10, 0
    v_accvgpr_write_b32 a11, 0
    v_accvgpr_write_b32 a12, 0
    v_accvgpr_write_b32 a13, 0
    v_accvgpr_write_b32 a14, 0
    v_mfma_f32_32x32x16_bf16 a[128:143], a[208:211], a[192:195], a[128:143]
    s_add_u32 m0, s74, 4096
    s_mov_b32 s96, 54784
    buffer_load_dwordx4 v249, s[36:39], s96 offen offset:3072 lds
    v_accvgpr_write_b32 a15, 0
    v_accvgpr_write_b32 a16, 0
    v_accvgpr_write_b32 a17, 0
    v_mfma_f32_32x32x16_bf16 a[144:159], a[208:211], a[196:199], a[144:159]
    v_accvgpr_write_b32 a18, 0
    v_accvgpr_write_b32 a19, 0
    v_accvgpr_write_b32 a20, 0
    v_accvgpr_write_b32 a21, 0
    v_accvgpr_write_b32 a22, 0
    v_accvgpr_write_b32 a23, 0
    s_waitcnt lgkmcnt(0)
    v_mfma_f32_32x32x16_bf16 v[120:135], v[40:43], a[200:203], v[120:135]
    ds_read_b128 a[192:195], v6 offset:0
    ds_read_b64_tr_b16 v[24:25], v8 offset:8192
    ds_read_b64_tr_b16 v[26:27], v8 offset:9216
    v_mfma_f32_32x32x16_bf16 v[136:151], v[44:47], a[200:203], v[136:151]
    ds_read_b128 a[196:199], v6 offset:4096
    ds_read_b64_tr_b16 v[28:29], v9 offset:8192
    ds_read_b64_tr_b16 v[30:31], v9 offset:9216
    v_mfma_f32_32x32x16_bf16 v[152:167], v[48:51], a[200:203], v[152:167]
    ds_read_b64_tr_b16 v[32:33], v10 offset:8192
    ds_read_b64_tr_b16 v[34:35], v10 offset:9216
    ds_read_b64_tr_b16 v[36:37], v11 offset:8192
    v_mfma_f32_32x32x16_bf16 v[168:183], v[52:55], a[200:203], v[168:183]
    ds_read_b64_tr_b16 v[38:39], v11 offset:9216
    ds_read_b64_tr_b16 a[208:209], v250 offset:9216
    ds_read_b64_tr_b16 a[210:211], v250 offset:9344
    v_mfma_f32_32x32x16_bf16 v[184:199], v[40:43], a[204:207], v[184:199]
    s_lshl_b32 s96, s3, 10
    s_add_u32 m0, s96, 147456
    s_mul_i32 s96, s84, 4
    buffer_load_dwordx4 v251, s[40:43], s96 offen lds
    v_accvgpr_write_b32 a24, 0
    v_accvgpr_write_b32 a25, 0
    v_mfma_f32_32x32x16_bf16 v[200:215], v[44:47], a[204:207], v[200:215]
    s_add_u32 m0, s75, 0
    s_mov_b32 s96, 2097152
    buffer_load_dwordx4 v3, s[44:47], s96 offen offset:0 lds
    v_accvgpr_write_b32 a26, 0
    v_accvgpr_write_b32 a27, 0
    v_accvgpr_write_b32 a28, 0
    v_mfma_f32_32x32x16_bf16 v[216:231], v[48:51], a[204:207], v[216:231]
    s_add_u32 m0, s75, 0
    s_mov_b32 s96, 2128896
    buffer_load_dwordx4 v3, s[44:47], s96 offen offset:1024 lds
    v_accvgpr_write_b32 a29, 0
    v_accvgpr_write_b32 a30, 0
    v_accvgpr_write_b32 a31, 0
    v_mfma_f32_32x32x16_bf16 v[232:247], v[52:55], a[204:207], v[232:247]
    v_accvgpr_write_b32 a32, 0
    v_accvgpr_write_b32 a33, 0
    v_accvgpr_write_b32 a34, 0
    v_accvgpr_write_b32 a35, 0
    v_accvgpr_write_b32 a36, 0
    v_accvgpr_write_b32 a37, 0
    v_mfma_f32_32x32x16_bf16 a[128:143], a[212:215], a[200:203], a[128:143]
    s_add_u32 m0, s75, 0
    s_mov_b32 s96, 2160640
    buffer_load_dwordx4 v3, s[44:47], s96 offen offset:2048 lds
    v_accvgpr_write_b32 a38, 0
    v_accvgpr_write_b32 a39, 0
    v_accvgpr_write_b32 a40, 0
    v_mfma_f32_32x32x16_bf16 a[144:159], a[212:215], a[204:207], a[144:159]
    v_accvgpr_write_b32 a41, 0
    v_accvgpr_write_b32 a42, 0
    v_accvgpr_write_b32 a43, 0
    v_accvgpr_write_b32 a44, 0
    v_accvgpr_write_b32 a45, 0
    v_accvgpr_write_b32 a46, 0
    s_waitcnt lgkmcnt(0)
    v_mfma_f32_32x32x16_bf16 v[120:135], v[24:27], a[192:195], v[120:135]
    ds_read_b128 a[200:203], v7 offset:0
    ds_read_b64_tr_b16 v[40:41], v8 offset:12288
    ds_read_b64_tr_b16 v[42:43], v8 offset:13312
    v_mfma_f32_32x32x16_bf16 v[136:151], v[28:31], a[192:195], v[136:151]
    ds_read_b128 a[204:207], v7 offset:4096
    ds_read_b64_tr_b16 v[44:45], v9 offset:12288
    ds_read_b64_tr_b16 v[46:47], v9 offset:13312
    v_mfma_f32_32x32x16_bf16 v[152:167], v[32:35], a[192:195], v[152:167]
    ds_read_b64_tr_b16 v[48:49], v10 offset:12288
    ds_read_b64_tr_b16 v[50:51], v10 offset:13312
    ds_read_b64_tr_b16 v[52:53], v11 offset:12288
    v_mfma_f32_32x32x16_bf16 v[168:183], v[36:39], a[192:195], v[168:183]
    ds_read_b64_tr_b16 v[54:55], v11 offset:13312
    ds_read_b64_tr_b16 a[212:213], v250 offset:9728
    ds_read_b64_tr_b16 a[214:215], v250 offset:9856
    v_mfma_f32_32x32x16_bf16 v[184:199], v[24:27], a[196:199], v[184:199]
    s_add_u32 m0, s75, 0
    s_mov_b32 s96, 2192384
    buffer_load_dwordx4 v3, s[44:47], s96 offen offset:3072 lds
    v_accvgpr_write_b32 a47, 0
    v_accvgpr_write_b32 a48, 0
    v_accvgpr_write_b32 a49, 0
    v_mfma_f32_32x32x16_bf16 v[200:215], v[28:31], a[196:199], v[200:215]
    v_accvgpr_write_b32 a50, 0
    v_accvgpr_write_b32 a51, 0
    v_accvgpr_write_b32 a52, 0
    v_accvgpr_write_b32 a53, 0
    v_accvgpr_write_b32 a54, 0
    v_accvgpr_write_b32 a55, 0
    v_mfma_f32_32x32x16_bf16 v[216:231], v[32:35], a[196:199], v[216:231]
    v_accvgpr_write_b32 a56, 0
    v_accvgpr_write_b32 a57, 0
    v_accvgpr_write_b32 a58, 0
    v_accvgpr_write_b32 a59, 0
    v_accvgpr_write_b32 a60, 0
    v_accvgpr_write_b32 a61, 0
    v_mfma_f32_32x32x16_bf16 v[232:247], v[36:39], a[196:199], v[232:247]
    v_accvgpr_write_b32 a62, 0
    v_accvgpr_write_b32 a63, 0
    v_mfma_f32_32x32x16_bf16 a[128:143], a[208:211], a[192:195], a[128:143]
    s_waitcnt lgkmcnt(0)
    s_waitcnt vmcnt(14)
    s_barrier
    v_add_u32 v4, 98304, v14
    v_xor_b32 v5, 32, v4
    v_xor_b32 v6, 64, v4
    v_xor_b32 v7, 96, v4
    v_mfma_f32_32x32x16_bf16 a[144:159], a[208:211], a[196:199], a[144:159]
    v_add_u32 v8, 98304, v16
    v_add_u32 v9, 98304, v17
    v_add_u32 v10, 98304, v18
    v_add_u32 v11, 98304, v19
    v_mfma_f32_32x32x16_bf16 v[120:135], v[40:43], a[200:203], v[120:135]
    ds_read_b128 a[192:195], v4 offset:0
    ds_read_b64_tr_b16 v[24:25], v8 offset:0
    ds_read_b64_tr_b16 v[26:27], v8 offset:1024
    v_mfma_f32_32x32x16_bf16 v[136:151], v[44:47], a[200:203], v[136:151]
    ds_read_b128 a[196:199], v4 offset:4096
    ds_read_b64_tr_b16 v[28:29], v9 offset:0
    ds_read_b64_tr_b16 v[30:31], v9 offset:1024
    v_mfma_f32_32x32x16_bf16 v[152:167], v[48:51], a[200:203], v[152:167]
    ds_read_b64_tr_b16 v[32:33], v10 offset:0
    ds_read_b64_tr_b16 v[34:35], v10 offset:1024
    ds_read_b64_tr_b16 v[36:37], v11 offset:0
    v_mfma_f32_32x32x16_bf16 v[168:183], v[52:55], a[200:203], v[168:183]
    ds_read_b64_tr_b16 v[38:39], v11 offset:1024
    ds_read_b64_tr_b16 a[208:209], v250 offset:12288
    ds_read_b64_tr_b16 a[210:211], v250 offset:12416
    v_mfma_f32_32x32x16_bf16 v[184:199], v[40:43], a[204:207], v[184:199]
    s_add_u32 m0, s74, 49152
    s_mov_b32 s96, 640
    buffer_load_dwordx4 v248, s[36:39], s96 offen offset:0 lds
    s_add_u32 m0, s74, 49152
    s_mov_b32 s96, 7808
    buffer_load_dwordx4 v249, s[36:39], s96 offen offset:1024 lds
    v_mfma_f32_32x32x16_bf16 v[200:215], v[44:47], a[204:207], v[200:215]
    s_add_u32 m0, s74, 49152
    s_mov_b32 s96, 14976
    buffer_load_dwordx4 v248, s[36:39], s96 offen offset:2048 lds
    s_add_u32 m0, s74, 49152
    s_mov_b32 s96, 22144
    buffer_load_dwordx4 v249, s[36:39], s96 offen offset:3072 lds
    v_mfma_f32_32x32x16_bf16 v[216:231], v[48:51], a[204:207], v[216:231]
    v_mfma_f32_32x32x16_bf16 v[232:247], v[52:55], a[204:207], v[232:247]
    v_mfma_f32_32x32x16_bf16 a[128:143], a[212:215], a[200:203], a[128:143]
    v_mfma_f32_32x32x16_bf16 a[144:159], a[212:215], a[204:207], a[144:159]
    s_waitcnt lgkmcnt(0)
    v_mfma_f32_32x32x16_bf16 v[120:135], v[24:27], a[192:195], v[120:135]
    ds_read_b128 a[200:203], v5 offset:0
    ds_read_b64_tr_b16 v[40:41], v8 offset:4096
    ds_read_b64_tr_b16 v[42:43], v8 offset:5120
    v_mfma_f32_32x32x16_bf16 v[136:151], v[28:31], a[192:195], v[136:151]
    ds_read_b128 a[204:207], v5 offset:4096
    ds_read_b64_tr_b16 v[44:45], v9 offset:4096
    ds_read_b64_tr_b16 v[46:47], v9 offset:5120
    v_mfma_f32_32x32x16_bf16 v[152:167], v[32:35], a[192:195], v[152:167]
    ds_read_b64_tr_b16 v[48:49], v10 offset:4096
    ds_read_b64_tr_b16 v[50:51], v10 offset:5120
    ds_read_b64_tr_b16 v[52:53], v11 offset:4096
    v_mfma_f32_32x32x16_bf16 v[168:183], v[36:39], a[192:195], v[168:183]
    ds_read_b64_tr_b16 v[54:55], v11 offset:5120
    ds_read_b64_tr_b16 a[212:213], v250 offset:12800
    ds_read_b64_tr_b16 a[214:215], v250 offset:12928
    v_mfma_f32_32x32x16_bf16 v[184:199], v[24:27], a[196:199], v[184:199]
    s_add_u32 m0, s74, 53248
    s_mov_b32 s96, 33408
    buffer_load_dwordx4 v248, s[36:39], s96 offen offset:0 lds
    s_add_u32 m0, s74, 53248
    s_mov_b32 s96, 40576
    buffer_load_dwordx4 v249, s[36:39], s96 offen offset:1024 lds
    v_mfma_f32_32x32x16_bf16 v[200:215], v[28:31], a[196:199], v[200:215]
    s_add_u32 m0, s74, 53248
    s_mov_b32 s96, 47744
    buffer_load_dwordx4 v248, s[36:39], s96 offen offset:2048 lds
    v_mfma_f32_32x32x16_bf16 v[216:231], v[32:35], a[196:199], v[216:231]
    v_mfma_f32_32x32x16_bf16 v[232:247], v[36:39], a[196:199], v[232:247]
    v_mfma_f32_32x32x16_bf16 a[128:143], a[208:211], a[192:195], a[128:143]
    s_add_u32 m0, s74, 53248
    s_mov_b32 s96, 54912
    buffer_load_dwordx4 v249, s[36:39], s96 offen offset:3072 lds
    v_mfma_f32_32x32x16_bf16 a[144:159], a[208:211], a[196:199], a[144:159]
    s_waitcnt lgkmcnt(0)
    v_mfma_f32_32x32x16_bf16 v[120:135], v[40:43], a[200:203], v[120:135]
    ds_read_b128 a[192:195], v6 offset:0
    ds_read_b64_tr_b16 v[24:25], v8 offset:8192
    ds_read_b64_tr_b16 v[26:27], v8 offset:9216
    v_mfma_f32_32x32x16_bf16 v[136:151], v[44:47], a[200:203], v[136:151]
    ds_read_b128 a[196:199], v6 offset:4096
    ds_read_b64_tr_b16 v[28:29], v9 offset:8192
    ds_read_b64_tr_b16 v[30:31], v9 offset:9216
    v_mfma_f32_32x32x16_bf16 v[152:167], v[48:51], a[200:203], v[152:167]
    ds_read_b64_tr_b16 v[32:33], v10 offset:8192
    ds_read_b64_tr_b16 v[34:35], v10 offset:9216
    ds_read_b64_tr_b16 v[36:37], v11 offset:8192
    v_mfma_f32_32x32x16_bf16 v[168:183], v[52:55], a[200:203], v[168:183]
    ds_read_b64_tr_b16 v[38:39], v11 offset:9216
    ds_read_b64_tr_b16 a[208:209], v250 offset:13312
    ds_read_b64_tr_b16 a[210:211], v250 offset:13440
    v_mfma_f32_32x32x16_bf16 v[184:199], v[40:43], a[204:207], v[184:199]
    s_lshl_b32 s96, s3, 10
    s_add_u32 m0, s96, 151552
    s_mul_i32 s96, s84, 5
    buffer_load_dwordx4 v251, s[40:43], s96 offen lds
    v_mfma_f32_32x32x16_bf16 v[200:215], v[44:47], a[204:207], v[200:215]
    s_add_u32 m0, s75, 49152
    s_mov_b32 s96, 2621440
    buffer_load_dwordx4 v3, s[44:47], s96 offen offset:0 lds
    v_mfma_f32_32x32x16_bf16 v[216:231], v[48:51], a[204:207], v[216:231]
    s_add_u32 m0, s75, 49152
    s_mov_b32 s96, 2653184
    buffer_load_dwordx4 v3, s[44:47], s96 offen offset:1024 lds
    v_mfma_f32_32x32x16_bf16 v[232:247], v[52:55], a[204:207], v[232:247]
    v_mfma_f32_32x32x16_bf16 a[128:143], a[212:215], a[200:203], a[128:143]
    s_add_u32 m0, s75, 49152
    s_mov_b32 s96, 2684928
    buffer_load_dwordx4 v3, s[44:47], s96 offen offset:2048 lds
    v_mfma_f32_32x32x16_bf16 a[144:159], a[212:215], a[204:207], a[144:159]
    s_waitcnt lgkmcnt(0)
    v_mfma_f32_32x32x16_bf16 v[120:135], v[24:27], a[192:195], v[120:135]
    ds_read_b128 a[200:203], v7 offset:0
    ds_read_b64_tr_b16 v[40:41], v8 offset:12288
    ds_read_b64_tr_b16 v[42:43], v8 offset:13312
    v_mfma_f32_32x32x16_bf16 v[136:151], v[28:31], a[192:195], v[136:151]
    ds_read_b128 a[204:207], v7 offset:4096
    ds_read_b64_tr_b16 v[44:45], v9 offset:12288
    ds_read_b64_tr_b16 v[46:47], v9 offset:13312
    v_mfma_f32_32x32x16_bf16 v[152:167], v[32:35], a[192:195], v[152:167]
    ds_read_b64_tr_b16 v[48:49], v10 offset:12288
    ds_read_b64_tr_b16 v[50:51], v10 offset:13312
    ds_read_b64_tr_b16 v[52:53], v11 offset:12288
    v_mfma_f32_32x32x16_bf16 v[168:183], v[36:39], a[192:195], v[168:183]
    ds_read_b64_tr_b16 v[54:55], v11 offset:13312
    ds_read_b64_tr_b16 a[212:213], v250 offset:13824
    ds_read_b64_tr_b16 a[214:215], v250 offset:13952
    v_mfma_f32_32x32x16_bf16 v[184:199], v[24:27], a[196:199], v[184:199]
    s_add_u32 m0, s75, 49152
    s_mov_b32 s96, 2716672
    buffer_load_dwordx4 v3, s[44:47], s96 offen offset:3072 lds
    v_mfma_f32_32x32x16_bf16 v[200:215], v[28:31], a[196:199], v[200:215]
    v_mfma_f32_32x32x16_bf16 v[216:231], v[32:35], a[196:199], v[216:231]
    v_mfma_f32_32x32x16_bf16 v[232:247], v[36:39], a[196:199], v[232:247]
    v_mfma_f32_32x32x16_bf16 a[128:143], a[208:211], a[192:195], a[128:143]
    s_waitcnt lgkmcnt(0)
    s_waitcnt vmcnt(13)
    s_barrier
    v_add_u32 v4, 0, v14
    v_xor_b32 v5, 32, v4
    v_xor_b32 v6, 64, v4
    v_xor_b32 v7, 96, v4
    v_mfma_f32_32x32x16_bf16 a[144:159], a[208:211], a[196:199], a[144:159]
    v_add_u32 v8, 0, v16
    v_add_u32 v9, 0, v17
    v_add_u32 v10, 0, v18
    v_add_u32 v11, 0, v19
    s_cmp_lg_u32 s3, 0
    s_cbranch_scc1 A_NOSIG
    s_lshl_b32 s98, s4, 2
    v_mov_b32 v252, s98
    v_mov_b32 v253, 1
    s_mov_b64 exec, 1
    global_atomic_add v252, v253, s[72:73]
    s_mov_b64 exec, -1
A_NOSIG:
    v_mfma_f32_32x32x16_bf16 v[120:135], v[40:43], a[200:203], v[120:135]
    ds_read_b128 a[192:195], v4 offset:0
    ds_read_b64_tr_b16 v[24:25], v8 offset:0
    ds_read_b64_tr_b16 v[26:27], v8 offset:1024
    v_mfma_f32_32x32x16_bf16 v[136:151], v[44:47], a[200:203], v[136:151]
    ds_read_b128 a[196:199], v4 offset:4096
    ds_read_b64_tr_b16 v[28:29], v9 offset:0
    ds_read_b64_tr_b16 v[30:31], v9 offset:1024
    v_mfma_f32_32x32x16_bf16 v[152:167], v[48:51], a[200:203], v[152:167]
    ds_read_b64_tr_b16 v[32:33], v10 offset:0
    ds_read_b64_tr_b16 v[34:35], v10 offset:1024
    ds_read_b64_tr_b16 v[36:37], v11 offset:0
    v_mfma_f32_32x32x16_bf16 v[168:183], v[52:55], a[200:203], v[168:183]
    ds_read_b64_tr_b16 v[38:39], v11 offset:1024
    ds_read_b64_tr_b16 a[208:209], v250 offset:0
    ds_read_b64_tr_b16 a[210:211], v250 offset:128
    v_mfma_f32_32x32x16_bf16 v[184:199], v[40:43], a[204:207], v[184:199]
    s_add_u32 m0, s74, 98304
    s_mov_b32 s96, 768
    buffer_load_dwordx4 v248, s[36:39], s96 offen offset:0 lds
    s_add_u32 m0, s74, 98304
    s_mov_b32 s96, 7936
    buffer_load_dwordx4 v249, s[36:39], s96 offen offset:1024 lds
    v_mfma_f32_32x32x16_bf16 v[200:215], v[44:47], a[204:207], v[200:215]
    s_add_u32 m0, s74, 98304
    s_mov_b32 s96, 15104
    buffer_load_dwordx4 v248, s[36:39], s96 offen offset:2048 lds
    s_add_u32 m0, s74, 98304
    s_mov_b32 s96, 22272
    buffer_load_dwordx4 v249, s[36:39], s96 offen offset:3072 lds
    v_mfma_f32_32x32x16_bf16 v[216:231], v[48:51], a[204:207], v[216:231]
    v_mfma_f32_32x32x16_bf16 v[232:247], v[52:55], a[204:207], v[232:247]
    v_mfma_f32_32x32x16_bf16 a[128:143], a[212:215], a[200:203], a[128:143]
    v_mfma_f32_32x32x16_bf16 a[144:159], a[212:215], a[204:207], a[144:159]
    s_waitcnt lgkmcnt(0)
    v_mfma_f32_32x32x16_bf16 v[120:135], v[24:27], a[192:195], v[120:135]
    ds_read_b128 a[200:203], v5 offset:0
    ds_read_b64_tr_b16 v[40:41], v8 offset:4096
    ds_read_b64_tr_b16 v[42:43], v8 offset:5120
    v_mfma_f32_32x32x16_bf16 v[136:151], v[28:31], a[192:195], v[136:151]
    ds_read_b128 a[204:207], v5 offset:4096
    ds_read_b64_tr_b16 v[44:45], v9 offset:4096
    ds_read_b64_tr_b16 v[46:47], v9 offset:5120
    v_mfma_f32_32x32x16_bf16 v[152:167], v[32:35], a[192:195], v[152:167]
    ds_read_b64_tr_b16 v[48:49], v10 offset:4096
    ds_read_b64_tr_b16 v[50:51], v10 offset:5120
    ds_read_b64_tr_b16 v[52:53], v11 offset:4096
    v_mfma_f32_32x32x16_bf16 v[168:183], v[36:39], a[192:195], v[168:183]
    ds_read_b64_tr_b16 v[54:55], v11 offset:5120
    ds_read_b64_tr_b16 a[212:213], v250 offset:512
    ds_read_b64_tr_b16 a[214:215], v250 offset:640
    v_mfma_f32_32x32x16_bf16 v[184:199], v[24:27], a[196:199], v[184:199]
    s_add_u32 m0, s74, 102400
    s_mov_b32 s96, 33536
    buffer_load_dwordx4 v248, s[36:39], s96 offen offset:0 lds
    s_add_u32 m0, s74, 102400
    s_mov_b32 s96, 40704
    buffer_load_dwordx4 v249, s[36:39], s96 offen offset:1024 lds
    v_mfma_f32_32x32x16_bf16 v[200:215], v[28:31], a[196:199], v[200:215]
    s_add_u32 m0, s74, 102400
    s_mov_b32 s96, 47872
    buffer_load_dwordx4 v248, s[36:39], s96 offen offset:2048 lds
    v_accvgpr_write_b32 a64, 0
    v_accvgpr_write_b32 a65, 0
    v_accvgpr_write_b32 a66, 0
    v_mfma_f32_32x32x16_bf16 v[216:231], v[32:35], a[196:199], v[216:231]
    v_accvgpr_write_b32 a67, 0
    v_accvgpr_write_b32 a68, 0
    v_accvgpr_write_b32 a69, 0
    v_accvgpr_write_b32 a70, 0
    v_accvgpr_write_b32 a71, 0
    v_accvgpr_write_b32 a72, 0
    v_mfma_f32_32x32x16_bf16 v[232:247], v[36:39], a[196:199], v[232:247]
    v_accvgpr_write_b32 a73, 0
    v_accvgpr_write_b32 a74, 0
    v_accvgpr_write_b32 a75, 0
    v_accvgpr_write_b32 a76, 0
    v_accvgpr_write_b32 a77, 0
    v_accvgpr_write_b32 a78, 0
    v_mfma_f32_32x32x16_bf16 a[128:143], a[208:211], a[192:195], a[128:143]
    s_add_u32 m0, s74, 102400
    s_mov_b32 s96, 55040
    buffer_load_dwordx4 v249, s[36:39], s96 offen offset:3072 lds
    v_accvgpr_write_b32 a79, 0
    v_accvgpr_write_b32 a80, 0
    v_accvgpr_write_b32 a81, 0
    v_mfma_f32_32x32x16_bf16 a[144:159], a[208:211], a[196:199], a[144:159]
    v_accvgpr_write_b32 a82, 0
    v_accvgpr_write_b32 a83, 0
    v_accvgpr_write_b32 a84, 0
    v_accvgpr_write_b32 a85, 0
    v_accvgpr_write_b32 a86, 0
    v_accvgpr_write_b32 a87, 0
    s_waitcnt lgkmcnt(0)
    v_mfma_f32_32x32x16_bf16 v[120:135], v[40:43], a[200:203], v[120:135]
    ds_read_b128 a[192:195], v6 offset:0
    ds_read_b64_tr_b16 v[24:25], v8 offset:8192
    ds_read_b64_tr_b16 v[26:27], v8 offset:9216
    v_mfma_f32_32x32x16_bf16 v[136:151], v[44:47], a[200:203], v[136:151]
    ds_read_b128 a[196:199], v6 offset:4096
    ds_read_b64_tr_b16 v[28:29], v9 offset:8192
    ds_read_b64_tr_b16 v[30:31], v9 offset:9216
    v_mfma_f32_32x32x16_bf16 v[152:167], v[48:51], a[200:203], v[152:167]
    ds_read_b64_tr_b16 v[32:33], v10 offset:8192
    ds_read_b64_tr_b16 v[34:35], v10 offset:9216
    ds_read_b64_tr_b16 v[36:37], v11 offset:8192
    v_mfma_f32_32x32x16_bf16 v[168:183], v[52:55], a[200:203], v[168:183]
    ds_read_b64_tr_b16 v[38:39], v11 offset:9216
    ds_read_b64_tr_b16 a[208:209], v250 offset:1024
    ds_read_b64_tr_b16 a[210:211], v250 offset:1152
    v_mfma_f32_32x32x16_bf16 v[184:199], v[40:43], a[204:207], v[184:199]
    s_lshl_b32 s96, s3, 10
    s_add_u32 m0, s96, 155648
    s_mul_i32 s96, s84, 6
    buffer_load_dwordx4 v251, s[40:43], s96 offen lds
    v_accvgpr_write_b32 a88, 0
    v_accvgpr_write_b32 a89, 0
    v_mfma_f32_32x32x16_bf16 v[200:215], v[44:47], a[204:207], v[200:215]
    s_add_u32 m0, s75, 98304
    s_mov_b32 s96, 3145728
    buffer_load_dwordx4 v3, s[44:47], s96 offen offset:0 lds
    v_accvgpr_write_b32 a90, 0
    v_accvgpr_write_b32 a91, 0
    v_accvgpr_write_b32 a92, 0
    v_mfma_f32_32x32x16_bf16 v[216:231], v[48:51], a[204:207], v[216:231]
    s_add_u32 m0, s75, 98304
    s_mov_b32 s96, 3177472
    buffer_load_dwordx4 v3, s[44:47], s96 offen offset:1024 lds
    v_accvgpr_write_b32 a93, 0
    v_accvgpr_write_b32 a94, 0
    v_accvgpr_write_b32 a95, 0
    v_mfma_f32_32x32x16_bf16 v[232:247], v[52:55], a[204:207], v[232:247]
    v_accvgpr_write_b32 a96, 0
    v_accvgpr_write_b32 a97, 0
    v_accvgpr_write_b32 a98, 0
    v_accvgpr_write_b32 a99, 0
    v_accvgpr_write_b32 a100, 0
    v_accvgpr_write_b32 a101, 0
    v_mfma_f32_32x32x16_bf16 a[128:143], a[212:215], a[200:203], a[128:143]
    s_add_u32 m0, s75, 98304
    s_mov_b32 s96, 3209216
    buffer_load_dwordx4 v3, s[44:47], s96 offen offset:2048 lds
    v_accvgpr_write_b32 a102, 0
    v_accvgpr_write_b32 a103, 0
    v_accvgpr_write_b32 a104, 0
    v_mfma_f32_32x32x16_bf16 a[144:159], a[212:215], a[204:207], a[144:159]
    v_accvgpr_write_b32 a105, 0
    v_accvgpr_write_b32 a106, 0
    v_accvgpr_write_b32 a107, 0
    v_accvgpr_write_b32 a108, 0
    v_accvgpr_write_b32 a109, 0
    v_accvgpr_write_b32 a110, 0
    s_waitcnt lgkmcnt(0)
    v_mfma_f32_32x32x16_bf16 v[120:135], v[24:27], a[192:195], v[120:135]
    ds_read_b128 a[200:203], v7 offset:0
    ds_read_b64_tr_b16 v[40:41], v8 offset:12288
    ds_read_b64_tr_b16 v[42:43], v8 offset:13312
    v_mfma_f32_32x32x16_bf16 v[136:151], v[28:31], a[192:195], v[136:151]
    ds_read_b128 a[204:207], v7 offset:4096
    ds_read_b64_tr_b16 v[44:45], v9 offset:12288
    ds_read_b64_tr_b16 v[46:47], v9 offset:13312
    v_mfma_f32_32x32x16_bf16 v[152:167], v[32:35], a[192:195], v[152:167]
    ds_read_b64_tr_b16 v[48:49], v10 offset:12288
    ds_read_b64_tr_b16 v[50:51], v10 offset:13312
    ds_read_b64_tr_b16 v[52:53], v11 offset:12288
    v_mfma_f32_32x32x16_bf16 v[168:183], v[36:39], a[192:195], v[168:183]
    ds_read_b64_tr_b16 v[54:55], v11 offset:13312
    ds_read_b64_tr_b16 a[212:213], v250 offset:1536
    ds_read_b64_tr_b16 a[214:215], v250 offset:1664
    v_mfma_f32_32x32x16_bf16 v[184:199], v[24:27], a[196:199], v[184:199]
    s_add_u32 m0, s75, 98304
    s_mov_b32 s96, 3240960
    buffer_load_dwordx4 v3, s[44:47], s96 offen offset:3072 lds
    v_accvgpr_write_b32 a111, 0
    v_accvgpr_write_b32 a112, 0
    v_accvgpr_write_b32 a113, 0
    v_mfma_f32_32x32x16_bf16 v[200:215], v[28:31], a[196:199], v[200:215]
    v_accvgpr_write_b32 a114, 0
    v_accvgpr_write_b32 a115, 0
    v_accvgpr_write_b32 a116, 0
    v_accvgpr_write_b32 a117, 0
    v_accvgpr_write_b32 a118, 0
    v_accvgpr_write_b32 a119, 0
    v_mfma_f32_32x32x16_bf16 v[216:231], v[32:35], a[196:199], v[216:231]
    v_accvgpr_write_b32 a120, 0
    v_accvgpr_write_b32 a121, 0
    v_accvgpr_write_b32 a122, 0
    v_accvgpr_write_b32 a123, 0
    v_accvgpr_write_b32 a124, 0
    v_accvgpr_write_b32 a125, 0
    v_mfma_f32_32x32x16_bf16 v[232:247], v[36:39], a[196:199], v[232:247]
    v_accvgpr_write_b32 a126, 0
    v_accvgpr_write_b32 a127, 0
    v_accvgpr_write_b32 a216, 0
    v_accvgpr_write_b32 a217, 0
    v_accvgpr_write_b32 a218, 0
    v_accvgpr_write_b32 a219, 0
    v_mfma_f32_32x32x16_bf16 a[128:143], a[208:211], a[192:195], a[128:143]
    s_waitcnt lgkmcnt(0)
    s_waitcnt vmcnt(13)
    s_barrier
    v_add_u32 v4, 49152, v14
    v_xor_b32 v5, 32, v4
    v_xor_b32 v6, 64, v4
    v_xor_b32 v7, 96, v4
    v_mfma_f32_32x32x16_bf16 a[144:159], a[208:211], a[196:199], a[144:159]
    v_add_u32 v8, 49152, v16
    v_add_u32 v9, 49152, v17
    v_add_u32 v10, 49152, v18
    v_add_u32 v11, 49152, v19
    v_accvgpr_write_b32 a220, 0
    v_accvgpr_write_b32 a221, 0
    v_mfma_f32_32x32x16_bf16 v[120:135], v[40:43], a[200:203], v[120:135]
    ds_read_b128 a[192:195], v4 offset:0
    ds_read_b64_tr_b16 v[24:25], v8 offset:0
    ds_read_b64_tr_b16 v[26:27], v8 offset:1024
    v_mfma_f32_32x32x16_bf16 v[136:151], v[44:47], a[200:203], v[136:151]
    ds_read_b128 a[196:199], v4 offset:4096
    ds_read_b64_tr_b16 v[28:29], v9 offset:0
    ds_read_b64_tr_b16 v[30:31], v9 offset:1024
    v_mfma_f32_32x32x16_bf16 v[152:167], v[48:51], a[200:203], v[152:167]
    ds_read_b64_tr_b16 v[32:33], v10 offset:0
    ds_read_b64_tr_b16 v[34:35], v10 offset:1024
    ds_read_b64_tr_b16 v[36:37], v11 offset:0
    v_mfma_f32_32x32x16_bf16 v[168:183], v[52:55], a[200:203], v[168:183]
    ds_read_b64_tr_b16 v[38:39], v11 offset:1024
    ds_read_b64_tr_b16 a[208:209], v250 offset:4096
    ds_read_b64_tr_b16 a[210:211], v250 offset:4224
    v_mfma_f32_32x32x16_bf16 v[184:199], v[40:43], a[204:207], v[184:199]
    s_add_u32 m0, s74, 0
    s_mov_b32 s96, 896
    buffer_load_dwordx4 v248, s[36:39], s96 offen offset:0 lds
    s_add_u32 m0, s74, 0
    s_mov_b32 s96, 8064
    buffer_load_dwordx4 v249, s[36:39], s96 offen offset:1024 lds
    v_mfma_f32_32x32x16_bf16 v[200:215], v[44:47], a[204:207], v[200:215]
    s_add_u32 m0, s74, 0
    s_mov_b32 s96, 15232
    buffer_load_dwordx4 v248, s[36:39], s96 offen offset:2048 lds
    s_add_u32 m0, s74, 0
    s_mov_b32 s96, 22400
    buffer_load_dwordx4 v249, s[36:39], s96 offen offset:3072 lds
    v_mfma_f32_32x32x16_bf16 v[216:231], v[48:51], a[204:207], v[216:231]
    v_accvgpr_write_b32 a222, 0
    v_accvgpr_write_b32 a223, 0
    v_accvgpr_write_b32 a224, 0
    v_accvgpr_write_b32 a225, 0
    v_accvgpr_write_b32 a226, 0
    v_accvgpr_write_b32 a227, 0
    v_mfma_f32_32x32x16_bf16 v[232:247], v[52:55], a[204:207], v[232:247]
    v_accvgpr_write_b32 a228, 0
    v_accvgpr_write_b32 a229, 0
    v_accvgpr_write_b32 a230, 0
    v_accvgpr_write_b32 a231, 0
    v_accvgpr_write_b32 a232, 0
    v_accvgpr_write_b32 a233, 0
    v_mfma_f32_32x32x16_bf16 a[128:143], a[212:215], a[200:203], a[128:143]
    v_accvgpr_write_b32 a234, 0
    v_accvgpr_write_b32 a235, 0
    v_accvgpr_write_b32 a236, 0
    v_accvgpr_write_b32 a237, 0
    v_accvgpr_write_b32 a238, 0
    v_accvgpr_write_b32 a239, 0
    v_mfma_f32_32x32x16_bf16 a[144:159], a[212:215], a[204:207], a[144:159]
    v_accvgpr_write_b32 a240, 0
    v_accvgpr_write_b32 a241, 0
    v_accvgpr_write_b32 a242, 0
    v_accvgpr_write_b32 a243, 0
    v_accvgpr_write_b32 a244, 0
    v_accvgpr_write_b32 a245, 0
    v_accvgpr_write_b32 a246, 0
    v_accvgpr_write_b32 a247, 0
    v_accvgpr_write_b32 a248, 0
    v_accvgpr_write_b32 a249, 0
    v_accvgpr_write_b32 a250, 0
    v_accvgpr_write_b32 a251, 0
    v_accvgpr_write_b32 a252, 0
    v_accvgpr_write_b32 a253, 0
    v_accvgpr_write_b32 a254, 0
    v_accvgpr_write_b32 a255, 0
    s_waitcnt lgkmcnt(0)
    v_mfma_f32_32x32x16_bf16 v[120:135], v[24:27], a[192:195], v[120:135]
    ds_read_b128 a[200:203], v5 offset:0
    ds_read_b64_tr_b16 v[40:41], v8 offset:4096
    ds_read_b64_tr_b16 v[42:43], v8 offset:5120
    v_mfma_f32_32x32x16_bf16 v[136:151], v[28:31], a[192:195], v[136:151]
    ds_read_b128 a[204:207], v5 offset:4096
    ds_read_b64_tr_b16 v[44:45], v9 offset:4096
    ds_read_b64_tr_b16 v[46:47], v9 offset:5120
    v_mfma_f32_32x32x16_bf16 v[152:167], v[32:35], a[192:195], v[152:167]
    ds_read_b64_tr_b16 v[48:49], v10 offset:4096
    ds_read_b64_tr_b16 v[50:51], v10 offset:5120
    ds_read_b64_tr_b16 v[52:53], v11 offset:4096
    v_mfma_f32_32x32x16_bf16 v[168:183], v[36:39], a[192:195], v[168:183]
    ds_read_b64_tr_b16 v[54:55], v11 offset:5120
    ds_read_b64_tr_b16 a[212:213], v250 offset:4608
    ds_read_b64_tr_b16 a[214:215], v250 offset:4736
    v_mfma_f32_32x32x16_bf16 v[184:199], v[24:27], a[196:199], v[184:199]
    s_add_u32 m0, s74, 4096
    s_mov_b32 s96, 33664
    buffer_load_dwordx4 v248, s[36:39], s96 offen offset:0 lds
    s_add_u32 m0, s74, 4096
    s_mov_b32 s96, 40832
    buffer_load_dwordx4 v249, s[36:39], s96 offen offset:1024 lds
    v_mfma_f32_32x32x16_bf16 v[200:215], v[28:31], a[196:199], v[200:215]
    s_add_u32 m0, s74, 4096
    s_mov_b32 s96, 48000
    buffer_load_dwordx4 v248, s[36:39], s96 offen offset:2048 lds
    v_mfma_f32_32x32x16_bf16 v[216:231], v[32:35], a[196:199], v[216:231]
    v_mfma_f32_32x32x16_bf16 v[232:247], v[36:39], a[196:199], v[232:247]
    v_mfma_f32_32x32x16_bf16 a[128:143], a[208:211], a[192:195], a[128:143]
    s_add_u32 m0, s74, 4096
    s_mov_b32 s96, 55168
    buffer_load_dwordx4 v249, s[36:39], s96 offen offset:3072 lds
    v_mfma_f32_32x32x16_bf16 a[144:159], a[208:211], a[196:199], a[144:159]
    s_waitcnt lgkmcnt(0)
    v_mfma_f32_32x32x16_bf16 v[120:135], v[40:43], a[200:203], v[120:135]
    ds_read_b128 a[192:195], v6 offset:0
    ds_read_b64_tr_b16 v[24:25], v8 offset:8192
    ds_read_b64_tr_b16 v[26:27], v8 offset:9216
    v_mfma_f32_32x32x16_bf16 v[136:151], v[44:47], a[200:203], v[136:151]
    ds_read_b128 a[196:199], v6 offset:4096
    ds_read_b64_tr_b16 v[28:29], v9 offset:8192
    ds_read_b64_tr_b16 v[30:31], v9 offset:9216
    v_mfma_f32_32x32x16_bf16 v[152:167], v[48:51], a[200:203], v[152:167]
    ds_read_b64_tr_b16 v[32:33], v10 offset:8192
    ds_read_b64_tr_b16 v[34:35], v10 offset:9216
    ds_read_b64_tr_b16 v[36:37], v11 offset:8192
    v_mfma_f32_32x32x16_bf16 v[168:183], v[52:55], a[200:203], v[168:183]
    ds_read_b64_tr_b16 v[38:39], v11 offset:9216
    ds_read_b64_tr_b16 a[208:209], v250 offset:5120
    ds_read_b64_tr_b16 a[210:211], v250 offset:5248
    v_mfma_f32_32x32x16_bf16 v[184:199], v[40:43], a[204:207], v[184:199]
    s_lshl_b32 s96, s3, 10
    s_add_u32 m0, s96, 159744
    s_mul_i32 s96, s84, 7
    buffer_load_dwordx4 v251, s[40:43], s96 offen lds
    v_mfma_f32_32x32x16_bf16 v[200:215], v[44:47], a[204:207], v[200:215]
    s_add_u32 m0, s75, 0
    s_mov_b32 s96, 3670016
    buffer_load_dwordx4 v3, s[44:47], s96 offen offset:0 lds
    v_mfma_f32_32x32x16_bf16 v[216:231], v[48:51], a[204:207], v[216:231]
    s_add_u32 m0, s75, 0
    s_mov_b32 s96, 3701760
    buffer_load_dwordx4 v3, s[44:47], s96 offen offset:1024 lds
    v_mfma_f32_32x32x16_bf16 v[232:247], v[52:55], a[204:207], v[232:247]
    s_lshl_b32 s98, s4, 2
    v_mov_b32 v252, s98
    global_load_dword v253, v252, s[72:73] sc0 sc1
    v_mfma_f32_32x32x16_bf16 a[128:143], a[212:215], a[200:203], a[128:143]
    s_add_u32 m0, s75, 0
    s_mov_b32 s96, 3733504
    buffer_load_dwordx4 v3, s[44:47], s96 offen offset:2048 lds
    v_mfma_f32_32x32x16_bf16 a[144:159], a[212:215], a[204:207], a[144:159]
    s_waitcnt lgkmcnt(0)
    v_mfma_f32_32x32x16_bf16 v[120:135], v[24:27], a[192:195], v[120:135]
    ds_read_b128 a[200:203], v7 offset:0
    ds_read_b64_tr_b16 v[40:41], v8 offset:12288
    ds_read_b64_tr_b16 v[42:43], v8 offset:13312
    v_mfma_f32_32x32x16_bf16 v[136:151], v[28:31], a[192:195], v[136:151]
    ds_read_b128 a[204:207], v7 offset:4096
    ds_read_b64_tr_b16 v[44:45], v9 offset:12288
    ds_read_b64_tr_b16 v[46:47], v9 offset:13312
    v_mfma_f32_32x32x16_bf16 v[152:167], v[32:35], a[192:195], v[152:167]
    ds_read_b64_tr_b16 v[48:49], v10 offset:12288
    ds_read_b64_tr_b16 v[50:51], v10 offset:13312
    ds_read_b64_tr_b16 v[52:53], v11 offset:12288
    v_mfma_f32_32x32x16_bf16 v[168:183], v[36:39], a[192:195], v[168:183]
    ds_read_b64_tr_b16 v[54:55], v11 offset:13312
    ds_read_b64_tr_b16 a[212:213], v250 offset:5632
    ds_read_b64_tr_b16 a[214:215], v250 offset:5760
    v_mfma_f32_32x32x16_bf16 v[184:199], v[24:27], a[196:199], v[184:199]
    s_add_u32 m0, s75, 0
    s_mov_b32 s96, 3765248
    buffer_load_dwordx4 v3, s[44:47], s96 offen offset:3072 lds
    v_mfma_f32_32x32x16_bf16 v[200:215], v[28:31], a[196:199], v[200:215]
    v_mfma_f32_32x32x16_bf16 v[216:231], v[32:35], a[196:199], v[216:231]
    v_mfma_f32_32x32x16_bf16 v[232:247], v[36:39], a[196:199], v[232:247]
    v_mfma_f32_32x32x16_bf16 a[128:143], a[208:211], a[192:195], a[128:143]
    s_waitcnt lgkmcnt(0)
    s_waitcnt vmcnt(14)
    s_barrier
    v_add_u32 v4, 98304, v14
    v_xor_b32 v5, 32, v4
    v_xor_b32 v6, 64, v4
    v_xor_b32 v7, 96, v4
    v_mfma_f32_32x32x16_bf16 a[144:159], a[208:211], a[196:199], a[144:159]
    v_add_u32 v8, 98304, v16
    v_add_u32 v9, 98304, v17
    v_add_u32 v10, 98304, v18
    v_add_u32 v11, 98304, v19
    v_mfma_f32_32x32x16_bf16 v[120:135], v[40:43], a[200:203], v[120:135]
    ds_read_b128 a[192:195], v4 offset:0
    ds_read_b64_tr_b16 v[24:25], v8 offset:0
    ds_read_b64_tr_b16 v[26:27], v8 offset:1024
    v_mfma_f32_32x32x16_bf16 v[136:151], v[44:47], a[200:203], v[136:151]
    ds_read_b128 a[196:199], v4 offset:4096
    ds_read_b64_tr_b16 v[28:29], v9 offset:0
    ds_read_b64_tr_b16 v[30:31], v9 offset:1024
    v_mfma_f32_32x32x16_bf16 v[152:167], v[48:51], a[200:203], v[152:167]
    ds_read_b64_tr_b16 v[32:33], v10 offset:0
    ds_read_b64_tr_b16 v[34:35], v10 offset:1024
    ds_read_b64_tr_b16 v[36:37], v11 offset:0
    v_mfma_f32_32x32x16_bf16 v[168:183], v[52:55], a[200:203], v[168:183]
    ds_read_b64_tr_b16 v[38:39], v11 offset:1024
    ds_read_b64_tr_b16 a[208:209], v250 offset:8192
    ds_read_b64_tr_b16 a[210:211], v250 offset:8320
    v_mfma_f32_32x32x16_bf16 v[184:199], v[40:43], a[204:207], v[184:199]
    v_mfma_f32_32x32x16_bf16 v[200:215], v[44:47], a[204:207], v[200:215]
    v_mfma_f32_32x32x16_bf16 v[216:231], v[48:51], a[204:207], v[216:231]
    v_mfma_f32_32x32x16_bf16 v[232:247], v[52:55], a[204:207], v[232:247]
    v_mfma_f32_32x32x16_bf16 a[128:143], a[212:215], a[200:203], a[128:143]
    v_mfma_f32_32x32x16_bf16 a[144:159], a[212:215], a[204:207], a[144:159]
    s_waitcnt vmcnt(2)
    v_readfirstlane_b32 s98, v253
    s_nop 3
    s_and_b32 s98, s98, 0xffff
    s_cmp_ge_u32 s98, 8
    s_cbranch_scc0 A_SPIN
A_READY:
    s_waitcnt lgkmcnt(0)
    v_mfma_f32_32x32x16_bf16 v[120:135], v[24:27], a[192:195], v[120:135]
    ds_read_b128 a[200:203], v5 offset:0
    ds_read_b64_tr_b16 v[40:41], v8 offset:4096
    ds_read_b64_tr_b16 v[42:43], v8 offset:5120
    v_mfma_f32_32x32x16_bf16 v[136:151], v[28:31], a[192:195], v[136:151]
    ds_read_b128 a[204:207], v5 offset:4096
    ds_read_b64_tr_b16 v[44:45], v9 offset:4096
    ds_read_b64_tr_b16 v[46:47], v9 offset:5120
    v_mfma_f32_32x32x16_bf16 v[152:167], v[32:35], a[192:195], v[152:167]
    ds_read_b64_tr_b16 v[48:49], v10 offset:4096
    ds_read_b64_tr_b16 v[50:51], v10 offset:5120
    ds_read_b64_tr_b16 v[52:53], v11 offset:4096
    v_mfma_f32_32x32x16_bf16 v[168:183], v[36:39], a[192:195], v[168:183]
    ds_read_b64_tr_b16 v[54:55], v11 offset:5120
    ds_read_b64_tr_b16 a[212:213], v250 offset:8704
    ds_read_b64_tr_b16 a[214:215], v250 offset:8832
    v_mfma_f32_32x32x16_bf16 v[184:199], v[24:27], a[196:199], v[184:199]
    s_lshl_b32 s98, s3, 12
    s_add_u32 m0, s98, 65536
    s_lshl_b32 s99, s4, 19
    s_add_u32 s98, s98, s99
    s_add_u32 s98, s98, 16777216
    buffer_load_dwordx4 v12, s[68:71], s98 offen offset:0 sc1 lds
    v_mfma_f32_32x32x16_bf16 v[200:215], v[28:31], a[196:199], v[200:215]
    v_mfma_f32_32x32x16_bf16 v[216:231], v[32:35], a[196:199], v[216:231]
    v_mfma_f32_32x32x16_bf16 v[232:247], v[36:39], a[196:199], v[232:247]
    v_mfma_f32_32x32x16_bf16 a[128:143], a[208:211], a[192:195], a[128:143]
    s_lshl_b32 s98, s3, 12
    s_add_u32 m0, s98, 65536
    s_lshl_b32 s99, s4, 19
    s_add_u32 s98, s98, s99
    s_add_u32 s98, s98, 16777216
    buffer_load_dwordx4 v12, s[68:71], s98 offen offset:1024 sc1 lds
    v_mfma_f32_32x32x16_bf16 a[144:159], a[208:211], a[196:199], a[144:159]
    s_waitcnt lgkmcnt(0)
    v_mfma_f32_32x32x16_bf16 v[120:135], v[40:43], a[200:203], v[120:135]
    ds_read_b128 a[192:195], v6 offset:0
    ds_read_b64_tr_b16 v[24:25], v8 offset:8192
    ds_read_b64_tr_b16 v[26:27], v8 offset:9216
    v_mfma_f32_32x32x16_bf16 v[136:151], v[44:47], a[200:203], v[136:151]
    ds_read_b128 a[196:199], v6 offset:4096
    ds_read_b64_tr_b16 v[28:29], v9 offset:8192
    ds_read_b64_tr_b16 v[30:31], v9 offset:9216
    v_mfma_f32_32x32x16_bf16 v[152:167], v[48:51], a[200:203], v[152:167]
    ds_read_b64_tr_b16 v[32:33], v10 offset:8192
    ds_read_b64_tr_b16 v[34:35], v10 offset:9216
    ds_read_b64_tr_b16 v[36:37], v11 offset:8192
    v_mfma_f32_32x32x16_bf16 v[168:183], v[52:55], a[200:203], v[168:183]
    ds_read_b64_tr_b16 v[38:39], v11 offset:9216
    ds_read_b64_tr_b16 a[208:209], v250 offset:9216
    ds_read_b64_tr_b16 a[210:211], v250 offset:9344
    v_mfma_f32_32x32x16_bf16 v[184:199], v[40:43], a[204:207], v[184:199]
    s_lshl_b32 s98, s3, 12
    s_add_u32 m0, s98, 65536
    s_lshl_b32 s99, s4, 19
    s_add_u32 s98, s98, s99
    s_add_u32 s98, s98, 16777216
    buffer_load_dwordx4 v12, s[68:71], s98 offen offset:2048 sc1 lds
    v_mfma_f32_32x32x16_bf16 v[200:215], v[44:47], a[204:207], v[200:215]
    v_mfma_f32_32x32x16_bf16 v[216:231], v[48:51], a[204:207], v[216:231]
    v_mfma_f32_32x32x16_bf16 v[232:247], v[52:55], a[204:207], v[232:247]
    v_mfma_f32_32x32x16_bf16 a[128:143], a[212:215], a[200:203], a[128:143]
    v_mfma_f32_32x32x16_bf16 a[144:159], a[212:215], a[204:207], a[144:159]
    s_waitcnt lgkmcnt(0)
    v_mfma_f32_32x32x16_bf16 v[120:135], v[24:27], a[192:195], v[120:135]
    ds_read_b128 a[200:203], v7 offset:0
    ds_read_b64_tr_b16 v[40:41], v8 offset:12288
    ds_read_b64_tr_b16 v[42:43], v8 offset:13312
    v_mfma_f32_32x32x16_bf16 v[136:151], v[28:31], a[192:195], v[136:151]
    ds_read_b128 a[204:207], v7 offset:4096
    ds_read_b64_tr_b16 v[44:45], v9 offset:12288
    ds_read_b64_tr_b16 v[46:47], v9 offset:13312
    v_mfma_f32_32x32x16_bf16 v[152:167], v[32:35], a[192:195], v[152:167]
    ds_read_b64_tr_b16 v[48:49], v10 offset:12288
    ds_read_b64_tr_b16 v[50:51], v10 offset:13312
    ds_read_b64_tr_b16 v[52:53], v11 offset:12288
    v_mfma_f32_32x32x16_bf16 v[168:183], v[36:39], a[192:195], v[168:183]
    ds_read_b64_tr_b16 v[54:55], v11 offset:13312
    ds_read_b64_tr_b16 a[212:213], v250 offset:9728
    ds_read_b64_tr_b16 a[214:215], v250 offset:9856
    v_mfma_f32_32x32x16_bf16 v[184:199], v[24:27], a[196:199], v[184:199]
    s_lshl_b32 s98, s3, 12
    s_add_u32 m0, s98, 65536
    s_lshl_b32 s99, s4, 19
    s_add_u32 s98, s98, s99
    s_add_u32 s98, s98, 16777216
    buffer_load_dwordx4 v12, s[68:71], s98 offen offset:3072 sc1 lds
    v_mfma_f32_32x32x16_bf16 v[200:215], v[28:31], a[196:199], v[200:215]
    v_mfma_f32_32x32x16_bf16 v[216:231], v[32:35], a[196:199], v[216:231]
    v_mfma_f32_32x32x16_bf16 v[232:247], v[36:39], a[196:199], v[232:247]
    v_mfma_f32_32x32x16_bf16 a[128:143], a[208:211], a[192:195], a[128:143]
    s_waitcnt lgkmcnt(0)
    s_waitcnt vmcnt(4)
    s_barrier
    v_add_u32 v4, 0, v14
    v_xor_b32 v5, 32, v4
    v_xor_b32 v6, 64, v4
    v_xor_b32 v7, 96, v4
    v_mfma_f32_32x32x16_bf16 a[144:159], a[208:211], a[196:199], a[144:159]
    v_add_u32 v8, 0, v16
    v_add_u32 v9, 0, v17
    v_add_u32 v10, 0, v18
    v_add_u32 v11, 0, v19
    v_mfma_f32_32x32x16_bf16 v[120:135], v[40:43], a[200:203], v[120:135]
    ds_read_b128 a[192:195], v4 offset:0
    ds_read_b64_tr_b16 v[24:25], v8 offset:0
    ds_read_b64_tr_b16 v[26:27], v8 offset:1024
    v_mfma_f32_32x32x16_bf16 v[136:151], v[44:47], a[200:203], v[136:151]
    ds_read_b128 a[196:199], v4 offset:4096
    ds_read_b64_tr_b16 v[28:29], v9 offset:0
    ds_read_b64_tr_b16 v[30:31], v9 offset:1024
    v_mfma_f32_32x32x16_bf16 v[152:167], v[48:51], a[200:203], v[152:167]
    ds_read_b64_tr_b16 v[32:33], v10 offset:0
    ds_read_b64_tr_b16 v[34:35], v10 offset:1024
    ds_read_b64_tr_b16 v[36:37], v11 offset:0
    v_mfma_f32_32x32x16_bf16 v[168:183], v[52:55], a[200:203], v[168:183]
    ds_read_b64_tr_b16 v[38:39], v11 offset:1024
    ds_read_b64_tr_b16 a[208:209], v250 offset:12288
    ds_read_b64_tr_b16 a[210:211], v250 offset:12416
    v_mfma_f32_32x32x16_bf16 v[184:199], v[40:43], a[204:207], v[184:199]
    v_mfma_f32_32x32x16_bf16 v[200:215], v[44:47], a[204:207], v[200:215]
    v_mfma_f32_32x32x16_bf16 v[216:231], v[48:51], a[204:207], v[216:231]
    v_mfma_f32_32x32x16_bf16 v[232:247], v[52:55], a[204:207], v[232:247]
    v_mfma_f32_32x32x16_bf16 a[128:143], a[212:215], a[200:203], a[128:143]
    v_mfma_f32_32x32x16_bf16 a[144:159], a[212:215], a[204:207], a[144:159]
    s_waitcnt lgkmcnt(0)
    v_mfma_f32_32x32x16_bf16 v[120:135], v[24:27], a[192:195], v[120:135]
    ds_read_b128 a[200:203], v5 offset:0
    ds_read_b64_tr_b16 v[40:41], v8 offset:4096
    ds_read_b64_tr_b16 v[42:43], v8 offset:5120
    v_mfma_f32_32x32x16_bf16 v[136:151], v[28:31], a[192:195], v[136:151]
    ds_read_b128 a[204:207], v5 offset:4096
    ds_read_b64_tr_b16 v[44:45], v9 offset:4096
    ds_read_b64_tr_b16 v[46:47], v9 offset:5120
    v_mfma_f32_32x32x16_bf16 v[152:167], v[32:35], a[192:195], v[152:167]
    ds_read_b64_tr_b16 v[48:49], v10 offset:4096
    ds_read_b64_tr_b16 v[50:51], v10 offset:5120
    ds_read_b64_tr_b16 v[52:53], v11 offset:4096
    v_mfma_f32_32x32x16_bf16 v[168:183], v[36:39], a[192:195], v[168:183]
    ds_read_b64_tr_b16 v[54:55], v11 offset:5120
    ds_read_b64_tr_b16 a[212:213], v250 offset:12800
    ds_read_b64_tr_b16 a[214:215], v250 offset:12928
    v_mfma_f32_32x32x16_bf16 v[184:199], v[24:27], a[196:199], v[184:199]
    v_mfma_f32_32x32x16_bf16 v[200:215], v[28:31], a[196:199], v[200:215]
    v_mfma_f32_32x32x16_bf16 v[216:231], v[32:35], a[196:199], v[216:231]
    v_mfma_f32_32x32x16_bf16 v[232:247], v[36:39], a[196:199], v[232:247]
    v_mfma_f32_32x32x16_bf16 a[128:143], a[208:211], a[192:195], a[128:143]
    v_mfma_f32_32x32x16_bf16 a[144:159], a[208:211], a[196:199], a[144:159]
    s_waitcnt lgkmcnt(0)
    v_mfma_f32_32x32x16_bf16 v[120:135], v[40:43], a[200:203], v[120:135]
    ds_read_b128 a[192:195], v6 offset:0
    ds_read_b64_tr_b16 v[24:25], v8 offset:8192
    ds_read_b64_tr_b16 v[26:27], v8 offset:9216
    v_mfma_f32_32x32x16_bf16 v[136:151], v[44:47], a[200:203], v[136:151]
    ds_read_b128 a[196:199], v6 offset:4096
    ds_read_b64_tr_b16 v[28:29], v9 offset:8192
    ds_read_b64_tr_b16 v[30:31], v9 offset:9216
    v_mfma_f32_32x32x16_bf16 v[152:167], v[48:51], a[200:203], v[152:167]
    ds_read_b64_tr_b16 v[32:33], v10 offset:8192
    ds_read_b64_tr_b16 v[34:35], v10 offset:9216
    ds_read_b64_tr_b16 v[36:37], v11 offset:8192
    v_mfma_f32_32x32x16_bf16 v[168:183], v[52:55], a[200:203], v[168:183]
    ds_read_b64_tr_b16 v[38:39], v11 offset:9216
    ds_read_b64_tr_b16 a[208:209], v250 offset:13312
    ds_read_b64_tr_b16 a[210:211], v250 offset:13440
    v_mfma_f32_32x32x16_bf16 v[184:199], v[40:43], a[204:207], v[184:199]
    v_mfma_f32_32x32x16_bf16 v[200:215], v[44:47], a[204:207], v[200:215]
    v_mfma_f32_32x32x16_bf16 v[216:231], v[48:51], a[204:207], v[216:231]
    v_mfma_f32_32x32x16_bf16 v[232:247], v[52:55], a[204:207], v[232:247]
    v_mfma_f32_32x32x16_bf16 a[128:143], a[212:215], a[200:203], a[128:143]
    v_mfma_f32_32x32x16_bf16 a[144:159], a[212:215], a[204:207], a[144:159]
    s_waitcnt lgkmcnt(0)
    v_mfma_f32_32x32x16_bf16 v[120:135], v[24:27], a[192:195], v[120:135]
    ds_read_b128 a[200:203], v7 offset:0
    ds_read_b64_tr_b16 v[40:41], v8 offset:12288
    ds_read_b64_tr_b16 v[42:43], v8 offset:13312
    v_mfma_f32_32x32x16_bf16 v[136:151], v[28:31], a[192:195], v[136:151]
    ds_read_b128 a[204:207], v7 offset:4096
    ds_read_b64_tr_b16 v[44:45], v9 offset:12288
    ds_read_b64_tr_b16 v[46:47], v9 offset:13312
    v_mfma_f32_32x32x16_bf16 v[152:167], v[32:35], a[192:195], v[152:167]
    ds_read_b64_tr_b16 v[48:49], v10 offset:12288
    ds_read_b64_tr_b16 v[50:51], v10 offset:13312
    ds_read_b64_tr_b16 v[52:53], v11 offset:12288
    v_mfma_f32_32x32x16_bf16 v[168:183], v[36:39], a[192:195], v[168:183]
    ds_read_b64_tr_b16 v[54:55], v11 offset:13312
    ds_read_b64_tr_b16 a[212:213], v250 offset:13824
    ds_read_b64_tr_b16 a[214:215], v250 offset:13952
    v_mfma_f32_32x32x16_bf16 v[184:199], v[24:27], a[196:199], v[184:199]
    v_mfma_f32_32x32x16_bf16 v[200:215], v[28:31], a[196:199], v[200:215]
    v_mfma_f32_32x32x16_bf16 v[216:231], v[32:35], a[196:199], v[216:231]
    v_mfma_f32_32x32x16_bf16 v[232:247], v[36:39], a[196:199], v[232:247]
    v_mfma_f32_32x32x16_bf16 a[128:143], a[208:211], a[192:195], a[128:143]
    v_mfma_f32_32x32x16_bf16 a[144:159], a[208:211], a[196:199], a[144:159]
    s_waitcnt lgkmcnt(0)
    v_mfma_f32_32x32x16_bf16 v[120:135], v[40:43], a[200:203], v[120:135]
    v_mfma_f32_32x32x16_bf16 v[136:151], v[44:47], a[200:203], v[136:151]
    v_mfma_f32_32x32x16_bf16 v[152:167], v[48:51], a[200:203], v[152:167]
    v_mfma_f32_32x32x16_bf16 v[168:183], v[52:55], a[200:203], v[168:183]
    v_mfma_f32_32x32x16_bf16 v[184:199], v[40:43], a[204:207], v[184:199]
    v_mfma_f32_32x32x16_bf16 v[200:215], v[44:47], a[204:207], v[200:215]
    v_mfma_f32_32x32x16_bf16 v[216:231], v[48:51], a[204:207], v[216:231]
    v_mfma_f32_32x32x16_bf16 v[232:247], v[52:55], a[204:207], v[232:247]
    v_mfma_f32_32x32x16_bf16 a[128:143], a[212:215], a[200:203], a[128:143]
    v_mfma_f32_32x32x16_bf16 a[144:159], a[212:215], a[204:207], a[144:159]
    s_waitcnt vmcnt(0)
    s_barrier
    s_and_b32 s4, s2, 7
    s_lshl_b32 s4, s4, 2
    s_lshr_b32 s48, s2, 3
    s_and_b32 s48, s48, 3
    s_add_u32 s4, s4, s48
    s_lshr_b32 s5, s2, 5
    s_and_b32 s16, s3, 1
    s_lshr_b32 s17, s3, 1
    s_lshl_b32 s27, s4, 19
    v_lshlrev_b32 v1, 4, v0
    s_lshl_b32 s48, s17, 11
    s_add_u32 s49, s48, 2048
    s_sub_u32 s50, 2048, s48
    v_add_u32 v2, s49, v1
    v_add_u32 v3, s50, v1
    v_mov_b32 v18, 0xff800000
    v_mov_b32 v19, 0x42000000
    s_lshl_b32 s48, s5, 1
    s_add_u32 s49, s48, 2
    s_cmp_eq_u32 s5, 7
    s_cselect_b32 s50, 2, 0
    s_sub_u32 s51, 18, s50
    s_sub_u32 s32, 17, s48
    s_lshl_b32 s32, s32, 14
    s_sub_u32 s18, 15, s5
    s_cmp_eq_u32 s17, 0
    s_cselect_b32 s20, s51, s48
    s_cselect_b32 s33, s50, 2
    s_cselect_b32 s30, 1000, s49
    s_cselect_b32 s18, s18, s5
    s_cselect_b32 s19, 1, 0
    s_mov_b32 s31, s30
    s_lshl_b32 s50, s16, 13
    s_add_u32 s49, s50, s27
    s_add_u32 s21, s49, 16777216
    s_add_u32 s22, s49, 33552384
    s_lshl_b32 s49, s17, 16
    s_add_u32 s23, s49, s50
    s_add_u32 s24, s23, 16384
    v_add_u32 v4, s49, v1
    v_mov_b32 v5, v4
    s_sub_u32 s30, s30, 1
    s_cmp_eq_u32 s30, 0
    s_cselect_b32 s48, s32, 16384
    s_add_u32 s21, s21, s48
    s_xor_b32 s23, s23, 32768
    s_nop 7
    s_mov_b32 s52, 1052289595
    s_mov_b32 s54, 1040356334
    s_mov_b32 s55, s54
    s_lshl_b32 s49, s18, 2
    s_lshl_b32 s50, s16, 1
    s_add_u32 s49, s49, s50
    s_lshl_b32 s49, s49, 10
    s_lshl_b32 s50, s4, 16
    s_add_u32 s49, s49, s50
    s_add_u32 s50, s49, 67108864
    s_add_u32 s51, s49, 69206016
    v_accvgpr_read_b32 v88, a128
    v_accvgpr_read_b32 v89, a129
    v_accvgpr_read_b32 v90, a130
    v_accvgpr_read_b32 v91, a131
    v_accvgpr_read_b32 v92, a132
    v_accvgpr_read_b32 v93, a133
    v_accvgpr_read_b32 v94, a134
    v_accvgpr_read_b32 v95, a135
    v_accvgpr_read_b32 v96, a136
    v_accvgpr_read_b32 v97, a137
    v_accvgpr_read_b32 v98, a138
    v_accvgpr_read_b32 v99, a139
    v_accvgpr_read_b32 v100, a140
    v_accvgpr_read_b32 v101, a141
    v_accvgpr_read_b32 v102, a142
    v_accvgpr_read_b32 v103, a143
    v_accvgpr_read_b32 v104, a144
    v_accvgpr_read_b32 v105, a145
    v_accvgpr_read_b32 v106, a146
    v_accvgpr_read_b32 v107, a147
    v_accvgpr_read_b32 v108, a148
    v_accvgpr_read_b32 v109, a149
    v_accvgpr_read_b32 v110, a150
    v_accvgpr_read_b32 v111, a151
    v_accvgpr_read_b32 v112, a152
    v_accvgpr_read_b32 v113, a153
    v_accvgpr_read_b32 v114, a154
    v_accvgpr_read_b32 v115, a155
    v_accvgpr_read_b32 v116, a156
    v_accvgpr_read_b32 v117, a157
    v_accvgpr_read_b32 v118, a158
    v_accvgpr_read_b32 v119, a159
    v_mul_f32 v88, s52, v88
    v_mul_f32 v89, s52, v89
    v_mul_f32 v90, s52, v90
    v_mul_f32 v91, s52, v91
    v_mul_f32 v92, s52, v92
    v_mul_f32 v93, s52, v93
    v_mul_f32 v94, s52, v94
    v_mul_f32 v95, s52, v95
    v_cvt_pk_bf16_f32 v88, v88, v89
    v_cvt_pk_bf16_f32 v89, v90, v91
    v_cvt_pk_bf16_f32 v90, v92, v93
    v_cvt_pk_bf16_f32 v91, v94, v95
    v_cvt_pk_bf16_f32 v96, v96, v97
    v_cvt_pk_bf16_f32 v97, v98, v99
    v_cvt_pk_bf16_f32 v98, v100, v101
    v_cvt_pk_bf16_f32 v99, v102, v103
    buffer_store_dwordx4 v[88:91], v1, s[68:71], s50 offen offset:0
    v_mul_f32 v104, s52, v104
    v_mul_f32 v105, s52, v105
    v_mul_f32 v106, s52, v106
    v_mul_f32 v107, s52, v107
    v_mul_f32 v108, s52, v108
    v_mul_f32 v109, s52, v109
    v_mul_f32 v110, s52, v110
    v_mul_f32 v111, s52, v111
    v_cvt_pk_bf16_f32 v104, v104, v105
    v_cvt_pk_bf16_f32 v105, v106, v107
    v_cvt_pk_bf16_f32 v106, v108, v109
    v_cvt_pk_bf16_f32 v107, v110, v111
    v_cvt_pk_bf16_f32 v112, v112, v113
    v_cvt_pk_bf16_f32 v113, v114, v115
    v_cvt_pk_bf16_f32 v114, v116, v117
    v_cvt_pk_bf16_f32 v115, v118, v119
    buffer_store_dwordx4 v[104:107], v1, s[68:71], s50 offen offset:1024
    s_cmp_ge_u32 s4, 2
    s_cbranch_scc1 A_NOKV
    v_and_b32 v20, 31, v0
    v_lshrrev_b32 v21, 5, v0
    v_lshlrev_b32 v20, 5, v20
    v_lshl_add_u32 v20, v21, 4, v20
    s_cmp_eq_u32 s4, 0
    s_cselect_b64 vcc, -1, 0
    v_cndmask_b32 v20, v20, v1, vcc
    buffer_store_dwordx4 v[96:99], v20, s[68:71], s51 offen offset:0
    buffer_store_dwordx4 v[112:115], v20, s[68:71], s51 offen offset:1024
A_NOKV:
    v_add_u32 v25, 65536, v1
    v_pk_mul_f32 v[120:121], v[120:121], s[54:55]
    v_pk_mul_f32 v[122:123], v[122:123], s[54:55]
    v_pk_mul_f32 v[124:125], v[124:125], s[54:55]
    ds_read_b128 a[128:131], v25 offset:0
    v_pk_mul_f32 v[126:127], v[126:127], s[54:55]
    v_cvt_pk_bf16_f32 v32, v120, v121
    v_cvt_pk_bf16_f32 v33, v122, v123
    ds_read_b128 a[132:135], v25 offset:1024
    v_cvt_pk_bf16_f32 v34, v124, v125
    v_cvt_pk_bf16_f32 v35, v126, v127
    v_pk_mul_f32 v[128:129], v[128:129], s[54:55]
    ds_read_b128 a[136:139], v25 offset:2048
    v_pk_mul_f32 v[130:131], v[130:131], s[54:55]
    v_pk_mul_f32 v[132:133], v[132:133], s[54:55]
    v_pk_mul_f32 v[134:135], v[134:135], s[54:55]
    ds_read_b128 a[140:143], v25 offset:3072
    v_cvt_pk_bf16_f32 v36, v128, v129
    v_cvt_pk_bf16_f32 v37, v130, v131
    v_cvt_pk_bf16_f32 v38, v132, v133
    ds_read_b128 a[144:147], v25 offset:4096
    v_cvt_pk_bf16_f32 v39, v134, v135
    v_pk_mul_f32 v[136:137], v[136:137], s[54:55]
    v_pk_mul_f32 v[138:139], v[138:139], s[54:55]
    ds_read_b128 a[148:151], v25 offset:5120
    v_pk_mul_f32 v[140:141], v[140:141], s[54:55]
    v_pk_mul_f32 v[142:143], v[142:143], s[54:55]
    v_cvt_pk_bf16_f32 v40, v136, v137
    ds_read_b128 a[152:155], v25 offset:6144
    v_cvt_pk_bf16_f32 v41, v138, v139
    v_cvt_pk_bf16_f32 v42, v140, v141
    v_cvt_pk_bf16_f32 v43, v142, v143
    ds_read_b128 a[156:159], v25 offset:7168
    v_pk_mul_f32 v[144:145], v[144:145], s[54:55]
    v_pk_mul_f32 v[146:147], v[146:147], s[54:55]
    v_pk_mul_f32 v[148:149], v[148:149], s[54:55]
    ds_read_b128 a[160:163], v25 offset:8192
    v_pk_mul_f32 v[150:151], v[150:151], s[54:55]
    v_cvt_pk_bf16_f32 v44, v144, v145
    v_cvt_pk_bf16_f32 v45, v146, v147
    ds_read_b128 a[164:167], v25 offset:9216
    v_cvt_pk_bf16_f32 v46, v148, v149
    v_cvt_pk_bf16_f32 v47, v150, v151
    v_pk_mul_f32 v[152:153], v[152:153], s[54:55]
    ds_read_b128 a[168:171], v25 offset:10240
    v_pk_mul_f32 v[154:155], v[154:155], s[54:55]
    v_pk_mul_f32 v[156:157], v[156:157], s[54:55]
    v_pk_mul_f32 v[158:159], v[158:159], s[54:55]
    ds_read_b128 a[172:175], v25 offset:11264
    v_cvt_pk_bf16_f32 v48, v152, v153
    v_cvt_pk_bf16_f32 v49, v154, v155
    v_cvt_pk_bf16_f32 v50, v156, v157
    ds_read_b128 a[176:179], v25 offset:12288
    v_cvt_pk_bf16_f32 v51, v158, v159
    v_pk_mul_f32 v[160:161], v[160:161], s[54:55]
    v_pk_mul_f32 v[162:163], v[162:163], s[54:55]
    ds_read_b128 a[180:183], v25 offset:13312
    v_pk_mul_f32 v[164:165], v[164:165], s[54:55]
    v_pk_mul_f32 v[166:167], v[166:167], s[54:55]
    v_cvt_pk_bf16_f32 v52, v160, v161
    ds_read_b128 a[184:187], v25 offset:14336
    v_cvt_pk_bf16_f32 v53, v162, v163
    v_cvt_pk_bf16_f32 v54, v164, v165
    v_cvt_pk_bf16_f32 v55, v166, v167
    ds_read_b128 a[188:191], v25 offset:15360
    v_pk_mul_f32 v[168:169], v[168:169], s[54:55]
    v_pk_mul_f32 v[170:171], v[170:171], s[54:55]
    v_pk_mul_f32 v[172:173], v[172:173], s[54:55]
    s_add_u32 m0, s24, 0
    s_add_u32 s48, s22, 0
    buffer_load_dwordx4 v2, s[68:71], s48 offen sc1 lds
    v_pk_mul_f32 v[174:175], v[174:175], s[54:55]
    v_cvt_pk_bf16_f32 v56, v168, v169
    v_cvt_pk_bf16_f32 v57, v170, v171
    buffer_load_dwordx4 v2, s[68:71], s48 offen offset:1024 sc1 lds
    v_cvt_pk_bf16_f32 v58, v172, v173
    v_cvt_pk_bf16_f32 v59, v174, v175
    v_pk_mul_f32 v[176:177], v[176:177], s[54:55]
    buffer_load_dwordx4 v3, s[68:71], s48 offen offset:2048 sc1 lds
    v_pk_mul_f32 v[178:179], v[178:179], s[54:55]
    v_pk_mul_f32 v[180:181], v[180:181], s[54:55]
    v_pk_mul_f32 v[182:183], v[182:183], s[54:55]
    buffer_load_dwordx4 v3, s[68:71], s48 offen offset:3072 sc1 lds
    v_cvt_pk_bf16_f32 v60, v176, v177
    v_cvt_pk_bf16_f32 v61, v178, v179
    v_cvt_pk_bf16_f32 v62, v180, v181
    s_add_u32 m0, s24, 4096
    s_add_u32 s48, s22, 4096
    buffer_load_dwordx4 v2, s[68:71], s48 offen sc1 lds
    v_cvt_pk_bf16_f32 v63, v182, v183
    v_pk_mul_f32 v[184:185], v[184:185], s[54:55]
    v_pk_mul_f32 v[186:187], v[186:187], s[54:55]
    buffer_load_dwordx4 v2, s[68:71], s48 offen offset:1024 sc1 lds
    v_pk_mul_f32 v[188:189], v[188:189], s[54:55]
    v_pk_mul_f32 v[190:191], v[190:191], s[54:55]
    v_cvt_pk_bf16_f32 v64, v184, v185
    buffer_load_dwordx4 v3, s[68:71], s48 offen offset:2048 sc1 lds
    v_cvt_pk_bf16_f32 v65, v186, v187
    v_cvt_pk_bf16_f32 v66, v188, v189
    v_cvt_pk_bf16_f32 v67, v190, v191
    buffer_load_dwordx4 v3, s[68:71], s48 offen offset:3072 sc1 lds
    v_pk_mul_f32 v[192:193], v[192:193], s[54:55]
    v_pk_mul_f32 v[194:195], v[194:195], s[54:55]
    v_pk_mul_f32 v[196:197], v[196:197], s[54:55]
    s_sub_u32 s31, s31, 1
    s_cmp_eq_u32 s31, 0
    s_cselect_b32 s48, s32, 16384
    s_add_u32 s22, s22, s48
    s_xor_b32 s24, s24, 32768
    v_pk_mul_f32 v[198:199], v[198:199], s[54:55]
    v_cvt_pk_bf16_f32 v68, v192, v193
    v_cvt_pk_bf16_f32 v69, v194, v195
    s_add_u32 m0, s23, 0
    s_add_u32 s48, s21, 0
    buffer_load_dwordx4 v1, s[68:71], s48 offen sc1 lds
    v_cvt_pk_bf16_f32 v70, v196, v197
    v_cvt_pk_bf16_f32 v71, v198, v199
    v_pk_mul_f32 v[200:201], v[200:201], s[54:55]
    buffer_load_dwordx4 v1, s[68:71], s48 offen offset:1024 sc1 lds
    v_pk_mul_f32 v[202:203], v[202:203], s[54:55]
    v_pk_mul_f32 v[204:205], v[204:205], s[54:55]
    v_pk_mul_f32 v[206:207], v[206:207], s[54:55]
    buffer_load_dwordx4 v1, s[68:71], s48 offen offset:2048 sc1 lds
    v_cvt_pk_bf16_f32 v72, v200, v201
    v_cvt_pk_bf16_f32 v73, v202, v203
    v_cvt_pk_bf16_f32 v74, v204, v205
    buffer_load_dwordx4 v1, s[68:71], s48 offen offset:3072 sc1 lds
    v_cvt_pk_bf16_f32 v75, v206, v207
    v_pk_mul_f32 v[208:209], v[208:209], s[54:55]
    v_pk_mul_f32 v[210:211], v[210:211], s[54:55]
    s_add_u32 m0, s23, 4096
    s_add_u32 s48, s21, 4096
    buffer_load_dwordx4 v1, s[68:71], s48 offen sc1 lds
    v_pk_mul_f32 v[212:213], v[212:213], s[54:55]
    v_pk_mul_f32 v[214:215], v[214:215], s[54:55]
    v_cvt_pk_bf16_f32 v76, v208, v209
    buffer_load_dwordx4 v1, s[68:71], s48 offen offset:1024 sc1 lds
    v_cvt_pk_bf16_f32 v77, v210, v211
    v_cvt_pk_bf16_f32 v78, v212, v213
    v_cvt_pk_bf16_f32 v79, v214, v215
    buffer_load_dwordx4 v1, s[68:71], s48 offen offset:2048 sc1 lds
    v_pk_mul_f32 v[216:217], v[216:217], s[54:55]
    v_pk_mul_f32 v[218:219], v[218:219], s[54:55]
    v_pk_mul_f32 v[220:221], v[220:221], s[54:55]
    buffer_load_dwordx4 v1, s[68:71], s48 offen offset:3072 sc1 lds
    v_pk_mul_f32 v[222:223], v[222:223], s[54:55]
    v_cvt_pk_bf16_f32 v80, v216, v217
    v_cvt_pk_bf16_f32 v81, v218, v219
    s_sub_u32 s30, s30, 1
    s_cmp_eq_u32 s30, 0
    s_cselect_b32 s48, s32, 16384
    s_add_u32 s21, s21, s48
    s_xor_b32 s23, s23, 32768
    v_cvt_pk_bf16_f32 v82, v220, v221
    v_cvt_pk_bf16_f32 v83, v222, v223
    v_pk_mul_f32 v[224:225], v[224:225], s[54:55]
    v_xor_b32 v4, 32768, v4
    v_pk_mul_f32 v[226:227], v[226:227], s[54:55]
    v_pk_mul_f32 v[228:229], v[228:229], s[54:55]
    v_pk_mul_f32 v[230:231], v[230:231], s[54:55]
    v_cvt_pk_bf16_f32 v84, v224, v225
    v_cvt_pk_bf16_f32 v85, v226, v227
    v_cvt_pk_bf16_f32 v86, v228, v229
    v_cvt_pk_bf16_f32 v87, v230, v231
    v_pk_mul_f32 v[232:233], v[232:233], s[54:55]
    v_pk_mul_f32 v[234:235], v[234:235], s[54:55]
    v_pk_mul_f32 v[236:237], v[236:237], s[54:55]
    v_pk_mul_f32 v[238:239], v[238:239], s[54:55]
    v_cvt_pk_bf16_f32 v88, v232, v233
    v_cvt_pk_bf16_f32 v89, v234, v235
    v_cvt_pk_bf16_f32 v90, v236, v237
    v_cvt_pk_bf16_f32 v91, v238, v239
    v_pk_mul_f32 v[240:241], v[240:241], s[54:55]
    v_pk_mul_f32 v[242:243], v[242:243], s[54:55]
    v_pk_mul_f32 v[244:245], v[244:245], s[54:55]
    v_pk_mul_f32 v[246:247], v[246:247], s[54:55]
    v_cvt_pk_bf16_f32 v92, v240, v241
    v_cvt_pk_bf16_f32 v93, v242, v243
    v_cvt_pk_bf16_f32 v94, v244, v245
    v_cvt_pk_bf16_f32 v95, v246, v247
    s_cmp_lg_u32 s17, 0
    s_cbranch_scc1 A_NOSTASH
    s_lshl_b32 s50, s16, 14
    s_add_u32 s50, s50, 131072
    v_add_u32 v24, s50, v1
    ds_write_b128 v24, v[32:35] offset:0
    ds_write_b128 v24, v[36:39] offset:1024
    ds_write_b128 v24, v[40:43] offset:2048
    ds_write_b128 v24, v[44:47] offset:3072
    ds_write_b128 v24, v[48:51] offset:4096
    ds_write_b128 v24, v[52:55] offset:5120
    ds_write_b128 v24, v[56:59] offset:6144
    ds_write_b128 v24, v[60:63] offset:7168
    ds_write_b128 v24, v[64:67] offset:8192
    ds_write_b128 v24, v[68:71] offset:9216
    ds_write_b128 v24, v[72:75] offset:10240
    ds_write_b128 v24, v[76:79] offset:11264
    ds_write_b128 v24, v[80:83] offset:12288
    ds_write_b128 v24, v[84:87] offset:13312
    ds_write_b128 v24, v[88:91] offset:14336
    ds_write_b128 v24, v[92:95] offset:15360
A_NOSTASH:
    s_lshl_b32 s49, s18, 2
    s_lshl_b32 s50, s16, 1
    s_add_u32 s49, s49, s50
    s_lshl_b32 s52, s49, 18
    s_lshl_b32 s51, s4, 13
    s_add_u32 s52, s52, s51
    s_add_u32 s52, s52, 50331648
    s_mov_b32 s26, s52
    s_lshl_b32 s51, s16, 6
    v_and_b32 v20, 31, v0
    v_lshrrev_b32 v21, 5, v0
    v_lshlrev_b32 v21, 2, v21
    v_sub_u32 v20, v20, v21
    v_add_u32 v6, s51, v20
    v_add_u32 v7, 32, v6
    v_mov_b32 v160, 0
    v_mov_b32 v161, 0
    v_mov_b32 v162, 0
    v_mov_b32 v163, 0
    v_mov_b32 v176, 0
    v_mov_b32 v177, 0
    v_mov_b32 v178, 0
    v_mov_b32 v179, 0
    s_nop 0
    v_mfma_f32_32x32x16_bf16 v[192:207], v[160:163], v[160:163], 0
    v_mfma_f32_32x32x16_bf16 v[208:223], v[160:163], v[160:163], 0
    v_mov_b32 v136, v18
    v_mov_b32 v137, v18
    v_mov_b32 v138, v18
    v_mov_b32 v139, v18
    v_mov_b32 v140, v18
    v_mov_b32 v141, v18
    v_mov_b32 v142, v18
    v_mov_b32 v143, v18
    v_mov_b32 v144, v18
    v_mov_b32 v145, v18
    v_mov_b32 v146, v18
    v_mov_b32 v147, v18
    v_mov_b32 v148, v18
    v_mov_b32 v149, v18
    v_mov_b32 v150, v18
    v_mov_b32 v151, v18
    v_mov_b32 v152, v18
    v_mov_b32 v153, v18
    v_mov_b32 v154, v18
    v_mov_b32 v155, v18
    v_mov_b32 v156, v18
    v_mov_b32 v157, v18
    v_mov_b32 v158, v18
    v_mov_b32 v159, v18
    v_mov_b32 v10, 0
    v_mov_b32 v11, 0
    v_mov_b32 v12, 0
    v_mov_b32 v13, 0
    v_mov_b32 v8, v18
    v_mov_b32 v9, v18
    s_mov_b32 s25, 3
    v_cmp_gt_i32 vcc, 0, v20
    v_mov_b32 v240, v18
    s_nop 0
    v_cndmask_b32 v224, 0, v18, vcc
    v_cmp_gt_i32 vcc, 1, v20
    v_mov_b32 v241, v18
    s_nop 0
    v_cndmask_b32 v225, 0, v18, vcc
    v_cmp_gt_i32 vcc, 2, v20
    v_mov_b32 v242, v18
    s_nop 0
    v_cndmask_b32 v226, 0, v18, vcc
    v_cmp_gt_i32 vcc, 3, v20
    v_mov_b32 v243, v18
    s_nop 0
    v_cndmask_b32 v227, 0, v18, vcc
    v_cmp_gt_i32 vcc, 8, v20
    v_mov_b32 v244, v18
    s_nop 0
    v_cndmask_b32 v228, 0, v18, vcc
    v_cmp_gt_i32 vcc, 9, v20
    v_mov_b32 v245, v18
    s_nop 0
    v_cndmask_b32 v229, 0, v18, vcc
    v_cmp_gt_i32 vcc, 10, v20
    v_mov_b32 v246, v18
    s_nop 0
    v_cndmask_b32 v230, 0, v18, vcc
    v_cmp_gt_i32 vcc, 11, v20
    v_mov_b32 v247, v18
    s_nop 0
    v_cndmask_b32 v231, 0, v18, vcc
    v_cmp_gt_i32 vcc, 16, v20
    v_mov_b32 v248, v18
    s_nop 0
    v_cndmask_b32 v232, 0, v18, vcc
    v_cmp_gt_i32 vcc, 17, v20
    v_mov_b32 v249, v18
    s_nop 0
    v_cndmask_b32 v233, 0, v18, vcc
    v_cmp_gt_i32 vcc, 18, v20
    v_mov_b32 v250, v18
    s_nop 0
    v_cndmask_b32 v234, 0, v18, vcc
    v_cmp_gt_i32 vcc, 19, v20
    v_mov_b32 v251, v18
    s_nop 0
    v_cndmask_b32 v235, 0, v18, vcc
    v_cmp_gt_i32 vcc, 24, v20
    v_mov_b32 v252, v18
    s_nop 0
    v_cndmask_b32 v236, 0, v18, vcc
    v_cmp_gt_i32 vcc, 25, v20
    v_mov_b32 v253, v18
    s_nop 0
    v_cndmask_b32 v237, 0, v18, vcc
    v_cmp_gt_i32 vcc, 26, v20
    v_mov_b32 v254, v18
    s_nop 0
    v_cndmask_b32 v238, 0, v18, vcc
    v_cmp_gt_i32 vcc, 27, v20
    v_mov_b32 v255, v18
    s_nop 0
    v_cndmask_b32 v239, 0, v18, vcc
A_SEG:
    s_cmp_lg_u32 s33, 0
    s_cselect_b32 s48, s16, 0
    s_add_u32 s20, s20, s48
    s_cmp_eq_u32 s20, 0
    s_cbranch_scc1 A_MASKED
A_LOOP:
    s_waitcnt lgkmcnt(0)
    v_mfma_f32_32x32x16_bf16 v[96:111], a[128:131], v[32:35], v[192:207]
    v_exp_f32 v136, v136
    v_exp_f32 v137, v137
    v_add_f32 v12, v12, v136
    v_mfma_f32_32x32x16_bf16 v[96:111], a[132:135], v[36:39], v[96:111]
    v_exp_f32 v138, v138
    v_add_f32 v13, v13, v137
    v_cvt_pk_bf16_f32 v180, v136, v137
    v_exp_f32 v139, v139
    v_mfma_f32_32x32x16_bf16 v[96:111], a[136:139], v[40:43], v[96:111]
    v_add_f32 v12, v12, v138
    v_exp_f32 v140, v140
    v_add_f32 v13, v13, v139
    v_cvt_pk_bf16_f32 v181, v138, v139
    v_mfma_f32_32x32x16_bf16 v[96:111], a[140:143], v[44:47], v[96:111]
    v_exp_f32 v141, v141
    v_add_f32 v12, v12, v140
    v_exp_f32 v142, v142
    v_add_f32 v13, v13, v141
    v_mfma_f32_32x32x16_bf16 v[96:111], a[144:147], v[48:51], v[96:111]
    v_cvt_pk_bf16_f32 v182, v140, v141
    v_exp_f32 v143, v143
    v_add_f32 v12, v12, v142
    v_add_f32 v13, v13, v143
    v_cvt_pk_bf16_f32 v183, v142, v143
    v_mfma_f32_32x32x16_bf16 v[96:111], a[148:151], v[52:55], v[96:111]
    v_exp_f32 v144, v144
    v_exp_f32 v145, v145
    v_add_f32 v12, v12, v144
    v_mfma_f32_32x32x16_bf16 v[96:111], a[152:155], v[56:59], v[96:111]
    v_exp_f32 v146, v146
    v_add_f32 v13, v13, v145
    v_cvt_pk_bf16_f32 v184, v144, v145
    v_exp_f32 v147, v147
    v_mfma_f32_32x32x16_bf16 v[96:111], a[156:159], v[60:63], v[96:111]
    v_add_f32 v12, v12, v146
    v_exp_f32 v148, v148
    v_add_f32 v13, v13, v147
    v_cvt_pk_bf16_f32 v185, v146, v147
    v_mfma_f32_32x32x16_bf16 v[112:127], a[160:163], v[32:35], v[192:207]
    v_exp_f32 v149, v149
    v_add_f32 v12, v12, v148
    v_exp_f32 v150, v150
    v_add_f32 v13, v13, v149
    v_mfma_f32_32x32x16_bf16 v[112:127], a[164:167], v[36:39], v[112:127]
    v_cvt_pk_bf16_f32 v186, v148, v149
    v_exp_f32 v151, v151
    v_add_f32 v12, v12, v150
    v_add_f32 v13, v13, v151
    v_cvt_pk_bf16_f32 v187, v150, v151
    v_mfma_f32_32x32x16_bf16 v[112:127], a[168:171], v[40:43], v[112:127]
    v_exp_f32 v152, v152
    v_exp_f32 v153, v153
    v_add_f32 v12, v12, v152
    v_max3_f32 v14, v96, v97, v98
    v_mfma_f32_32x32x16_bf16 v[112:127], a[172:175], v[44:47], v[112:127]
    v_exp_f32 v154, v154
    v_add_f32 v13, v13, v153
    v_cvt_pk_bf16_f32 v188, v152, v153
    v_exp_f32 v155, v155
    v_mfma_f32_32x32x16_bf16 v[112:127], a[176:179], v[48:51], v[112:127]
    v_add_f32 v12, v12, v154
    v_exp_f32 v156, v156
    v_add_f32 v13, v13, v155
    v_cvt_pk_bf16_f32 v189, v154, v155
    v_max3_f32 v14, v14, v99, v100
    v_mfma_f32_32x32x16_bf16 v[112:127], a[180:183], v[52:55], v[112:127]
    v_exp_f32 v157, v157
    v_add_f32 v12, v12, v156
    v_exp_f32 v158, v158
    v_add_f32 v13, v13, v157
    v_mfma_f32_32x32x16_bf16 v[112:127], a[184:187], v[56:59], v[112:127]
    s_waitcnt vmcnt(0)
    s_barrier
    v_cvt_pk_bf16_f32 v190, v156, v157
    v_exp_f32 v159, v159
    v_add_f32 v12, v12, v158
    v_mfma_f32_32x32x16_bf16 v[112:127], a[188:191], v[60:63], v[112:127]
    s_add_u32 m0, s24, 0
    s_add_u32 s48, s22, 0
    buffer_load_dwordx4 v2, s[68:71], s48 offen sc1 lds
    v_add_f32 v13, v13, v159
    v_cvt_pk_bf16_f32 v191, v158, v159
    v_max3_f32 v14, v14, v101, v102
    v_mfma_f32_32x32x16_bf16 a[64:79], a[192:195], v[176:179], a[64:79]
    ds_read_b128 a[192:195], v5 offset:16384
    v_max3_f32 v14, v14, v103, v104
    v_max3_f32 v14, v14, v105, v106
    v_max3_f32 v14, v14, v107, v108
    v_max3_f32 v14, v14, v109, v110
    v_max_f32 v14, v14, v111
    v_mfma_f32_32x32x16_bf16 a[80:95], a[196:199], v[176:179], a[80:95]
    buffer_load_dwordx4 v2, s[68:71], s48 offen offset:1024 sc1 lds
    ds_read_b128 a[196:199], v5 offset:17408
    v_mfma_f32_32x32x16_bf16 a[96:111], a[200:203], v[176:179], a[96:111]
    ds_read_b128 a[200:203], v5 offset:18432
    v_max3_f32 v15, v112, v113, v114
    v_max3_f32 v15, v15, v115, v116
    v_max3_f32 v15, v15, v117, v118
    v_max3_f32 v15, v15, v119, v120
    v_max3_f32 v15, v15, v121, v122
    v_mfma_f32_32x32x16_bf16 a[112:127], a[204:207], v[176:179], a[112:127]
    ds_read_b128 a[204:207], v5 offset:19456
    v_max3_f32 v15, v15, v123, v124
    v_max3_f32 v15, v15, v125, v126
    v_max3_f32 v14, v14, v15, v127
    v_mov_b32 v15, v14
    v_mfma_f32_32x32x16_bf16 a[64:79], a[208:211], v[180:183], a[64:79]
    buffer_load_dwordx4 v3, s[68:71], s48 offen offset:2048 sc1 lds
    ds_read_b128 a[208:211], v5 offset:20480
    s_nop 1
    v_permlane32_swap_b32 v15, v14
    v_max_f32 v14, v14, v15
    v_mfma_f32_32x32x16_bf16 a[80:95], a[212:215], v[180:183], a[80:95]
    ds_read_b128 a[212:215], v5 offset:21504
    v_cmp_gt_f32 vcc, v14, v8
    s_cbranch_vccnz A_TR0
A_RT0:
    v_exp_f32 v96, v96
    v_mfma_f32_32x32x16_bf16 a[96:111], a[216:219], v[180:183], a[96:111]
    buffer_load_dwordx4 v3, s[68:71], s48 offen offset:3072 sc1 lds
    ds_read_b128 a[216:219], v5 offset:22528
    v_exp_f32 v97, v97
    v_add_f32 v10, v10, v96
    v_mfma_f32_32x32x16_bf16 a[112:127], a[220:223], v[180:183], a[112:127]
    ds_read_b128 a[220:223], v5 offset:23552
    v_exp_f32 v98, v98
    v_add_f32 v11, v11, v97
    v_cvt_pk_bf16_f32 v160, v96, v97
    v_mfma_f32_32x32x16_bf16 a[64:79], a[224:227], v[184:187], a[64:79]
    ds_read_b128 a[224:227], v5 offset:24576
    v_exp_f32 v99, v99
    v_add_f32 v10, v10, v98
    v_exp_f32 v100, v100
    v_mfma_f32_32x32x16_bf16 a[80:95], a[228:231], v[184:187], a[80:95]
    s_add_u32 m0, s24, 4096
    s_add_u32 s48, s22, 4096
    buffer_load_dwordx4 v2, s[68:71], s48 offen sc1 lds
    ds_read_b128 a[228:231], v5 offset:25600
    v_add_f32 v11, v11, v99
    v_cvt_pk_bf16_f32 v161, v98, v99
    v_mfma_f32_32x32x16_bf16 a[96:111], a[232:235], v[184:187], a[96:111]
    ds_read_b128 a[232:235], v5 offset:26624
    v_exp_f32 v101, v101
    v_add_f32 v10, v10, v100
    v_exp_f32 v102, v102
    v_mfma_f32_32x32x16_bf16 a[112:127], a[236:239], v[184:187], a[112:127]
    buffer_load_dwordx4 v2, s[68:71], s48 offen offset:1024 sc1 lds
    ds_read_b128 a[236:239], v5 offset:27648
    v_add_f32 v11, v11, v101
    v_cvt_pk_bf16_f32 v162, v100, v101
    v_mfma_f32_32x32x16_bf16 a[64:79], a[240:243], v[188:191], a[64:79]
    ds_read_b128 a[240:243], v5 offset:28672
    v_exp_f32 v103, v103
    v_add_f32 v10, v10, v102
    v_add_f32 v11, v11, v103
    v_cvt_pk_bf16_f32 v163, v102, v103
    v_mfma_f32_32x32x16_bf16 a[80:95], a[244:247], v[188:191], a[80:95]
    ds_read_b128 a[244:247], v5 offset:29696
    v_exp_f32 v104, v104
    v_exp_f32 v105, v105
    v_add_f32 v10, v10, v104
    v_mfma_f32_32x32x16_bf16 a[96:111], a[248:251], v[188:191], a[96:111]
    buffer_load_dwordx4 v3, s[68:71], s48 offen offset:2048 sc1 lds
    ds_read_b128 a[248:251], v5 offset:30720
    v_exp_f32 v106, v106
    v_add_f32 v11, v11, v105
    v_mfma_f32_32x32x16_bf16 a[112:127], a[252:255], v[188:191], a[112:127]
    ds_read_b128 a[252:255], v5 offset:31744
    v_cvt_pk_bf16_f32 v164, v104, v105
    v_exp_f32 v107, v107
    v_add_f32 v10, v10, v106
    v_mfma_f32_32x32x16_bf16 v[128:143], a[128:131], v[64:67], v[208:223]
    buffer_load_dwordx4 v3, s[68:71], s48 offen offset:3072 sc1 lds
    ds_read_b128 a[128:131], v4 offset:0
    v_exp_f32 v108, v108
    v_add_f32 v11, v11, v107
    v_mfma_f32_32x32x16_bf16 v[128:143], a[132:135], v[68:71], v[128:143]
    ds_read_b128 a[132:135], v4 offset:1024
    v_cvt_pk_bf16_f32 v165, v106, v107
    v_exp_f32 v109, v109
    v_add_f32 v10, v10, v108
    v_mfma_f32_32x32x16_bf16 v[128:143], a[136:139], v[72:75], v[128:143]
    ds_read_b128 a[136:139], v4 offset:2048
    v_exp_f32 v110, v110
    v_add_f32 v11, v11, v109
    v_cvt_pk_bf16_f32 v166, v108, v109
    v_mfma_f32_32x32x16_bf16 v[128:143], a[140:143], v[76:79], v[128:143]
    s_sub_u32 s31, s31, 1
    s_cmp_eq_u32 s31, 0
    s_cselect_b32 s48, s32, 16384
    s_add_u32 s22, s22, s48
    s_xor_b32 s24, s24, 32768
    ds_read_b128 a[140:143], v4 offset:3072
    v_exp_f32 v111, v111
    v_mfma_f32_32x32x16_bf16 v[128:143], a[144:147], v[80:83], v[128:143]
    ds_read_b128 a[144:147], v4 offset:4096
    v_add_f32 v10, v10, v110
    v_add_f32 v11, v11, v111
    v_cvt_pk_bf16_f32 v167, v110, v111
    v_exp_f32 v112, v112
    v_mfma_f32_32x32x16_bf16 v[128:143], a[148:151], v[84:87], v[128:143]
    s_add_u32 m0, s23, 0
    s_add_u32 s48, s21, 0
    buffer_load_dwordx4 v1, s[68:71], s48 offen sc1 lds
    ds_read_b128 a[148:151], v4 offset:5120
    v_exp_f32 v113, v113
    v_mfma_f32_32x32x16_bf16 v[128:143], a[152:155], v[88:91], v[128:143]
    ds_read_b128 a[152:155], v4 offset:6144
    v_add_f32 v10, v10, v112
    v_exp_f32 v114, v114
    v_add_f32 v11, v11, v113
    v_cvt_pk_bf16_f32 v168, v112, v113
    v_mfma_f32_32x32x16_bf16 v[128:143], a[156:159], v[92:95], v[128:143]
    ds_read_b128 a[156:159], v4 offset:7168
    v_exp_f32 v115, v115
    v_add_f32 v10, v10, v114
    v_exp_f32 v116, v116
    v_mfma_f32_32x32x16_bf16 v[144:159], a[160:163], v[64:67], v[208:223]
    buffer_load_dwordx4 v1, s[68:71], s48 offen offset:1024 sc1 lds
    ds_read_b128 a[160:163], v4 offset:8192
    v_add_f32 v11, v11, v115
    v_cvt_pk_bf16_f32 v169, v114, v115
    v_mfma_f32_32x32x16_bf16 v[144:159], a[164:167], v[68:71], v[144:159]
    ds_read_b128 a[164:167], v4 offset:9216
    v_exp_f32 v117, v117
    v_add_f32 v10, v10, v116
    v_exp_f32 v118, v118
    v_mfma_f32_32x32x16_bf16 v[144:159], a[168:171], v[72:75], v[144:159]
    buffer_load_dwordx4 v1, s[68:71], s48 offen offset:2048 sc1 lds
    ds_read_b128 a[168:171], v4 offset:10240
    v_add_f32 v11, v11, v117
    v_cvt_pk_bf16_f32 v170, v116, v117
    v_max3_f32 v16, v128, v129, v130
    v_mfma_f32_32x32x16_bf16 v[144:159], a[172:175], v[76:79], v[144:159]
    ds_read_b128 a[172:175], v4 offset:11264
    v_exp_f32 v119, v119
    v_add_f32 v10, v10, v118
    v_add_f32 v11, v11, v119
    v_cvt_pk_bf16_f32 v171, v118, v119
    v_mfma_f32_32x32x16_bf16 v[144:159], a[176:179], v[80:83], v[144:159]
    ds_read_b128 a[176:179], v4 offset:12288
    v_exp_f32 v120, v120
    v_exp_f32 v121, v121
    v_add_f32 v10, v10, v120
    v_mfma_f32_32x32x16_bf16 v[144:159], a[180:183], v[84:87], v[144:159]
    buffer_load_dwordx4 v1, s[68:71], s48 offen offset:3072 sc1 lds
    ds_read_b128 a[180:183], v4 offset:13312
    v_exp_f32 v122, v122
    v_add_f32 v11, v11, v121
    v_mfma_f32_32x32x16_bf16 v[144:159], a[184:187], v[88:91], v[144:159]
    ds_read_b128 a[184:187], v4 offset:14336
    v_cvt_pk_bf16_f32 v172, v120, v121
    v_exp_f32 v123, v123
    v_add_f32 v10, v10, v122
    v_max3_f32 v16, v16, v131, v132
    v_mfma_f32_32x32x16_bf16 v[144:159], a[188:191], v[92:95], v[144:159]
    s_add_u32 m0, s23, 4096
    s_add_u32 s48, s21, 4096
    buffer_load_dwordx4 v1, s[68:71], s48 offen sc1 lds
    ds_read_b128 a[188:191], v4 offset:15360
    v_exp_f32 v124, v124
    s_waitcnt lgkmcnt(15)
    v_mfma_f32_32x32x16_bf16 a[0:15], a[192:195], v[160:163], a[0:15]
    v_add_f32 v11, v11, v123
    v_cvt_pk_bf16_f32 v173, v122, v123
    v_exp_f32 v125, v125
    v_add_f32 v10, v10, v124
    v_max3_f32 v16, v16, v133, v134
    v_mfma_f32_32x32x16_bf16 a[16:31], a[196:199], v[160:163], a[16:31]
    v_exp_f32 v126, v126
    v_add_f32 v11, v11, v125
    v_cvt_pk_bf16_f32 v174, v124, v125
    v_exp_f32 v127, v127
    v_mfma_f32_32x32x16_bf16 a[32:47], a[200:203], v[160:163], a[32:47]
    buffer_load_dwordx4 v1, s[68:71], s48 offen offset:1024 sc1 lds
    v_add_f32 v10, v10, v126
    v_add_f32 v11, v11, v127
    v_cvt_pk_bf16_f32 v175, v126, v127
    v_max3_f32 v16, v16, v135, v136
    v_mfma_f32_32x32x16_bf16 a[48:63], a[204:207], v[160:163], a[48:63]
    v_max3_f32 v16, v16, v137, v138
    v_max3_f32 v16, v16, v139, v140
    v_max3_f32 v16, v16, v141, v142
    v_max_f32 v16, v16, v143
    v_max3_f32 v17, v144, v145, v146
    v_max3_f32 v17, v17, v147, v148
    v_mfma_f32_32x32x16_bf16 a[0:15], a[208:211], v[164:167], a[0:15]
    buffer_load_dwordx4 v1, s[68:71], s48 offen offset:2048 sc1 lds
    v_max3_f32 v17, v17, v149, v150
    v_max3_f32 v17, v17, v151, v152
    v_max3_f32 v17, v17, v153, v154
    v_max3_f32 v17, v17, v155, v156
    v_mfma_f32_32x32x16_bf16 a[16:31], a[212:215], v[164:167], a[16:31]
    v_max3_f32 v17, v17, v157, v158
    v_max3_f32 v16, v16, v17, v159
    v_mov_b32 v17, v16
    s_nop 1
    v_permlane32_swap_b32 v17, v16
    v_max_f32 v16, v16, v17
    v_mfma_f32_32x32x16_bf16 a[32:47], a[216:219], v[164:167], a[32:47]
    v_cmp_gt_f32 vcc, v16, v9
    s_cbranch_vccnz A_TR1
A_RT1:
    v_exp_f32 v128, v128
    v_exp_f32 v129, v129
    v_mfma_f32_32x32x16_bf16 a[48:63], a[220:223], v[164:167], a[48:63]
    buffer_load_dwordx4 v1, s[68:71], s48 offen offset:3072 sc1 lds
    v_add_f32 v12, v12, v128
    v_exp_f32 v130, v130
    v_add_f32 v13, v13, v129
    v_mfma_f32_32x32x16_bf16 a[0:15], a[224:227], v[168:171], a[0:15]
    v_cvt_pk_bf16_f32 v176, v128, v129
    v_exp_f32 v131, v131
    v_add_f32 v12, v12, v130
    v_exp_f32 v132, v132
    v_mfma_f32_32x32x16_bf16 a[16:31], a[228:231], v[168:171], a[16:31]
    s_sub_u32 s30, s30, 1
    s_cmp_eq_u32 s30, 0
    s_cselect_b32 s48, s32, 16384
    s_add_u32 s21, s21, s48
    s_xor_b32 s23, s23, 32768
    v_add_f32 v13, v13, v131
    v_cvt_pk_bf16_f32 v177, v130, v131
    v_mfma_f32_32x32x16_bf16 a[32:47], a[232:235], v[168:171], a[32:47]
    v_exp_f32 v133, v133
    v_add_f32 v12, v12, v132
    v_exp_f32 v134, v134
    v_add_f32 v13, v13, v133
    v_mfma_f32_32x32x16_bf16 a[48:63], a[236:239], v[168:171], a[48:63]
    v_cvt_pk_bf16_f32 v178, v132, v133
    v_exp_f32 v135, v135
    v_add_f32 v12, v12, v134
    v_add_f32 v13, v13, v135
    v_cvt_pk_bf16_f32 v179, v134, v135
    v_mfma_f32_32x32x16_bf16 a[0:15], a[240:243], v[172:175], a[0:15]
    v_xor_b32 v5, 32768, v5
    v_mfma_f32_32x32x16_bf16 a[16:31], a[244:247], v[172:175], a[16:31]
    v_mfma_f32_32x32x16_bf16 a[32:47], a[248:251], v[172:175], a[32:47]
    v_xor_b32 v4, 32768, v4
    v_mfma_f32_32x32x16_bf16 a[48:63], a[252:255], v[172:175], a[48:63]
    s_mov_b32 s25, 0
    s_sub_u32 s20, s20, 1
    s_cmp_lg_u32 s20, 0
    s_cbranch_scc1 A_LOOP
A_MASKED:
    s_cmp_eq_u32 s33, 0
    s_cbranch_scc1 A_SEGEND
    s_waitcnt lgkmcnt(0)
    v_add_f32 v96, v192, v224
    v_add_f32 v97, v193, v225
    v_add_f32 v98, v194, v226
    v_add_f32 v99, v195, v227
    v_add_f32 v100, v196, v228
    v_add_f32 v101, v197, v229
    v_add_f32 v102, v198, v230
    v_add_f32 v103, v199, v231
    v_add_f32 v104, v200, v232
    v_add_f32 v105, v201, v233
    v_add_f32 v106, v202, v234
    v_add_f32 v107, v203, v235
    v_add_f32 v108, v204, v236
    v_add_f32 v109, v205, v237
    v_add_f32 v110, v206, v238
    v_add_f32 v111, v207, v239
    s_nop 1
    v_mfma_f32_32x32x16_bf16 v[96:111], a[128:131], v[32:35], v[96:111]
    v_exp_f32 v136, v136
    v_exp_f32 v137, v137
    v_add_f32 v12, v12, v136
    v_mfma_f32_32x32x16_bf16 v[96:111], a[132:135], v[36:39], v[96:111]
    v_exp_f32 v138, v138
    v_add_f32 v13, v13, v137
    v_cvt_pk_bf16_f32 v180, v136, v137
    v_exp_f32 v139, v139
    v_mfma_f32_32x32x16_bf16 v[96:111], a[136:139], v[40:43], v[96:111]
    v_add_f32 v12, v12, v138
    v_exp_f32 v140, v140
    v_add_f32 v13, v13, v139
    v_cvt_pk_bf16_f32 v181, v138, v139
    v_mfma_f32_32x32x16_bf16 v[96:111], a[140:143], v[44:47], v[96:111]
    v_exp_f32 v141, v141
    v_add_f32 v12, v12, v140
    v_exp_f32 v142, v142
    v_add_f32 v13, v13, v141
    v_mfma_f32_32x32x16_bf16 v[96:111], a[144:147], v[48:51], v[96:111]
    v_cvt_pk_bf16_f32 v182, v140, v141
    v_exp_f32 v143, v143
    v_add_f32 v12, v12, v142
    v_add_f32 v13, v13, v143
    v_cvt_pk_bf16_f32 v183, v142, v143
    v_mfma_f32_32x32x16_bf16 v[96:111], a[148:151], v[52:55], v[96:111]
    v_exp_f32 v144, v144
    v_exp_f32 v145, v145
    v_add_f32 v12, v12, v144
    v_mfma_f32_32x32x16_bf16 v[96:111], a[152:155], v[56:59], v[96:111]
    v_exp_f32 v146, v146
    v_add_f32 v13, v13, v145
    v_cvt_pk_bf16_f32 v184, v144, v145
    v_exp_f32 v147, v147
    v_mfma_f32_32x32x16_bf16 v[96:111], a[156:159], v[60:63], v[96:111]
    v_add_f32 v12, v12, v146
    v_exp_f32 v148, v148
    v_add_f32 v13, v13, v147
    v_cvt_pk_bf16_f32 v185, v146, v147
    v_mfma_f32_32x32x16_bf16 v[112:127], a[160:163], v[32:35], v[240:255]
    v_exp_f32 v149, v149
    v_add_f32 v12, v12, v148
    v_exp_f32 v150, v150
    v_add_f32 v13, v13, v149
    v_mfma_f32_32x32x16_bf16 v[112:127], a[164:167], v[36:39], v[112:127]
    v_cvt_pk_bf16_f32 v186, v148, v149
    v_exp_f32 v151, v151
    v_add_f32 v12, v12, v150
    v_add_f32 v13, v13, v151
    v_cvt_pk_bf16_f32 v187, v150, v151
    v_mfma_f32_32x32x16_bf16 v[112:127], a[168:171], v[40:43], v[112:127]
    v_exp_f32 v152, v152
    v_exp_f32 v153, v153
    v_add_f32 v12, v12, v152
    v_max3_f32 v14, v96, v97, v98
    v_mfma_f32_32x32x16_bf16 v[112:127], a[172:175], v[44:47], v[112:127]
    v_exp_f32 v154, v154
    v_add_f32 v13, v13, v153
    v_cvt_pk_bf16_f32 v188, v152, v153
    v_exp_f32 v155, v155
    v_mfma_f32_32x32x16_bf16 v[112:127], a[176:179], v[48:51], v[112:127]
    v_add_f32 v12, v12, v154
    v_exp_f32 v156, v156
    v_add_f32 v13, v13, v155
    v_cvt_pk_bf16_f32 v189, v154, v155
    v_max3_f32 v14, v14, v99, v100
    v_mfma_f32_32x32x16_bf16 v[112:127], a[180:183], v[52:55], v[112:127]
    v_exp_f32 v157, v157
    v_add_f32 v12, v12, v156
    v_exp_f32 v158, v158
    v_add_f32 v13, v13, v157
    v_mfma_f32_32x32x16_bf16 v[112:127], a[184:187], v[56:59], v[112:127]
    s_waitcnt vmcnt(0)
    s_barrier
    v_cvt_pk_bf16_f32 v190, v156, v157
    v_exp_f32 v159, v159
    v_add_f32 v12, v12, v158
    v_mfma_f32_32x32x16_bf16 v[112:127], a[188:191], v[60:63], v[112:127]
    s_add_u32 m0, s24, 0
    s_add_u32 s48, s22, 0
    buffer_load_dwordx4 v2, s[68:71], s48 offen sc1 lds
    v_add_f32 v13, v13, v159
    v_cvt_pk_bf16_f32 v191, v158, v159
    v_add_f32 v144, v208, v224
    v_mfma_f32_32x32x16_bf16 a[64:79], a[192:195], v[176:179], a[64:79]
    ds_read_b128 a[192:195], v5 offset:16384
    v_add_f32 v145, v209, v225
    v_add_f32 v146, v210, v226
    v_add_f32 v147, v211, v227
    v_add_f32 v148, v212, v228
    v_add_f32 v149, v213, v229
    v_mfma_f32_32x32x16_bf16 a[80:95], a[196:199], v[176:179], a[80:95]
    buffer_load_dwordx4 v2, s[68:71], s48 offen offset:1024 sc1 lds
    ds_read_b128 a[196:199], v5 offset:17408
    v_add_f32 v150, v214, v230
    v_add_f32 v151, v215, v231
    v_add_f32 v152, v216, v232
    v_mfma_f32_32x32x16_bf16 a[96:111], a[200:203], v[176:179], a[96:111]
    ds_read_b128 a[200:203], v5 offset:18432
    v_add_f32 v153, v217, v233
    v_add_f32 v154, v218, v234
    v_add_f32 v155, v219, v235
    v_add_f32 v156, v220, v236
    v_add_f32 v157, v221, v237
    v_mfma_f32_32x32x16_bf16 a[112:127], a[204:207], v[176:179], a[112:127]
    ds_read_b128 a[204:207], v5 offset:19456
    v_add_f32 v158, v222, v238
    v_add_f32 v159, v223, v239
    v_max3_f32 v14, v14, v101, v102
    v_max3_f32 v14, v14, v103, v104
    v_max3_f32 v14, v14, v105, v106
    v_mfma_f32_32x32x16_bf16 a[64:79], a[208:211], v[180:183], a[64:79]
    buffer_load_dwordx4 v3, s[68:71], s48 offen offset:2048 sc1 lds
    ds_read_b128 a[208:211], v5 offset:20480
    v_max3_f32 v14, v14, v107, v108
    v_max3_f32 v14, v14, v109, v110
    v_max_f32 v14, v14, v111
    v_mfma_f32_32x32x16_bf16 a[80:95], a[212:215], v[180:183], a[80:95]
    ds_read_b128 a[212:215], v5 offset:21504
    v_max3_f32 v15, v112, v113, v114
    v_max3_f32 v15, v15, v115, v116
    v_max3_f32 v15, v15, v117, v118
    v_max3_f32 v15, v15, v119, v120
    v_max3_f32 v15, v15, v121, v122
    v_mfma_f32_32x32x16_bf16 a[96:111], a[216:219], v[180:183], a[96:111]
    buffer_load_dwordx4 v3, s[68:71], s48 offen offset:3072 sc1 lds
    ds_read_b128 a[216:219], v5 offset:22528
    v_max3_f32 v15, v15, v123, v124
    v_max3_f32 v15, v15, v125, v126
    v_max3_f32 v14, v14, v15, v127
    v_mfma_f32_32x32x16_bf16 a[112:127], a[220:223], v[180:183], a[112:127]
    ds_read_b128 a[220:223], v5 offset:23552
    v_mov_b32 v15, v14
    s_nop 1
    v_permlane32_swap_b32 v15, v14
    v_max_f32 v14, v14, v15
    v_mfma_f32_32x32x16_bf16 a[64:79], a[224:227], v[184:187], a[64:79]
    ds_read_b128 a[224:227], v5 offset:24576
    v_cmp_gt_f32 vcc, v14, v8
    s_cbranch_vccnz A_TR2
A_RT2:
    v_exp_f32 v96, v96
    v_mfma_f32_32x32x16_bf16 a[80:95], a[228:231], v[184:187], a[80:95]
    s_add_u32 m0, s24, 4096
    s_add_u32 s48, s22, 4096
    buffer_load_dwordx4 v2, s[68:71], s48 offen sc1 lds
    ds_read_b128 a[228:231], v5 offset:25600
    v_exp_f32 v97, v97
    v_mfma_f32_32x32x16_bf16 a[96:111], a[232:235], v[184:187], a[96:111]
    ds_read_b128 a[232:235], v5 offset:26624
    v_add_f32 v10, v10, v96
    v_exp_f32 v98, v98
    v_add_f32 v11, v11, v97
    v_cvt_pk_bf16_f32 v160, v96, v97
    v_mfma_f32_32x32x16_bf16 a[112:127], a[236:239], v[184:187], a[112:127]
    buffer_load_dwordx4 v2, s[68:71], s48 offen offset:1024 sc1 lds
    ds_read_b128 a[236:239], v5 offset:27648
    v_exp_f32 v99, v99
    v_add_f32 v10, v10, v98
    v_mfma_f32_32x32x16_bf16 a[64:79], a[240:243], v[188:191], a[64:79]
    ds_read_b128 a[240:243], v5 offset:28672
    v_exp_f32 v100, v100
    v_add_f32 v11, v11, v99
    v_cvt_pk_bf16_f32 v161, v98, v99
    v_mfma_f32_32x32x16_bf16 a[80:95], a[244:247], v[188:191], a[80:95]
    ds_read_b128 a[244:247], v5 offset:29696
    v_exp_f32 v101, v101
    v_add_f32 v10, v10, v100
    v_exp_f32 v102, v102
    v_mfma_f32_32x32x16_bf16 a[96:111], a[248:251], v[188:191], a[96:111]
    buffer_load_dwordx4 v3, s[68:71], s48 offen offset:2048 sc1 lds
    ds_read_b128 a[248:251], v5 offset:30720
    v_add_f32 v11, v11, v101
    v_cvt_pk_bf16_f32 v162, v100, v101
    v_mfma_f32_32x32x16_bf16 a[112:127], a[252:255], v[188:191], a[112:127]
    ds_read_b128 a[252:255], v5 offset:31744
    v_exp_f32 v103, v103
    v_add_f32 v10, v10, v102
    v_add_f32 v11, v11, v103
    v_cvt_pk_bf16_f32 v163, v102, v103
    v_mfma_f32_32x32x16_bf16 v[128:143], a[128:131], v[64:67], v[208:223]
    buffer_load_dwordx4 v3, s[68:71], s48 offen offset:3072 sc1 lds
    ds_read_b128 a[128:131], v4 offset:0
    v_exp_f32 v104, v104
    v_mfma_f32_32x32x16_bf16 v[128:143], a[132:135], v[68:71], v[128:143]
    ds_read_b128 a[132:135], v4 offset:1024
    v_exp_f32 v105, v105
    v_add_f32 v10, v10, v104
    v_exp_f32 v106, v106
    v_mfma_f32_32x32x16_bf16 v[128:143], a[136:139], v[72:75], v[128:143]
    ds_read_b128 a[136:139], v4 offset:2048
    v_add_f32 v11, v11, v105
    v_cvt_pk_bf16_f32 v164, v104, v105
    v_exp_f32 v107, v107
    v_add_f32 v10, v10, v106
    v_mfma_f32_32x32x16_bf16 v[128:143], a[140:143], v[76:79], v[128:143]
    s_sub_u32 s31, s31, 1
    s_cmp_eq_u32 s31, 0
    s_cselect_b32 s48, s32, 16384
    s_add_u32 s22, s22, s48
    s_xor_b32 s24, s24, 32768
    ds_read_b128 a[140:143], v4 offset:3072
    v_exp_f32 v108, v108
    v_mfma_f32_32x32x16_bf16 v[128:143], a[144:147], v[80:83], v[128:143]
    ds_read_b128 a[144:147], v4 offset:4096
    v_add_f32 v11, v11, v107
    v_cvt_pk_bf16_f32 v165, v106, v107
    v_exp_f32 v109, v109
    v_add_f32 v10, v10, v108
    v_mfma_f32_32x32x16_bf16 v[128:143], a[148:151], v[84:87], v[128:143]
    s_add_u32 m0, s23, 0
    s_add_u32 s48, s21, 0
    buffer_load_dwordx4 v1, s[68:71], s48 offen sc1 lds
    ds_read_b128 a[148:151], v4 offset:5120
    v_exp_f32 v110, v110
    v_mfma_f32_32x32x16_bf16 v[128:143], a[152:155], v[88:91], v[128:143]
    ds_read_b128 a[152:155], v4 offset:6144
    v_add_f32 v11, v11, v109
    v_cvt_pk_bf16_f32 v166, v108, v109
    v_exp_f32 v111, v111
    v_add_f32 v10, v10, v110
    v_mfma_f32_32x32x16_bf16 v[128:143], a[156:159], v[92:95], v[128:143]
    ds_read_b128 a[156:159], v4 offset:7168
    v_add_f32 v11, v11, v111
    v_cvt_pk_bf16_f32 v167, v110, v111
    v_exp_f32 v112, v112
    v_mfma_f32_32x32x16_bf16 v[144:159], a[160:163], v[64:67], v[144:159]
    buffer_load_dwordx4 v1, s[68:71], s48 offen offset:1024 sc1 lds
    ds_read_b128 a[160:163], v4 offset:8192
    v_exp_f32 v113, v113
    v_add_f32 v10, v10, v112
    v_mfma_f32_32x32x16_bf16 v[144:159], a[164:167], v[68:71], v[144:159]
    ds_read_b128 a[164:167], v4 offset:9216
    v_exp_f32 v114, v114
    v_add_f32 v11, v11, v113
    v_cvt_pk_bf16_f32 v168, v112, v113
    v_mfma_f32_32x32x16_bf16 v[144:159], a[168:171], v[72:75], v[144:159]
    buffer_load_dwordx4 v1, s[68:71], s48 offen offset:2048 sc1 lds
    ds_read_b128 a[168:171], v4 offset:10240
    v_exp_f32 v115, v115
    v_add_f32 v10, v10, v114
    v_mfma_f32_32x32x16_bf16 v[144:159], a[172:175], v[76:79], v[144:159]
    ds_read_b128 a[172:175], v4 offset:11264
    v_exp_f32 v116, v116
    v_add_f32 v11, v11, v115
    v_cvt_pk_bf16_f32 v169, v114, v115
    v_max3_f32 v16, v128, v129, v130
    v_mfma_f32_32x32x16_bf16 v[144:159], a[176:179], v[80:83], v[144:159]
    ds_read_b128 a[176:179], v4 offset:12288
    v_exp_f32 v117, v117
    v_add_f32 v10, v10, v116
    v_exp_f32 v118, v118
    v_mfma_f32_32x32x16_bf16 v[144:159], a[180:183], v[84:87], v[144:159]
    buffer_load_dwordx4 v1, s[68:71], s48 offen offset:3072 sc1 lds
    ds_read_b128 a[180:183], v4 offset:13312
    v_add_f32 v11, v11, v117
    v_cvt_pk_bf16_f32 v170, v116, v117
    v_max3_f32 v16, v16, v131, v132
    v_mfma_f32_32x32x16_bf16 v[144:159], a[184:187], v[88:91], v[144:159]
    ds_read_b128 a[184:187], v4 offset:14336
    v_exp_f32 v119, v119
    v_add_f32 v10, v10, v118
    v_add_f32 v11, v11, v119
    v_cvt_pk_bf16_f32 v171, v118, v119
    v_mfma_f32_32x32x16_bf16 v[144:159], a[188:191], v[92:95], v[144:159]
    s_add_u32 m0, s23, 4096
    s_add_u32 s48, s21, 4096
    buffer_load_dwordx4 v1, s[68:71], s48 offen sc1 lds
    ds_read_b128 a[188:191], v4 offset:15360
    v_exp_f32 v120, v120
    s_waitcnt lgkmcnt(15)
    v_mfma_f32_32x32x16_bf16 a[0:15], a[192:195], v[160:163], a[0:15]
    v_exp_f32 v121, v121
    v_add_f32 v10, v10, v120
    v_exp_f32 v122, v122
    v_add_f32 v11, v11, v121
    v_mfma_f32_32x32x16_bf16 a[16:31], a[196:199], v[160:163], a[16:31]
    v_cvt_pk_bf16_f32 v172, v120, v121
    v_exp_f32 v123, v123
    v_add_f32 v10, v10, v122
    v_exp_f32 v124, v124
    v_mfma_f32_32x32x16_bf16 a[32:47], a[200:203], v[160:163], a[32:47]
    buffer_load_dwordx4 v1, s[68:71], s48 offen offset:1024 sc1 lds
    v_add_f32 v11, v11, v123
    v_cvt_pk_bf16_f32 v173, v122, v123
    v_exp_f32 v125, v125
    v_mfma_f32_32x32x16_bf16 a[48:63], a[204:207], v[160:163], a[48:63]
    v_add_f32 v10, v10, v124
    v_exp_f32 v126, v126
    v_add_f32 v11, v11, v125
    v_cvt_pk_bf16_f32 v174, v124, v125
    v_max3_f32 v16, v16, v133, v134
    v_mfma_f32_32x32x16_bf16 a[0:15], a[208:211], v[164:167], a[0:15]
    buffer_load_dwordx4 v1, s[68:71], s48 offen offset:2048 sc1 lds
    v_exp_f32 v127, v127
    v_add_f32 v10, v10, v126
    v_add_f32 v11, v11, v127
    v_mfma_f32_32x32x16_bf16 a[16:31], a[212:215], v[164:167], a[16:31]
    v_cvt_pk_bf16_f32 v175, v126, v127
    v_max3_f32 v16, v16, v135, v136
    v_max3_f32 v16, v16, v137, v138
    v_max3_f32 v16, v16, v139, v140
    v_max3_f32 v16, v16, v141, v142
    v_max_f32 v16, v16, v143
    v_mfma_f32_32x32x16_bf16 a[32:47], a[216:219], v[164:167], a[32:47]
    v_max3_f32 v17, v144, v145, v146
    v_max3_f32 v17, v17, v147, v148
    v_max3_f32 v17, v17, v149, v150
    v_max3_f32 v17, v17, v151, v152
    v_max3_f32 v17, v17, v153, v154
    v_max3_f32 v17, v17, v155, v156
    v_mfma_f32_32x32x16_bf16 a[48:63], a[220:223], v[164:167], a[48:63]
    buffer_load_dwordx4 v1, s[68:71], s48 offen offset:3072 sc1 lds
    v_max3_f32 v17, v17, v157, v158
    v_max3_f32 v16, v16, v17, v159
    v_mov_b32 v17, v16
    v_mfma_f32_32x32x16_bf16 a[0:15], a[224:227], v[168:171], a[0:15]
    s_nop 1
    v_permlane32_swap_b32 v17, v16
    v_max_f32 v16, v16, v17
    v_cmp_gt_f32 vcc, v16, v9
    s_cbranch_vccnz A_TR3
A_RT3:
    v_mfma_f32_32x32x16_bf16 a[16:31], a[228:231], v[168:171], a[16:31]
    s_sub_u32 s30, s30, 1
    s_cmp_eq_u32 s30, 0
    s_cselect_b32 s48, s32, 16384
    s_add_u32 s21, s21, s48
    s_xor_b32 s23, s23, 32768
    v_exp_f32 v128, v128
    v_mfma_f32_32x32x16_bf16 a[32:47], a[232:235], v[168:171], a[32:47]
    v_exp_f32 v129, v129
    v_add_f32 v12, v12, v128
    v_exp_f32 v130, v130
    v_add_f32 v13, v13, v129
    v_mfma_f32_32x32x16_bf16 a[48:63], a[236:239], v[168:171], a[48:63]
    v_cvt_pk_bf16_f32 v176, v128, v129
    v_exp_f32 v131, v131
    v_add_f32 v12, v12, v130
    v_exp_f32 v132, v132
    v_mfma_f32_32x32x16_bf16 a[0:15], a[240:243], v[172:175], a[0:15]
    v_add_f32 v13, v13, v131
    v_cvt_pk_bf16_f32 v177, v130, v131
    v_exp_f32 v133, v133
    v_add_f32 v12, v12, v132
    v_xor_b32 v5, 32768, v5
    v_mfma_f32_32x32x16_bf16 a[16:31], a[244:247], v[172:175], a[16:31]
    v_exp_f32 v134, v134
    v_add_f32 v13, v13, v133
    v_cvt_pk_bf16_f32 v178, v132, v133
    v_exp_f32 v135, v135
    v_mfma_f32_32x32x16_bf16 a[32:47], a[248:251], v[172:175], a[32:47]
    v_add_f32 v12, v12, v134
    v_add_f32 v13, v13, v135
    v_cvt_pk_bf16_f32 v179, v134, v135
    v_xor_b32 v4, 32768, v4
    v_mfma_f32_32x32x16_bf16 a[48:63], a[252:255], v[172:175], a[48:63]
    s_mov_b32 s25, 0
    s_cmp_lg_u32 s16, 0
    s_cbranch_scc1 A_SEGEND
    v_exp_f32 v136, v136
    v_exp_f32 v137, v137
    v_add_f32 v12, v12, v136
    v_exp_f32 v138, v138
    v_add_f32 v13, v13, v137
    v_mfma_f32_32x32x16_bf16 a[64:79], a[192:195], v[176:179], a[64:79]
    v_cvt_pk_bf16_f32 v180, v136, v137
    v_exp_f32 v139, v139
    v_add_f32 v12, v12, v138
    v_exp_f32 v140, v140
    v_add_f32 v13, v13, v139
    v_cvt_pk_bf16_f32 v181, v138, v139
    v_mfma_f32_32x32x16_bf16 a[80:95], a[196:199], v[176:179], a[80:95]
    v_exp_f32 v141, v141
    v_add_f32 v12, v12, v140
    v_exp_f32 v142, v142
    v_add_f32 v13, v13, v141
    v_cvt_pk_bf16_f32 v182, v140, v141
    v_mfma_f32_32x32x16_bf16 a[96:111], a[200:203], v[176:179], a[96:111]
    v_exp_f32 v143, v143
    v_add_f32 v12, v12, v142
    v_add_f32 v13, v13, v143
    v_cvt_pk_bf16_f32 v183, v142, v143
    v_exp_f32 v144, v144
    v_mfma_f32_32x32x16_bf16 a[112:127], a[204:207], v[176:179], a[112:127]
    v_exp_f32 v145, v145
    v_add_f32 v12, v12, v144
    v_exp_f32 v146, v146
    v_add_f32 v13, v13, v145
    v_cvt_pk_bf16_f32 v184, v144, v145
    v_mfma_f32_32x32x16_bf16 a[64:79], a[208:211], v[180:183], a[64:79]
    v_exp_f32 v147, v147
    v_add_f32 v12, v12, v146
    v_exp_f32 v148, v148
    v_add_f32 v13, v13, v147
    v_cvt_pk_bf16_f32 v185, v146, v147
    v_mfma_f32_32x32x16_bf16 a[80:95], a[212:215], v[180:183], a[80:95]
    v_exp_f32 v149, v149
    v_add_f32 v12, v12, v148
    v_exp_f32 v150, v150
    v_add_f32 v13, v13, v149
    v_cvt_pk_bf16_f32 v186, v148, v149
    v_mfma_f32_32x32x16_bf16 a[96:111], a[216:219], v[180:183], a[96:111]
    v_exp_f32 v151, v151
    v_add_f32 v12, v12, v150
    v_add_f32 v13, v13, v151
    v_cvt_pk_bf16_f32 v187, v150, v151
    v_exp_f32 v152, v152
    v_mfma_f32_32x32x16_bf16 a[112:127], a[220:223], v[180:183], a[112:127]
    v_exp_f32 v153, v153
    v_add_f32 v12, v12, v152
    v_exp_f32 v154, v154
    v_add_f32 v13, v13, v153
    v_cvt_pk_bf16_f32 v188, v152, v153
    v_mfma_f32_32x32x16_bf16 a[64:79], a[224:227], v[184:187], a[64:79]
    v_exp_f32 v155, v155
    v_add_f32 v12, v12, v154
    v_exp_f32 v156, v156
    v_add_f32 v13, v13, v155
    v_cvt_pk_bf16_f32 v189, v154, v155
    v_mfma_f32_32x32x16_bf16 a[80:95], a[228:231], v[184:187], a[80:95]
    v_exp_f32 v157, v157
    v_add_f32 v12, v12, v156
    v_exp_f32 v158, v158
    v_add_f32 v13, v13, v157
    v_cvt_pk_bf16_f32 v190, v156, v157
    v_mfma_f32_32x32x16_bf16 a[96:111], a[232:235], v[184:187], a[96:111]
    v_exp_f32 v159, v159
    v_add_f32 v12, v12, v158
    v_add_f32 v13, v13, v159
    v_cvt_pk_bf16_f32 v191, v158, v159
    v_mfma_f32_32x32x16_bf16 a[112:127], a[236:239], v[184:187], a[112:127]
    s_nop 0
    v_mfma_f32_32x32x16_bf16 a[64:79], a[240:243], v[188:191], a[64:79]
    v_mfma_f32_32x32x16_bf16 a[80:95], a[244:247], v[188:191], a[80:95]
    v_mfma_f32_32x32x16_bf16 a[96:111], a[248:251], v[188:191], a[96:111]
    v_mfma_f32_32x32x16_bf16 a[112:127], a[252:255], v[188:191], a[112:127]
    s_waitcnt vmcnt(0)
    s_barrier
    v_xor_b32 v5, 32768, v5
    s_add_u32 m0, s24, 0
    s_add_u32 s48, s22, 0
    buffer_load_dwordx4 v2, s[68:71], s48 offen sc1 lds
    buffer_load_dwordx4 v2, s[68:71], s48 offen offset:1024 sc1 lds
    buffer_load_dwordx4 v3, s[68:71], s48 offen offset:2048 sc1 lds
    buffer_load_dwordx4 v3, s[68:71], s48 offen offset:3072 sc1 lds
    s_add_u32 m0, s24, 4096
    s_add_u32 s48, s22, 4096
    buffer_load_dwordx4 v2, s[68:71], s48 offen sc1 lds
    buffer_load_dwordx4 v2, s[68:71], s48 offen offset:1024 sc1 lds
    buffer_load_dwordx4 v3, s[68:71], s48 offen offset:2048 sc1 lds
    buffer_load_dwordx4 v3, s[68:71], s48 offen offset:3072 sc1 lds
    s_sub_u32 s31, s31, 1
    s_cmp_eq_u32 s31, 0
    s_cselect_b32 s48, s32, 16384
    s_add_u32 s22, s22, s48
    s_xor_b32 s24, s24, 32768
    s_add_u32 m0, s23, 0
    s_add_u32 s48, s21, 0
    buffer_load_dwordx4 v1, s[68:71], s48 offen sc1 lds
    buffer_load_dwordx4 v1, s[68:71], s48 offen offset:1024 sc1 lds
    buffer_load_dwordx4 v1, s[68:71], s48 offen offset:2048 sc1 lds
    buffer_load_dwordx4 v1, s[68:71], s48 offen offset:3072 sc1 lds
    s_add_u32 m0, s23, 4096
    s_add_u32 s48, s21, 4096
    buffer_load_dwordx4 v1, s[68:71], s48 offen sc1 lds
    buffer_load_dwordx4 v1, s[68:71], s48 offen offset:1024 sc1 lds
    buffer_load_dwordx4 v1, s[68:71], s48 offen offset:2048 sc1 lds
    buffer_load_dwordx4 v1, s[68:71], s48 offen offset:3072 sc1 lds
    s_sub_u32 s30, s30, 1
    s_cmp_eq_u32 s30, 0
    s_cselect_b32 s48, s32, 16384
    s_add_u32 s21, s21, s48
    s_xor_b32 s23, s23, 32768
    ds_read_b128 a[128:131], v4 offset:0
    s_waitcnt lgkmcnt(15)
    ds_read_b128 a[132:135], v4 offset:1024
    s_waitcnt lgkmcnt(15)
    ds_read_b128 a[136:139], v4 offset:2048
    s_waitcnt lgkmcnt(15)
    ds_read_b128 a[140:143], v4 offset:3072
    s_waitcnt lgkmcnt(15)
    ds_read_b128 a[144:147], v4 offset:4096
    s_waitcnt lgkmcnt(15)
    ds_read_b128 a[148:151], v4 offset:5120
    s_waitcnt lgkmcnt(15)
    ds_read_b128 a[152:155], v4 offset:6144
    s_waitcnt lgkmcnt(15)
    ds_read_b128 a[156:159], v4 offset:7168
    s_waitcnt lgkmcnt(15)
    ds_read_b128 a[160:163], v4 offset:8192
    s_waitcnt lgkmcnt(15)
    ds_read_b128 a[164:167], v4 offset:9216
    s_waitcnt lgkmcnt(15)
    ds_read_b128 a[168:171], v4 offset:10240
    s_waitcnt lgkmcnt(15)
    ds_read_b128 a[172:175], v4 offset:11264
    s_waitcnt lgkmcnt(15)
    ds_read_b128 a[176:179], v4 offset:12288
    s_waitcnt lgkmcnt(15)
    ds_read_b128 a[180:183], v4 offset:13312
    s_waitcnt lgkmcnt(15)
    ds_read_b128 a[184:187], v4 offset:14336
    s_waitcnt lgkmcnt(15)
    ds_read_b128 a[188:191], v4 offset:15360
    v_xor_b32 v4, 32768, v4
    v_mov_b32 v176, 0
    v_mov_b32 v177, 0
    v_mov_b32 v178, 0
    v_mov_b32 v179, 0
    v_mov_b32 v136, v18
    v_mov_b32 v137, v18
    v_mov_b32 v138, v18
    v_mov_b32 v139, v18
    v_mov_b32 v140, v18
    v_mov_b32 v141, v18
    v_mov_b32 v142, v18
    v_mov_b32 v143, v18
    v_mov_b32 v144, v18
    v_mov_b32 v145, v18
    v_mov_b32 v146, v18
    v_mov_b32 v147, v18
    v_mov_b32 v148, v18
    v_mov_b32 v149, v18
    v_mov_b32 v150, v18
    v_mov_b32 v151, v18
    v_mov_b32 v152, v18
    v_mov_b32 v153, v18
    v_mov_b32 v154, v18
    v_mov_b32 v155, v18
    v_mov_b32 v156, v18
    v_mov_b32 v157, v18
    v_mov_b32 v158, v18
    v_mov_b32 v159, v18
A_SEGEND:
    s_cmp_lg_u32 s19, 0
    s_cbranch_scc1 A_FINAL
    s_sub_u32 s18, 15, s5
    s_lshl_b32 s49, s18, 2
    s_lshl_b32 s50, s16, 1
    s_add_u32 s49, s49, s50
    s_lshl_b32 s52, s49, 18
    s_lshl_b32 s51, s4, 13
    s_add_u32 s52, s52, s51
    s_add_u32 s52, s52, 50331648
    s_lshl_b32 s50, s16, 14
    s_add_u32 s50, s50, 131072
    v_add_u32 v24, s50, v1
    ds_read_b128 v[32:35], v24 offset:0
    ds_read_b128 v[36:39], v24 offset:1024
    ds_read_b128 v[40:43], v24 offset:2048
    ds_read_b128 v[44:47], v24 offset:3072
    ds_read_b128 v[48:51], v24 offset:4096
    ds_read_b128 v[52:55], v24 offset:5120
    ds_read_b128 v[56:59], v24 offset:6144
    ds_read_b128 v[60:63], v24 offset:7168
    ds_read_b128 v[64:67], v24 offset:8192
    ds_read_b128 v[68:71], v24 offset:9216
    ds_read_b128 v[72:75], v24 offset:10240
    ds_read_b128 v[76:79], v24 offset:11264
    ds_read_b128 v[80:83], v24 offset:12288
    ds_read_b128 v[84:87], v24 offset:13312
    ds_read_b128 v[88:91], v24 offset:14336
    ds_read_b128 v[92:95], v24 offset:15360
    v_exp_f32 v136, v136
    v_exp_f32 v137, v137
    v_add_f32 v12, v12, v136
    v_exp_f32 v138, v138
    v_add_f32 v13, v13, v137
    v_mfma_f32_32x32x16_bf16 a[64:79], a[192:195], v[176:179], a[64:79]
    v_cvt_pk_bf16_f32 v180, v136, v137
    v_exp_f32 v139, v139
    v_add_f32 v12, v12, v138
    v_exp_f32 v140, v140
    v_add_f32 v13, v13, v139
    v_cvt_pk_bf16_f32 v181, v138, v139
    v_mfma_f32_32x32x16_bf16 a[80:95], a[196:199], v[176:179], a[80:95]
    s_barrier
    v_exp_f32 v141, v141
    v_add_f32 v12, v12, v140
    v_exp_f32 v142, v142
    v_add_f32 v13, v13, v141
    v_cvt_pk_bf16_f32 v182, v140, v141
    v_mfma_f32_32x32x16_bf16 a[96:111], a[200:203], v[176:179], a[96:111]
    v_exp_f32 v143, v143
    v_add_f32 v12, v12, v142
    v_add_f32 v13, v13, v143
    v_cvt_pk_bf16_f32 v183, v142, v143
    v_exp_f32 v144, v144
    v_mfma_f32_32x32x16_bf16 a[112:127], a[204:207], v[176:179], a[112:127]
    v_exp_f32 v145, v145
    v_add_f32 v12, v12, v144
    v_exp_f32 v146, v146
    v_add_f32 v13, v13, v145
    v_cvt_pk_bf16_f32 v184, v144, v145
    v_mfma_f32_32x32x16_bf16 a[64:79], a[208:211], v[180:183], a[64:79]
    v_exp_f32 v147, v147
    v_add_f32 v12, v12, v146
    v_exp_f32 v148, v148
    v_add_f32 v13, v13, v147
    v_cvt_pk_bf16_f32 v185, v146, v147
    v_mfma_f32_32x32x16_bf16 a[80:95], a[212:215], v[180:183], a[80:95]
    v_exp_f32 v149, v149
    v_add_f32 v12, v12, v148
    v_exp_f32 v150, v150
    v_add_f32 v13, v13, v149
    v_cvt_pk_bf16_f32 v186, v148, v149
    v_mfma_f32_32x32x16_bf16 a[96:111], a[216:219], v[180:183], a[96:111]
    v_exp_f32 v151, v151
    v_add_f32 v12, v12, v150
    v_add_f32 v13, v13, v151
    v_cvt_pk_bf16_f32 v187, v150, v151
    v_exp_f32 v152, v152
    v_mfma_f32_32x32x16_bf16 a[112:127], a[220:223], v[180:183], a[112:127]
    v_exp_f32 v153, v153
    v_add_f32 v12, v12, v152
    v_exp_f32 v154, v154
    v_add_f32 v13, v13, v153
    v_cvt_pk_bf16_f32 v188, v152, v153
    v_mfma_f32_32x32x16_bf16 a[64:79], a[224:227], v[184:187], a[64:79]
    v_exp_f32 v155, v155
    v_add_f32 v12, v12, v154
    v_exp_f32 v156, v156
    v_add_f32 v13, v13, v155
    v_cvt_pk_bf16_f32 v189, v154, v155
    v_mfma_f32_32x32x16_bf16 a[80:95], a[228:231], v[184:187], a[80:95]
    v_exp_f32 v157, v157
    v_add_f32 v12, v12, v156
    v_exp_f32 v158, v158
    v_add_f32 v13, v13, v157
    v_cvt_pk_bf16_f32 v190, v156, v157
    v_mfma_f32_32x32x16_bf16 a[96:111], a[232:235], v[184:187], a[96:111]
    v_exp_f32 v159, v159
    v_add_f32 v12, v12, v158
    v_add_f32 v13, v13, v159
    v_cvt_pk_bf16_f32 v191, v158, v159
    v_mfma_f32_32x32x16_bf16 a[112:127], a[236:239], v[184:187], a[112:127]
    s_nop 0
    v_mfma_f32_32x32x16_bf16 a[64:79], a[240:243], v[188:191], a[64:79]
    v_mfma_f32_32x32x16_bf16 a[80:95], a[244:247], v[188:191], a[80:95]
    v_mfma_f32_32x32x16_bf16 a[96:111], a[248:251], v[188:191], a[96:111]
    v_mfma_f32_32x32x16_bf16 a[112:127], a[252:255], v[188:191], a[112:127]
    v_add_f32 v10, v10, v11
    v_mov_b32 v11, v10
    s_nop 1
    v_permlane32_swap_b32 v11, v10
    v_add_f32 v10, v10, v11
    v_rcp_f32 v10, v10
    v_add_f32 v12, v12, v13
    v_mov_b32 v13, v12
    s_nop 1
    v_permlane32_swap_b32 v13, v12
    v_add_f32 v12, v12, v13
    v_rcp_f32 v12, v12
    s_add_u32 s48, s26, 4096
    v_accvgpr_read_b32 v96, a0
    v_accvgpr_read_b32 v97, a1
    v_accvgpr_read_b32 v98, a2
    v_accvgpr_read_b32 v99, a3
    v_accvgpr_read_b32 v100, a4
    v_accvgpr_read_b32 v101, a5
    v_accvgpr_read_b32 v102, a6
    v_accvgpr_read_b32 v103, a7
    v_mul_f32 v96, v96, v10
    v_mul_f32 v97, v97, v10
    v_mul_f32 v98, v98, v10
    v_mul_f32 v99, v99, v10
    v_mul_f32 v100, v100, v10
    v_mul_f32 v101, v101, v10
    v_mul_f32 v102, v102, v10
    v_mul_f32 v103, v103, v10
    v_cvt_pk_bf16_f32 v96, v96, v97
    v_cvt_pk_bf16_f32 v97, v98, v99
    v_cvt_pk_bf16_f32 v98, v100, v101
    v_cvt_pk_bf16_f32 v99, v102, v103
    buffer_store_dwordx4 v[96:99], v1, s[68:71], s48 offen offset:0
    v_accvgpr_read_b32 v104, a8
    v_accvgpr_read_b32 v105, a9
    v_accvgpr_read_b32 v106, a10
    v_accvgpr_read_b32 v107, a11
    v_accvgpr_read_b32 v108, a12
    v_accvgpr_read_b32 v109, a13
    v_accvgpr_read_b32 v110, a14
    v_accvgpr_read_b32 v111, a15
    v_mul_f32 v104, v104, v10
    v_mul_f32 v105, v105, v10
    v_mul_f32 v106, v106, v10
    v_mul_f32 v107, v107, v10
    v_mul_f32 v108, v108, v10
    v_mul_f32 v109, v109, v10
    v_mul_f32 v110, v110, v10
    v_mul_f32 v111, v111, v10
    v_cvt_pk_bf16_f32 v104, v104, v105
    v_cvt_pk_bf16_f32 v105, v106, v107
    v_cvt_pk_bf16_f32 v106, v108, v109
    v_cvt_pk_bf16_f32 v107, v110, v111
    buffer_store_dwordx4 v[104:107], v1, s[68:71], s48 offen offset:1024
    s_add_u32 s48, s26, 4096
    v_accvgpr_read_b32 v112, a16
    v_accvgpr_read_b32 v113, a17
    v_accvgpr_read_b32 v114, a18
    v_accvgpr_read_b32 v115, a19
    v_accvgpr_read_b32 v116, a20
    v_accvgpr_read_b32 v117, a21
    v_accvgpr_read_b32 v118, a22
    v_accvgpr_read_b32 v119, a23
    v_mul_f32 v112, v112, v10
    v_mul_f32 v113, v113, v10
    v_mul_f32 v114, v114, v10
    v_mul_f32 v115, v115, v10
    v_mul_f32 v116, v116, v10
    v_mul_f32 v117, v117, v10
    v_mul_f32 v118, v118, v10
    v_mul_f32 v119, v119, v10
    v_cvt_pk_bf16_f32 v112, v112, v113
    v_cvt_pk_bf16_f32 v113, v114, v115
    v_cvt_pk_bf16_f32 v114, v116, v117
    v_cvt_pk_bf16_f32 v115, v118, v119
    buffer_store_dwordx4 v[112:115], v1, s[68:71], s48 offen offset:2048
    v_accvgpr_read_b32 v120, a24
    v_accvgpr_read_b32 v121, a25
    v_accvgpr_read_b32 v122, a26
    v_accvgpr_read_b32 v123, a27
    v_accvgpr_read_b32 v124, a28
    v_accvgpr_read_b32 v125, a29
    v_accvgpr_read_b32 v126, a30
    v_accvgpr_read_b32 v127, a31
    v_mul_f32 v120, v120, v10
    v_mul_f32 v121, v121, v10
    v_mul_f32 v122, v122, v10
    v_mul_f32 v123, v123, v10
    v_mul_f32 v124, v124, v10
    v_mul_f32 v125, v125, v10
    v_mul_f32 v126, v126, v10
    v_mul_f32 v127, v127, v10
    v_cvt_pk_bf16_f32 v120, v120, v121
    v_cvt_pk_bf16_f32 v121, v122, v123
    v_cvt_pk_bf16_f32 v122, v124, v125
    v_cvt_pk_bf16_f32 v123, v126, v127
    buffer_store_dwordx4 v[120:123], v1, s[68:71], s48 offen offset:3072
    s_add_u32 s48, s26, 0
    v_accvgpr_read_b32 v128, a32
    v_accvgpr_read_b32 v129, a33
    v_accvgpr_read_b32 v130, a34
    v_accvgpr_read_b32 v131, a35
    v_accvgpr_read_b32 v132, a36
    v_accvgpr_read_b32 v133, a37
    v_accvgpr_read_b32 v134, a38
    v_accvgpr_read_b32 v135, a39
    v_mul_f32 v128, v128, v10
    v_mul_f32 v129, v129, v10
    v_mul_f32 v130, v130, v10
    v_mul_f32 v131, v131, v10
    v_mul_f32 v132, v132, v10
    v_mul_f32 v133, v133, v10
    v_mul_f32 v134, v134, v10
    v_mul_f32 v135, v135, v10
    v_cvt_pk_bf16_f32 v128, v128, v129
    v_cvt_pk_bf16_f32 v129, v130, v131
    v_cvt_pk_bf16_f32 v130, v132, v133
    v_cvt_pk_bf16_f32 v131, v134, v135
    buffer_store_dwordx4 v[128:131], v1, s[68:71], s48 offen offset:0
    v_accvgpr_read_b32 v136, a40
    v_accvgpr_read_b32 v137, a41
    v_accvgpr_read_b32 v138, a42
    v_accvgpr_read_b32 v139, a43
    v_accvgpr_read_b32 v140, a44
    v_accvgpr_read_b32 v141, a45
    v_accvgpr_read_b32 v142, a46
    v_accvgpr_read_b32 v143, a47
    v_mul_f32 v136, v136, v10
    v_mul_f32 v137, v137, v10
    v_mul_f32 v138, v138, v10
    v_mul_f32 v139, v139, v10
    v_mul_f32 v140, v140, v10
    v_mul_f32 v141, v141, v10
    v_mul_f32 v142, v142, v10
    v_mul_f32 v143, v143, v10
    v_cvt_pk_bf16_f32 v136, v136, v137
    v_cvt_pk_bf16_f32 v137, v138, v139
    v_cvt_pk_bf16_f32 v138, v140, v141
    v_cvt_pk_bf16_f32 v139, v142, v143
    buffer_store_dwordx4 v[136:139], v1, s[68:71], s48 offen offset:1024
    s_add_u32 s48, s26, 0
    v_accvgpr_read_b32 v144, a48
    v_accvgpr_read_b32 v145, a49
    v_accvgpr_read_b32 v146, a50
    v_accvgpr_read_b32 v147, a51
    v_accvgpr_read_b32 v148, a52
    v_accvgpr_read_b32 v149, a53
    v_accvgpr_read_b32 v150, a54
    v_accvgpr_read_b32 v151, a55
    v_mul_f32 v144, v144, v10
    v_mul_f32 v145, v145, v10
    v_mul_f32 v146, v146, v10
    v_mul_f32 v147, v147, v10
    v_mul_f32 v148, v148, v10
    v_mul_f32 v149, v149, v10
    v_mul_f32 v150, v150, v10
    v_mul_f32 v151, v151, v10
    v_cvt_pk_bf16_f32 v144, v144, v145
    v_cvt_pk_bf16_f32 v145, v146, v147
    v_cvt_pk_bf16_f32 v146, v148, v149
    v_cvt_pk_bf16_f32 v147, v150, v151
    buffer_store_dwordx4 v[144:147], v1, s[68:71], s48 offen offset:2048
    v_accvgpr_read_b32 v152, a56
    v_accvgpr_read_b32 v153, a57
    v_accvgpr_read_b32 v154, a58
    v_accvgpr_read_b32 v155, a59
    v_accvgpr_read_b32 v156, a60
    v_accvgpr_read_b32 v157, a61
    v_accvgpr_read_b32 v158, a62
    v_accvgpr_read_b32 v159, a63
    v_mul_f32 v152, v152, v10
    v_mul_f32 v153, v153, v10
    v_mul_f32 v154, v154, v10
    v_mul_f32 v155, v155, v10
    v_mul_f32 v156, v156, v10
    v_mul_f32 v157, v157, v10
    v_mul_f32 v158, v158, v10
    v_mul_f32 v159, v159, v10
    v_cvt_pk_bf16_f32 v152, v152, v153
    v_cvt_pk_bf16_f32 v153, v154, v155
    v_cvt_pk_bf16_f32 v154, v156, v157
    v_cvt_pk_bf16_f32 v155, v158, v159
    buffer_store_dwordx4 v[152:155], v1, s[68:71], s48 offen offset:3072
    s_add_u32 s48, s26, 266240
    v_accvgpr_read_b32 v96, a64
    v_accvgpr_read_b32 v97, a65
    v_accvgpr_read_b32 v98, a66
    v_accvgpr_read_b32 v99, a67
    v_accvgpr_read_b32 v100, a68
    v_accvgpr_read_b32 v101, a69
    v_accvgpr_read_b32 v102, a70
    v_accvgpr_read_b32 v103, a71
    v_mul_f32 v96, v96, v12
    v_mul_f32 v97, v97, v12
    v_mul_f32 v98, v98, v12
    v_mul_f32 v99, v99, v12
    v_mul_f32 v100, v100, v12
    v_mul_f32 v101, v101, v12
    v_mul_f32 v102, v102, v12
    v_mul_f32 v103, v103, v12
    v_cvt_pk_bf16_f32 v96, v96, v97
    v_cvt_pk_bf16_f32 v97, v98, v99
    v_cvt_pk_bf16_f32 v98, v100, v101
    v_cvt_pk_bf16_f32 v99, v102, v103
    buffer_store_dwordx4 v[96:99], v1, s[68:71], s48 offen offset:0
    v_accvgpr_read_b32 v104, a72
    v_accvgpr_read_b32 v105, a73
    v_accvgpr_read_b32 v106, a74
    v_accvgpr_read_b32 v107, a75
    v_accvgpr_read_b32 v108, a76
    v_accvgpr_read_b32 v109, a77
    v_accvgpr_read_b32 v110, a78
    v_accvgpr_read_b32 v111, a79
    v_mul_f32 v104, v104, v12
    v_mul_f32 v105, v105, v12
    v_mul_f32 v106, v106, v12
    v_mul_f32 v107, v107, v12
    v_mul_f32 v108, v108, v12
    v_mul_f32 v109, v109, v12
    v_mul_f32 v110, v110, v12
    v_mul_f32 v111, v111, v12
    v_cvt_pk_bf16_f32 v104, v104, v105
    v_cvt_pk_bf16_f32 v105, v106, v107
    v_cvt_pk_bf16_f32 v106, v108, v109
    v_cvt_pk_bf16_f32 v107, v110, v111
    buffer_store_dwordx4 v[104:107], v1, s[68:71], s48 offen offset:1024
    s_add_u32 s48, s26, 266240
    v_accvgpr_read_b32 v112, a80
    v_accvgpr_read_b32 v113, a81
    v_accvgpr_read_b32 v114, a82
    v_accvgpr_read_b32 v115, a83
    v_accvgpr_read_b32 v116, a84
    v_accvgpr_read_b32 v117, a85
    v_accvgpr_read_b32 v118, a86
    v_accvgpr_read_b32 v119, a87
    v_mul_f32 v112, v112, v12
    v_mul_f32 v113, v113, v12
    v_mul_f32 v114, v114, v12
    v_mul_f32 v115, v115, v12
    v_mul_f32 v116, v116, v12
    v_mul_f32 v117, v117, v12
    v_mul_f32 v118, v118, v12
    v_mul_f32 v119, v119, v12
    v_cvt_pk_bf16_f32 v112, v112, v113
    v_cvt_pk_bf16_f32 v113, v114, v115
    v_cvt_pk_bf16_f32 v114, v116, v117
    v_cvt_pk_bf16_f32 v115, v118, v119
    buffer_store_dwordx4 v[112:115], v1, s[68:71], s48 offen offset:2048
    v_accvgpr_read_b32 v120, a88
    v_accvgpr_read_b32 v121, a89
    v_accvgpr_read_b32 v122, a90
    v_accvgpr_read_b32 v123, a91
    v_accvgpr_read_b32 v124, a92
    v_accvgpr_read_b32 v125, a93
    v_accvgpr_read_b32 v126, a94
    v_accvgpr_read_b32 v127, a95
    v_mul_f32 v120, v120, v12
    v_mul_f32 v121, v121, v12
    v_mul_f32 v122, v122, v12
    v_mul_f32 v123, v123, v12
    v_mul_f32 v124, v124, v12
    v_mul_f32 v125, v125, v12
    v_mul_f32 v126, v126, v12
    v_mul_f32 v127, v127, v12
    v_cvt_pk_bf16_f32 v120, v120, v121
    v_cvt_pk_bf16_f32 v121, v122, v123
    v_cvt_pk_bf16_f32 v122, v124, v125
    v_cvt_pk_bf16_f32 v123, v126, v127
    buffer_store_dwordx4 v[120:123], v1, s[68:71], s48 offen offset:3072
    s_add_u32 s48, s26, 262144
    v_accvgpr_read_b32 v128, a96
    v_accvgpr_read_b32 v129, a97
    v_accvgpr_read_b32 v130, a98
    v_accvgpr_read_b32 v131, a99
    v_accvgpr_read_b32 v132, a100
    v_accvgpr_read_b32 v133, a101
    v_accvgpr_read_b32 v134, a102
    v_accvgpr_read_b32 v135, a103
    v_mul_f32 v128, v128, v12
    v_mul_f32 v129, v129, v12
    v_mul_f32 v130, v130, v12
    v_mul_f32 v131, v131, v12
    v_mul_f32 v132, v132, v12
    v_mul_f32 v133, v133, v12
    v_mul_f32 v134, v134, v12
    v_mul_f32 v135, v135, v12
    v_cvt_pk_bf16_f32 v128, v128, v129
    v_cvt_pk_bf16_f32 v129, v130, v131
    v_cvt_pk_bf16_f32 v130, v132, v133
    v_cvt_pk_bf16_f32 v131, v134, v135
    buffer_store_dwordx4 v[128:131], v1, s[68:71], s48 offen offset:0
    v_accvgpr_read_b32 v136, a104
    v_accvgpr_read_b32 v137, a105
    v_accvgpr_read_b32 v138, a106
    v_accvgpr_read_b32 v139, a107
    v_accvgpr_read_b32 v140, a108
    v_accvgpr_read_b32 v141, a109
    v_accvgpr_read_b32 v142, a110
    v_accvgpr_read_b32 v143, a111
    v_mul_f32 v136, v136, v12
    v_mul_f32 v137, v137, v12
    v_mul_f32 v138, v138, v12
    v_mul_f32 v139, v139, v12
    v_mul_f32 v140, v140, v12
    v_mul_f32 v141, v141, v12
    v_mul_f32 v142, v142, v12
    v_mul_f32 v143, v143, v12
    v_cvt_pk_bf16_f32 v136, v136, v137
    v_cvt_pk_bf16_f32 v137, v138, v139
    v_cvt_pk_bf16_f32 v138, v140, v141
    v_cvt_pk_bf16_f32 v139, v142, v143
    buffer_store_dwordx4 v[136:139], v1, s[68:71], s48 offen offset:1024
    s_add_u32 s48, s26, 262144
    v_accvgpr_read_b32 v144, a112
    v_accvgpr_read_b32 v145, a113
    v_accvgpr_read_b32 v146, a114
    v_accvgpr_read_b32 v147, a115
    v_accvgpr_read_b32 v148, a116
    v_accvgpr_read_b32 v149, a117
    v_accvgpr_read_b32 v150, a118
    v_accvgpr_read_b32 v151, a119
    v_mul_f32 v144, v144, v12
    v_mul_f32 v145, v145, v12
    v_mul_f32 v146, v146, v12
    v_mul_f32 v147, v147, v12
    s_barrier
    v_mul_f32 v148, v148, v12
    v_mul_f32 v149, v149, v12
    v_mul_f32 v150, v150, v12
    v_mul_f32 v151, v151, v12
    v_cvt_pk_bf16_f32 v144, v144, v145
    v_cvt_pk_bf16_f32 v145, v146, v147
    v_cvt_pk_bf16_f32 v146, v148, v149
    v_cvt_pk_bf16_f32 v147, v150, v151
    buffer_store_dwordx4 v[144:147], v1, s[68:71], s48 offen offset:2048
    v_accvgpr_read_b32 v152, a120
    v_accvgpr_read_b32 v153, a121
    v_accvgpr_read_b32 v154, a122
    v_accvgpr_read_b32 v155, a123
    v_accvgpr_read_b32 v156, a124
    v_accvgpr_read_b32 v157, a125
    v_accvgpr_read_b32 v158, a126
    v_accvgpr_read_b32 v159, a127
    v_mul_f32 v152, v152, v12
    v_mul_f32 v153, v153, v12
    v_mul_f32 v154, v154, v12
    v_mul_f32 v155, v155, v12
    v_mul_f32 v156, v156, v12
    v_mul_f32 v157, v157, v12
    v_mul_f32 v158, v158, v12
    v_mul_f32 v159, v159, v12
    v_cvt_pk_bf16_f32 v152, v152, v153
    v_cvt_pk_bf16_f32 v153, v154, v155
    v_cvt_pk_bf16_f32 v154, v156, v157
    v_cvt_pk_bf16_f32 v155, v158, v159
    buffer_store_dwordx4 v[152:155], v1, s[68:71], s48 offen offset:3072
    s_mov_b32 s26, s52
    s_lshl_b32 s51, s16, 6
    v_and_b32 v20, 31, v0
    v_lshrrev_b32 v21, 5, v0
    v_lshlrev_b32 v21, 2, v21
    v_sub_u32 v20, v20, v21
    v_add_u32 v6, s51, v20
    v_add_u32 v7, 32, v6
    v_mov_b32 v160, 0
    v_mov_b32 v161, 0
    v_mov_b32 v162, 0
    v_mov_b32 v163, 0
    v_mov_b32 v164, 0
    v_mov_b32 v165, 0
    v_mov_b32 v166, 0
    v_mov_b32 v167, 0
    v_mov_b32 v168, 0
    v_mov_b32 v169, 0
    v_mov_b32 v170, 0
    v_mov_b32 v171, 0
    v_mov_b32 v172, 0
    v_mov_b32 v173, 0
    v_mov_b32 v174, 0
    v_mov_b32 v175, 0
    v_mov_b32 v176, 0
    v_mov_b32 v177, 0
    v_mov_b32 v178, 0
    v_mov_b32 v179, 0
    v_mov_b32 v180, 0
    v_mov_b32 v181, 0
    v_mov_b32 v182, 0
    v_mov_b32 v183, 0
    v_mov_b32 v184, 0
    v_mov_b32 v185, 0
    v_mov_b32 v186, 0
    v_mov_b32 v187, 0
    v_mov_b32 v188, 0
    v_mov_b32 v189, 0
    v_mov_b32 v190, 0
    v_mov_b32 v191, 0
    s_nop 0
    v_mfma_f32_32x32x16_bf16 a[0:15], v[160:163], v[160:163], 0
    v_mfma_f32_32x32x16_bf16 a[16:31], v[160:163], v[160:163], 0
    v_mfma_f32_32x32x16_bf16 a[32:47], v[160:163], v[160:163], 0
    v_mfma_f32_32x32x16_bf16 a[48:63], v[160:163], v[160:163], 0
    v_mfma_f32_32x32x16_bf16 a[64:79], v[160:163], v[160:163], 0
    v_mfma_f32_32x32x16_bf16 a[80:95], v[160:163], v[160:163], 0
    v_mfma_f32_32x32x16_bf16 a[96:111], v[160:163], v[160:163], 0
    v_mfma_f32_32x32x16_bf16 a[112:127], v[160:163], v[160:163], 0
    v_mfma_f32_32x32x16_bf16 v[192:207], v[160:163], v[160:163], 0
    v_mfma_f32_32x32x16_bf16 v[208:223], v[160:163], v[160:163], 0
    v_mov_b32 v136, v18
    v_mov_b32 v137, v18
    v_mov_b32 v138, v18
    v_mov_b32 v139, v18
    v_mov_b32 v140, v18
    v_mov_b32 v141, v18
    v_mov_b32 v142, v18
    v_mov_b32 v143, v18
    v_mov_b32 v144, v18
    v_mov_b32 v145, v18
    v_mov_b32 v146, v18
    v_mov_b32 v147, v18
    v_mov_b32 v148, v18
    v_mov_b32 v149, v18
    v_mov_b32 v150, v18
    v_mov_b32 v151, v18
    v_mov_b32 v152, v18
    v_mov_b32 v153, v18
    v_mov_b32 v154, v18
    v_mov_b32 v155, v18
    v_mov_b32 v156, v18
    v_mov_b32 v157, v18
    v_mov_b32 v158, v18
    v_mov_b32 v159, v18
    v_mov_b32 v10, 0
    v_mov_b32 v11, 0
    v_mov_b32 v12, 0
    v_mov_b32 v13, 0
    v_mov_b32 v8, v18
    v_mov_b32 v9, v18
    s_mov_b32 s25, 3
    s_lshl_b32 s48, s5, 1
    s_sub_u32 s20, 12, s48
    s_mov_b32 s33, 2
    s_mov_b32 s19, 1
    s_cmp_eq_u32 s5, 7
    s_cselect_b32 s20, 0, s20
    s_cselect_b32 s33, 0, s33
    s_waitcnt lgkmcnt(0)
    s_branch A_SEG
A_FINAL:
    s_waitcnt lgkmcnt(0)
    v_exp_f32 v136, v136
    v_exp_f32 v137, v137
    v_add_f32 v12, v12, v136
    v_exp_f32 v138, v138
    v_add_f32 v13, v13, v137
    v_mfma_f32_32x32x16_bf16 a[64:79], a[192:195], v[176:179], a[64:79]
    v_cvt_pk_bf16_f32 v180, v136, v137
    v_exp_f32 v139, v139
    v_add_f32 v12, v12, v138
    v_exp_f32 v140, v140
    v_add_f32 v13, v13, v139
    v_cvt_pk_bf16_f32 v181, v138, v139
    v_mfma_f32_32x32x16_bf16 a[80:95], a[196:199], v[176:179], a[80:95]
    v_exp_f32 v141, v141
    v_add_f32 v12, v12, v140
    v_exp_f32 v142, v142
    v_add_f32 v13, v13, v141
    v_cvt_pk_bf16_f32 v182, v140, v141
    v_mfma_f32_32x32x16_bf16 a[96:111], a[200:203], v[176:179], a[96:111]
    v_exp_f32 v143, v143
    v_add_f32 v12, v12, v142
    v_add_f32 v13, v13, v143
    v_cvt_pk_bf16_f32 v183, v142, v143
    v_exp_f32 v144, v144
    v_mfma_f32_32x32x16_bf16 a[112:127], a[204:207], v[176:179], a[112:127]
    v_exp_f32 v145, v145
    v_add_f32 v12, v12, v144
    v_exp_f32 v146, v146
    v_add_f32 v13, v13, v145
    v_cvt_pk_bf16_f32 v184, v144, v145
    v_mfma_f32_32x32x16_bf16 a[64:79], a[208:211], v[180:183], a[64:79]
    v_exp_f32 v147, v147
    v_add_f32 v12, v12, v146
    v_exp_f32 v148, v148
    v_add_f32 v13, v13, v147
    v_cvt_pk_bf16_f32 v185, v146, v147
    v_mfma_f32_32x32x16_bf16 a[80:95], a[212:215], v[180:183], a[80:95]
    v_exp_f32 v149, v149
    v_add_f32 v12, v12, v148
    v_exp_f32 v150, v150
    v_add_f32 v13, v13, v149
    v_cvt_pk_bf16_f32 v186, v148, v149
    v_mfma_f32_32x32x16_bf16 a[96:111], a[216:219], v[180:183], a[96:111]
    v_exp_f32 v151, v151
    v_add_f32 v12, v12, v150
    v_add_f32 v13, v13, v151
    v_cvt_pk_bf16_f32 v187, v150, v151
    v_exp_f32 v152, v152
    v_mfma_f32_32x32x16_bf16 a[112:127], a[220:223], v[180:183], a[112:127]
    v_exp_f32 v153, v153
    v_add_f32 v12, v12, v152
    v_exp_f32 v154, v154
    v_add_f32 v13, v13, v153
    v_cvt_pk_bf16_f32 v188, v152, v153
    v_mfma_f32_32x32x16_bf16 a[64:79], a[224:227], v[184:187], a[64:79]
    v_exp_f32 v155, v155
    v_add_f32 v12, v12, v154
    v_exp_f32 v156, v156
    v_add_f32 v13, v13, v155
    v_cvt_pk_bf16_f32 v189, v154, v155
    v_mfma_f32_32x32x16_bf16 a[80:95], a[228:231], v[184:187], a[80:95]
    v_exp_f32 v157, v157
    v_add_f32 v12, v12, v156
    v_exp_f32 v158, v158
    v_add_f32 v13, v13, v157
    v_cvt_pk_bf16_f32 v190, v156, v157
    v_mfma_f32_32x32x16_bf16 a[96:111], a[232:235], v[184:187], a[96:111]
    v_exp_f32 v159, v159
    v_add_f32 v12, v12, v158
    v_add_f32 v13, v13, v159
    v_cvt_pk_bf16_f32 v191, v158, v159
    v_mfma_f32_32x32x16_bf16 a[112:127], a[236:239], v[184:187], a[112:127]
    s_nop 0
    v_mfma_f32_32x32x16_bf16 a[64:79], a[240:243], v[188:191], a[64:79]
    v_mfma_f32_32x32x16_bf16 a[80:95], a[244:247], v[188:191], a[80:95]
    v_mfma_f32_32x32x16_bf16 a[96:111], a[248:251], v[188:191], a[96:111]
    v_mfma_f32_32x32x16_bf16 a[112:127], a[252:255], v[188:191], a[112:127]
    s_waitcnt vmcnt(0) lgkmcnt(0)
    s_barrier
    s_lshl_b32 s48, s3, 14
    v_add_u32 v20, s48, v1
    v_xor_b32 v21, 0x8000, v20
    v_add_u32 v20, 0, v20
    v_add_u32 v21, 0, v21
    s_lshl_b32 s48, s3, 10
    s_add_u32 s48, s48, 65536
    v_add_u32 v22, s48, v1
    v_xor_b32 v23, 2048, v22
    s_lshl_b32 s48, s17, 12
    s_add_u32 s26, s26, s48
    v_add_f32 v10, v10, v11
    v_mov_b32 v11, v10
    s_nop 1
    v_permlane32_swap_b32 v11, v10
    v_add_f32 v225, v10, v11
    v_sub_f32 v224, 0, v192
    v_cmp_lt_f32 vcc, 0, v225
    v_mov_b32 v10, 0xff7fffff
    s_nop 0
    v_cndmask_b32 v224, v10, v224, vcc
    v_add_f32 v12, v12, v13
    v_mov_b32 v13, v12
    s_nop 1
    v_permlane32_swap_b32 v13, v12
    v_add_f32 v227, v12, v13
    v_sub_f32 v226, 0, v208
    v_cmp_lt_f32 vcc, 0, v227
    v_mov_b32 v12, 0xff7fffff
    s_nop 0
    v_cndmask_b32 v226, v12, v226, vcc
    ds_write_b128 v22, v[224:227]
    ds_write_b128 v20, a[32:35] offset:0
    v_accvgpr_read_b32 v160, a0
    v_accvgpr_read_b32 v161, a1
    v_accvgpr_read_b32 v162, a2
    v_accvgpr_read_b32 v163, a3
    ds_write_b128 v20, a[36:39] offset:1024
    v_accvgpr_read_b32 v164, a4
    v_accvgpr_read_b32 v165, a5
    v_accvgpr_read_b32 v166, a6
    v_accvgpr_read_b32 v167, a7
    ds_write_b128 v20, a[40:43] offset:2048
    v_accvgpr_read_b32 v168, a8
    v_accvgpr_read_b32 v169, a9
    v_accvgpr_read_b32 v170, a10
    v_accvgpr_read_b32 v171, a11
    ds_write_b128 v20, a[44:47] offset:3072
    v_accvgpr_read_b32 v172, a12
    v_accvgpr_read_b32 v173, a13
    v_accvgpr_read_b32 v174, a14
    v_accvgpr_read_b32 v175, a15
    ds_write_b128 v20, a[48:51] offset:4096
    v_accvgpr_read_b32 v176, a16
    v_accvgpr_read_b32 v177, a17
    v_accvgpr_read_b32 v178, a18
    v_accvgpr_read_b32 v179, a19
    ds_write_b128 v20, a[52:55] offset:5120
    v_accvgpr_read_b32 v180, a20
    v_accvgpr_read_b32 v181, a21
    v_accvgpr_read_b32 v182, a22
    v_accvgpr_read_b32 v183, a23
    ds_write_b128 v20, a[56:59] offset:6144
    v_accvgpr_read_b32 v184, a24
    v_accvgpr_read_b32 v185, a25
    v_accvgpr_read_b32 v186, a26
    v_accvgpr_read_b32 v187, a27
    ds_write_b128 v20, a[60:63] offset:7168
    v_accvgpr_read_b32 v188, a28
    v_accvgpr_read_b32 v189, a29
    v_accvgpr_read_b32 v190, a30
    v_accvgpr_read_b32 v191, a31
    ds_write_b128 v20, a[96:99] offset:8192
    v_accvgpr_read_b32 v192, a64
    v_accvgpr_read_b32 v193, a65
    v_accvgpr_read_b32 v194, a66
    v_accvgpr_read_b32 v195, a67
    ds_write_b128 v20, a[100:103] offset:9216
    v_accvgpr_read_b32 v196, a68
    v_accvgpr_read_b32 v197, a69
    v_accvgpr_read_b32 v198, a70
    v_accvgpr_read_b32 v199, a71
    ds_write_b128 v20, a[104:107] offset:10240
    v_accvgpr_read_b32 v200, a72
    v_accvgpr_read_b32 v201, a73
    v_accvgpr_read_b32 v202, a74
    v_accvgpr_read_b32 v203, a75
    ds_write_b128 v20, a[108:111] offset:11264
    v_accvgpr_read_b32 v204, a76
    v_accvgpr_read_b32 v205, a77
    v_accvgpr_read_b32 v206, a78
    v_accvgpr_read_b32 v207, a79
    ds_write_b128 v20, a[112:115] offset:12288
    v_accvgpr_read_b32 v208, a80
    v_accvgpr_read_b32 v209, a81
    v_accvgpr_read_b32 v210, a82
    v_accvgpr_read_b32 v211, a83
    ds_write_b128 v20, a[116:119] offset:13312
    v_accvgpr_read_b32 v212, a84
    v_accvgpr_read_b32 v213, a85
    v_accvgpr_read_b32 v214, a86
    v_accvgpr_read_b32 v215, a87
    ds_write_b128 v20, a[120:123] offset:14336
    v_accvgpr_read_b32 v216, a88
    v_accvgpr_read_b32 v217, a89
    v_accvgpr_read_b32 v218, a90
    v_accvgpr_read_b32 v219, a91
    ds_write_b128 v20, a[124:127] offset:15360
    v_accvgpr_read_b32 v220, a92
    v_accvgpr_read_b32 v221, a93
    v_accvgpr_read_b32 v222, a94
    v_accvgpr_read_b32 v223, a95
    s_waitcnt lgkmcnt(0)
    s_barrier
    ds_read_b128 v[228:231], v23
    ds_read_b128 v[96:99], v21 offset:0
    ds_read_b128 v[100:103], v21 offset:1024
    ds_read_b128 v[104:107], v21 offset:2048
    ds_read_b128 v[108:111], v21 offset:3072
    ds_read_b128 v[112:115], v21 offset:4096
    ds_read_b128 v[116:119], v21 offset:5120
    ds_read_b128 v[120:123], v21 offset:6144
    ds_read_b128 v[124:127], v21 offset:7168
    ds_read_b128 v[128:131], v21 offset:8192
    ds_read_b128 v[132:135], v21 offset:9216
    ds_read_b128 v[136:139], v21 offset:10240
    ds_read_b128 v[140:143], v21 offset:11264
    ds_read_b128 v[144:147], v21 offset:12288
    ds_read_b128 v[148:151], v21 offset:13312
    ds_read_b128 v[152:155], v21 offset:14336
    ds_read_b128 v[156:159], v21 offset:15360
    s_waitcnt lgkmcnt(15)
    v_max_f32 v240, v224, v228
    v_sub_f32 v232, v224, v240
    v_sub_f32 v234, v228, v240
    v_exp_f32 v232, v232
    v_exp_f32 v234, v234
    s_nop 0
    v_mul_f32 v240, v225, v232
    v_fmac_f32 v240, v229, v234
    v_rcp_f32 v240, v240
    s_nop 0
    v_mul_f32 v232, v232, v240
    v_mul_f32 v234, v234, v240
    v_mov_b32 v233, v232
    v_mov_b32 v235, v234
    v_max_f32 v240, v226, v230
    v_sub_f32 v236, v226, v240
    v_sub_f32 v238, v230, v240
    v_exp_f32 v236, v236
    v_exp_f32 v238, v238
    s_nop 0
    v_mul_f32 v240, v227, v236
    v_fmac_f32 v240, v231, v238
    v_rcp_f32 v240, v240
    s_nop 0
    v_mul_f32 v236, v236, v240
    v_mul_f32 v238, v238, v240
    v_mov_b32 v237, v236
    v_mov_b32 v239, v238
    s_add_u32 s48, s26, 0
    v_pk_mul_f32 v[96:97], v[96:97], v[234:235]
    v_pk_mul_f32 v[98:99], v[98:99], v[234:235]
    s_waitcnt lgkmcnt(14)
    v_pk_mul_f32 v[100:101], v[100:101], v[234:235]
    v_pk_mul_f32 v[102:103], v[102:103], v[234:235]
    v_pk_fma_f32 v[96:97], v[160:161], v[232:233], v[96:97]
    v_pk_fma_f32 v[98:99], v[162:163], v[232:233], v[98:99]
    v_pk_fma_f32 v[100:101], v[164:165], v[232:233], v[100:101]
    v_pk_fma_f32 v[102:103], v[166:167], v[232:233], v[102:103]
    v_cvt_pk_bf16_f32 v96, v96, v97
    v_cvt_pk_bf16_f32 v97, v98, v99
    v_cvt_pk_bf16_f32 v98, v100, v101
    v_cvt_pk_bf16_f32 v99, v102, v103
    buffer_store_dwordx4 v[96:99], v1, s[68:71], s48 offen offset:0
    s_waitcnt lgkmcnt(13)
    v_pk_mul_f32 v[104:105], v[104:105], v[234:235]
    v_pk_mul_f32 v[106:107], v[106:107], v[234:235]
    s_waitcnt lgkmcnt(12)
    v_pk_mul_f32 v[108:109], v[108:109], v[234:235]
    v_pk_mul_f32 v[110:111], v[110:111], v[234:235]
    v_pk_fma_f32 v[104:105], v[168:169], v[232:233], v[104:105]
    v_pk_fma_f32 v[106:107], v[170:171], v[232:233], v[106:107]
    v_pk_fma_f32 v[108:109], v[172:173], v[232:233], v[108:109]
    v_pk_fma_f32 v[110:111], v[174:175], v[232:233], v[110:111]
    v_cvt_pk_bf16_f32 v104, v104, v105
    v_cvt_pk_bf16_f32 v105, v106, v107
    v_cvt_pk_bf16_f32 v106, v108, v109
    v_cvt_pk_bf16_f32 v107, v110, v111
    buffer_store_dwordx4 v[104:107], v1, s[68:71], s48 offen offset:1024
    s_waitcnt lgkmcnt(11)
    v_pk_mul_f32 v[112:113], v[112:113], v[234:235]
    v_pk_mul_f32 v[114:115], v[114:115], v[234:235]
    s_waitcnt lgkmcnt(10)
    v_pk_mul_f32 v[116:117], v[116:117], v[234:235]
    v_pk_mul_f32 v[118:119], v[118:119], v[234:235]
    v_pk_fma_f32 v[112:113], v[176:177], v[232:233], v[112:113]
    v_pk_fma_f32 v[114:115], v[178:179], v[232:233], v[114:115]
    v_pk_fma_f32 v[116:117], v[180:181], v[232:233], v[116:117]
    v_pk_fma_f32 v[118:119], v[182:183], v[232:233], v[118:119]
    v_cvt_pk_bf16_f32 v112, v112, v113
    v_cvt_pk_bf16_f32 v113, v114, v115
    v_cvt_pk_bf16_f32 v114, v116, v117
    v_cvt_pk_bf16_f32 v115, v118, v119
    buffer_store_dwordx4 v[112:115], v1, s[68:71], s48 offen offset:2048
    s_waitcnt lgkmcnt(9)
    v_pk_mul_f32 v[120:121], v[120:121], v[234:235]
    v_pk_mul_f32 v[122:123], v[122:123], v[234:235]
    s_waitcnt lgkmcnt(8)
    v_pk_mul_f32 v[124:125], v[124:125], v[234:235]
    v_pk_mul_f32 v[126:127], v[126:127], v[234:235]
    v_pk_fma_f32 v[120:121], v[184:185], v[232:233], v[120:121]
    v_pk_fma_f32 v[122:123], v[186:187], v[232:233], v[122:123]
    v_pk_fma_f32 v[124:125], v[188:189], v[232:233], v[124:125]
    v_pk_fma_f32 v[126:127], v[190:191], v[232:233], v[126:127]
    v_cvt_pk_bf16_f32 v120, v120, v121
    v_cvt_pk_bf16_f32 v121, v122, v123
    v_cvt_pk_bf16_f32 v122, v124, v125
    v_cvt_pk_bf16_f32 v123, v126, v127
    buffer_store_dwordx4 v[120:123], v1, s[68:71], s48 offen offset:3072
    s_add_u32 s48, s26, 262144
    s_waitcnt lgkmcnt(7)
    v_pk_mul_f32 v[128:129], v[128:129], v[238:239]
    v_pk_mul_f32 v[130:131], v[130:131], v[238:239]
    s_waitcnt lgkmcnt(6)
    v_pk_mul_f32 v[132:133], v[132:133], v[238:239]
    v_pk_mul_f32 v[134:135], v[134:135], v[238:239]
    v_pk_fma_f32 v[128:129], v[192:193], v[236:237], v[128:129]
    v_pk_fma_f32 v[130:131], v[194:195], v[236:237], v[130:131]
    v_pk_fma_f32 v[132:133], v[196:197], v[236:237], v[132:133]
    v_pk_fma_f32 v[134:135], v[198:199], v[236:237], v[134:135]
    v_cvt_pk_bf16_f32 v128, v128, v129
    v_cvt_pk_bf16_f32 v129, v130, v131
    v_cvt_pk_bf16_f32 v130, v132, v133
    v_cvt_pk_bf16_f32 v131, v134, v135
    buffer_store_dwordx4 v[128:131], v1, s[68:71], s48 offen offset:0
    s_waitcnt lgkmcnt(5)
    v_pk_mul_f32 v[136:137], v[136:137], v[238:239]
    v_pk_mul_f32 v[138:139], v[138:139], v[238:239]
    s_waitcnt lgkmcnt(4)
    v_pk_mul_f32 v[140:141], v[140:141], v[238:239]
    v_pk_mul_f32 v[142:143], v[142:143], v[238:239]
    v_pk_fma_f32 v[136:137], v[200:201], v[236:237], v[136:137]
    v_pk_fma_f32 v[138:139], v[202:203], v[236:237], v[138:139]
    v_pk_fma_f32 v[140:141], v[204:205], v[236:237], v[140:141]
    v_pk_fma_f32 v[142:143], v[206:207], v[236:237], v[142:143]
    v_cvt_pk_bf16_f32 v136, v136, v137
    v_cvt_pk_bf16_f32 v137, v138, v139
    v_cvt_pk_bf16_f32 v138, v140, v141
    v_cvt_pk_bf16_f32 v139, v142, v143
    buffer_store_dwordx4 v[136:139], v1, s[68:71], s48 offen offset:1024
    s_waitcnt lgkmcnt(3)
    v_pk_mul_f32 v[144:145], v[144:145], v[238:239]
    v_pk_mul_f32 v[146:147], v[146:147], v[238:239]
    s_waitcnt lgkmcnt(2)
    v_pk_mul_f32 v[148:149], v[148:149], v[238:239]
    v_pk_mul_f32 v[150:151], v[150:151], v[238:239]
    v_pk_fma_f32 v[144:145], v[208:209], v[236:237], v[144:145]
    v_pk_fma_f32 v[146:147], v[210:211], v[236:237], v[146:147]
    v_pk_fma_f32 v[148:149], v[212:213], v[236:237], v[148:149]
    v_pk_fma_f32 v[150:151], v[214:215], v[236:237], v[150:151]
    v_cvt_pk_bf16_f32 v144, v144, v145
    v_cvt_pk_bf16_f32 v145, v146, v147
    v_cvt_pk_bf16_f32 v146, v148, v149
    v_cvt_pk_bf16_f32 v147, v150, v151
    buffer_store_dwordx4 v[144:147], v1, s[68:71], s48 offen offset:2048
    s_waitcnt lgkmcnt(1)
    v_pk_mul_f32 v[152:153], v[152:153], v[238:239]
    v_pk_mul_f32 v[154:155], v[154:155], v[238:239]
    s_waitcnt lgkmcnt(0)
    v_pk_mul_f32 v[156:157], v[156:157], v[238:239]
    v_pk_mul_f32 v[158:159], v[158:159], v[238:239]
    v_pk_fma_f32 v[152:153], v[216:217], v[236:237], v[152:153]
    v_pk_fma_f32 v[154:155], v[218:219], v[236:237], v[154:155]
    v_pk_fma_f32 v[156:157], v[220:221], v[236:237], v[156:157]
    v_pk_fma_f32 v[158:159], v[222:223], v[236:237], v[158:159]
    v_cvt_pk_bf16_f32 v152, v152, v153
    v_cvt_pk_bf16_f32 v153, v154, v155
    v_cvt_pk_bf16_f32 v154, v156, v157
    v_cvt_pk_bf16_f32 v155, v158, v159
    buffer_store_dwordx4 v[152:155], v1, s[68:71], s48 offen offset:3072
A_END:
    s_endpgm
A_TR0:
    s_call_b64 s[28:29], A_RARE0
    s_branch A_RT0
A_TR1:
    s_call_b64 s[28:29], A_RARE1
    s_branch A_RT1
A_TR2:
    s_call_b64 s[28:29], A_RARE0
    s_branch A_RT2
A_TR3:
    s_call_b64 s[28:29], A_RARE1
    s_branch A_RT3
A_RARE0:
    s_nop 1
    v_cndmask_b32 v20, 0, v14, vcc
    v_cndmask_b32 v8, v8, v19, vcc
    v_sub_f32 v21, 0, v20
    v_min_f32 v21, 0, v21
    v_exp_f32 v21, v21
    v_sub_f32 v96, v96, v20
    v_sub_f32 v97, v97, v20
    v_sub_f32 v98, v98, v20
    v_sub_f32 v99, v99, v20
    v_sub_f32 v100, v100, v20
    v_sub_f32 v101, v101, v20
    v_sub_f32 v102, v102, v20
    v_sub_f32 v103, v103, v20
    v_sub_f32 v104, v104, v20
    v_sub_f32 v105, v105, v20
    v_sub_f32 v106, v106, v20
    v_sub_f32 v107, v107, v20
    v_sub_f32 v108, v108, v20
    v_sub_f32 v109, v109, v20
    v_sub_f32 v110, v110, v20
    v_sub_f32 v111, v111, v20
    v_sub_f32 v112, v112, v20
    v_sub_f32 v113, v113, v20
    v_sub_f32 v114, v114, v20
    v_sub_f32 v115, v115, v20
    v_sub_f32 v116, v116, v20
    v_sub_f32 v117, v117, v20
    v_sub_f32 v118, v118, v20
    v_sub_f32 v119, v119, v20
    v_sub_f32 v120, v120, v20
    v_sub_f32 v121, v121, v20
    v_sub_f32 v122, v122, v20
    v_sub_f32 v123, v123, v20
    v_sub_f32 v124, v124, v20
    v_sub_f32 v125, v125, v20
    v_sub_f32 v126, v126, v20
    v_sub_f32 v127, v127, v20
    v_sub_f32 v192, v192, v20
    v_sub_f32 v193, v193, v20
    v_sub_f32 v194, v194, v20
    v_sub_f32 v195, v195, v20
    v_sub_f32 v196, v196, v20
    v_sub_f32 v197, v197, v20
    v_sub_f32 v198, v198, v20
    v_sub_f32 v199, v199, v20
    v_sub_f32 v200, v200, v20
    v_sub_f32 v201, v201, v20
    v_sub_f32 v202, v202, v20
    v_sub_f32 v203, v203, v20
    v_sub_f32 v204, v204, v20
    v_sub_f32 v205, v205, v20
    v_sub_f32 v206, v206, v20
    v_sub_f32 v207, v207, v20
    v_mul_f32 v10, v10, v21
    v_mul_f32 v11, v11, v21
    s_bitcmp1_b32 s25, 0
    s_cbranch_scc1 A_RARE0_D
    v_accvgpr_read_b32 v22, a0
    v_accvgpr_read_b32 v23, a1
    v_accvgpr_read_b32 v24, a2
    v_accvgpr_read_b32 v25, a3
    v_mul_f32 v22, v22, v21
    v_mul_f32 v23, v23, v21
    v_mul_f32 v24, v24, v21
    v_mul_f32 v25, v25, v21
    v_accvgpr_write_b32 a0, v22
    v_accvgpr_write_b32 a1, v23
    v_accvgpr_write_b32 a2, v24
    v_accvgpr_write_b32 a3, v25
    v_accvgpr_read_b32 v22, a4
    v_accvgpr_read_b32 v23, a5
    v_accvgpr_read_b32 v24, a6
    v_accvgpr_read_b32 v25, a7
    v_mul_f32 v22, v22, v21
    v_mul_f32 v23, v23, v21
    v_mul_f32 v24, v24, v21
    v_mul_f32 v25, v25, v21
    v_accvgpr_write_b32 a4, v22
    v_accvgpr_write_b32 a5, v23
    v_accvgpr_write_b32 a6, v24
    v_accvgpr_write_b32 a7, v25
    v_accvgpr_read_b32 v22, a8
    v_accvgpr_read_b32 v23, a9
    v_accvgpr_read_b32 v24, a10
    v_accvgpr_read_b32 v25, a11
    v_mul_f32 v22, v22, v21
    v_mul_f32 v23, v23, v21
    v_mul_f32 v24, v24, v21
    v_mul_f32 v25, v25, v21
    v_accvgpr_write_b32 a8, v22
    v_accvgpr_write_b32 a9, v23
    v_accvgpr_write_b32 a10, v24
    v_accvgpr_write_b32 a11, v25
    v_accvgpr_read_b32 v22, a12
    v_accvgpr_read_b32 v23, a13
    v_accvgpr_read_b32 v24, a14
    v_accvgpr_read_b32 v25, a15
    v_mul_f32 v22, v22, v21
    v_mul_f32 v23, v23, v21
    v_mul_f32 v24, v24, v21
    v_mul_f32 v25, v25, v21
    v_accvgpr_write_b32 a12, v22
    v_accvgpr_write_b32 a13, v23
    v_accvgpr_write_b32 a14, v24
    v_accvgpr_write_b32 a15, v25
    v_accvgpr_read_b32 v22, a16
    v_accvgpr_read_b32 v23, a17
    v_accvgpr_read_b32 v24, a18
    v_accvgpr_read_b32 v25, a19
    v_mul_f32 v22, v22, v21
    v_mul_f32 v23, v23, v21
    v_mul_f32 v24, v24, v21
    v_mul_f32 v25, v25, v21
    v_accvgpr_write_b32 a16, v22
    v_accvgpr_write_b32 a17, v23
    v_accvgpr_write_b32 a18, v24
    v_accvgpr_write_b32 a19, v25
    v_accvgpr_read_b32 v22, a20
    v_accvgpr_read_b32 v23, a21
    v_accvgpr_read_b32 v24, a22
    v_accvgpr_read_b32 v25, a23
    v_mul_f32 v22, v22, v21
    v_mul_f32 v23, v23, v21
    v_mul_f32 v24, v24, v21
    v_mul_f32 v25, v25, v21
    v_accvgpr_write_b32 a20, v22
    v_accvgpr_write_b32 a21, v23
    v_accvgpr_write_b32 a22, v24
    v_accvgpr_write_b32 a23, v25
    v_accvgpr_read_b32 v22, a24
    v_accvgpr_read_b32 v23, a25
    v_accvgpr_read_b32 v24, a26
    v_accvgpr_read_b32 v25, a27
    v_mul_f32 v22, v22, v21
    v_mul_f32 v23, v23, v21
    v_mul_f32 v24, v24, v21
    v_mul_f32 v25, v25, v21
    v_accvgpr_write_b32 a24, v22
    v_accvgpr_write_b32 a25, v23
    v_accvgpr_write_b32 a26, v24
    v_accvgpr_write_b32 a27, v25
    v_accvgpr_read_b32 v22, a28
    v_accvgpr_read_b32 v23, a29
    v_accvgpr_read_b32 v24, a30
    v_accvgpr_read_b32 v25, a31
    v_mul_f32 v22, v22, v21
    v_mul_f32 v23, v23, v21
    v_mul_f32 v24, v24, v21
    v_mul_f32 v25, v25, v21
    v_accvgpr_write_b32 a28, v22
    v_accvgpr_write_b32 a29, v23
    v_accvgpr_write_b32 a30, v24
    v_accvgpr_write_b32 a31, v25
    v_accvgpr_read_b32 v22, a32
    v_accvgpr_read_b32 v23, a33
    v_accvgpr_read_b32 v24, a34
    v_accvgpr_read_b32 v25, a35
    v_mul_f32 v22, v22, v21
    v_mul_f32 v23, v23, v21
    v_mul_f32 v24, v24, v21
    v_mul_f32 v25, v25, v21
    v_accvgpr_write_b32 a32, v22
    v_accvgpr_write_b32 a33, v23
    v_accvgpr_write_b32 a34, v24
    v_accvgpr_write_b32 a35, v25
    v_accvgpr_read_b32 v22, a36
    v_accvgpr_read_b32 v23, a37
    v_accvgpr_read_b32 v24, a38
    v_accvgpr_read_b32 v25, a39
    v_mul_f32 v22, v22, v21
    v_mul_f32 v23, v23, v21
    v_mul_f32 v24, v24, v21
    v_mul_f32 v25, v25, v21
    v_accvgpr_write_b32 a36, v22
    v_accvgpr_write_b32 a37, v23
    v_accvgpr_write_b32 a38, v24
    v_accvgpr_write_b32 a39, v25
    v_accvgpr_read_b32 v22, a40
    v_accvgpr_read_b32 v23, a41
    v_accvgpr_read_b32 v24, a42
    v_accvgpr_read_b32 v25, a43
    v_mul_f32 v22, v22, v21
    v_mul_f32 v23, v23, v21
    v_mul_f32 v24, v24, v21
    v_mul_f32 v25, v25, v21
    v_accvgpr_write_b32 a40, v22
    v_accvgpr_write_b32 a41, v23
    v_accvgpr_write_b32 a42, v24
    v_accvgpr_write_b32 a43, v25
    v_accvgpr_read_b32 v22, a44
    v_accvgpr_read_b32 v23, a45
    v_accvgpr_read_b32 v24, a46
    v_accvgpr_read_b32 v25, a47
    v_mul_f32 v22, v22, v21
    v_mul_f32 v23, v23, v21
    v_mul_f32 v24, v24, v21
    v_mul_f32 v25, v25, v21
    v_accvgpr_write_b32 a44, v22
    v_accvgpr_write_b32 a45, v23
    v_accvgpr_write_b32 a46, v24
    v_accvgpr_write_b32 a47, v25
    v_accvgpr_read_b32 v22, a48
    v_accvgpr_read_b32 v23, a49
    v_accvgpr_read_b32 v24, a50
    v_accvgpr_read_b32 v25, a51
    v_mul_f32 v22, v22, v21
    v_mul_f32 v23, v23, v21
    v_mul_f32 v24, v24, v21
    v_mul_f32 v25, v25, v21
    v_accvgpr_write_b32 a48, v22
    v_accvgpr_write_b32 a49, v23
    v_accvgpr_write_b32 a50, v24
    v_accvgpr_write_b32 a51, v25
    v_accvgpr_read_b32 v22, a52
    v_accvgpr_read_b32 v23, a53
    v_accvgpr_read_b32 v24, a54
    v_accvgpr_read_b32 v25, a55
    v_mul_f32 v22, v22, v21
    v_mul_f32 v23, v23, v21
    v_mul_f32 v24, v24, v21
    v_mul_f32 v25, v25, v21
    v_accvgpr_write_b32 a52, v22
    v_accvgpr_write_b32 a53, v23
    v_accvgpr_write_b32 a54, v24
    v_accvgpr_write_b32 a55, v25
    v_accvgpr_read_b32 v22, a56
    v_accvgpr_read_b32 v23, a57
    v_accvgpr_read_b32 v24, a58
    v_accvgpr_read_b32 v25, a59
    v_mul_f32 v22, v22, v21
    v_mul_f32 v23, v23, v21
    v_mul_f32 v24, v24, v21
    v_mul_f32 v25, v25, v21
    v_accvgpr_write_b32 a56, v22
    v_accvgpr_write_b32 a57, v23
    v_accvgpr_write_b32 a58, v24
    v_accvgpr_write_b32 a59, v25
    v_accvgpr_read_b32 v22, a60
    v_accvgpr_read_b32 v23, a61
    v_accvgpr_read_b32 v24, a62
    v_accvgpr_read_b32 v25, a63
    v_mul_f32 v22, v22, v21
    v_mul_f32 v23, v23, v21
    v_mul_f32 v24, v24, v21
    v_mul_f32 v25, v25, v21
    v_accvgpr_write_b32 a60, v22
    v_accvgpr_write_b32 a61, v23
    v_accvgpr_write_b32 a62, v24
    v_accvgpr_write_b32 a63, v25
A_RARE0_D:
    s_nop 1
    s_setpc_b64 s[28:29]
A_RARE1:
    s_nop 1
    v_cndmask_b32 v20, 0, v16, vcc
    v_cndmask_b32 v9, v9, v19, vcc
    v_sub_f32 v21, 0, v20
    v_min_f32 v21, 0, v21
    v_exp_f32 v21, v21
    v_sub_f32 v128, v128, v20
    v_sub_f32 v129, v129, v20
    v_sub_f32 v130, v130, v20
    v_sub_f32 v131, v131, v20
    v_sub_f32 v132, v132, v20
    v_sub_f32 v133, v133, v20
    v_sub_f32 v134, v134, v20
    v_sub_f32 v135, v135, v20
    v_sub_f32 v136, v136, v20
    v_sub_f32 v137, v137, v20
    v_sub_f32 v138, v138, v20
    v_sub_f32 v139, v139, v20
    v_sub_f32 v140, v140, v20
    v_sub_f32 v141, v141, v20
    v_sub_f32 v142, v142, v20
    v_sub_f32 v143, v143, v20
    v_sub_f32 v144, v144, v20
    v_sub_f32 v145, v145, v20
    v_sub_f32 v146, v146, v20
    v_sub_f32 v147, v147, v20
    v_sub_f32 v148, v148, v20
    v_sub_f32 v149, v149, v20
    v_sub_f32 v150, v150, v20
    v_sub_f32 v151, v151, v20
    v_sub_f32 v152, v152, v20
    v_sub_f32 v153, v153, v20
    v_sub_f32 v154, v154, v20
    v_sub_f32 v155, v155, v20
    v_sub_f32 v156, v156, v20
    v_sub_f32 v157, v157, v20
    v_sub_f32 v158, v158, v20
    v_sub_f32 v159, v159, v20
    v_sub_f32 v208, v208, v20
    v_sub_f32 v209, v209, v20
    v_sub_f32 v210, v210, v20
    v_sub_f32 v211, v211, v20
    v_sub_f32 v212, v212, v20
    v_sub_f32 v213, v213, v20
    v_sub_f32 v214, v214, v20
    v_sub_f32 v215, v215, v20
    v_sub_f32 v216, v216, v20
    v_sub_f32 v217, v217, v20
    v_sub_f32 v218, v218, v20
    v_sub_f32 v219, v219, v20
    v_sub_f32 v220, v220, v20
    v_sub_f32 v221, v221, v20
    v_sub_f32 v222, v222, v20
    v_sub_f32 v223, v223, v20
    v_mul_f32 v12, v12, v21
    v_mul_f32 v13, v13, v21
    s_bitcmp1_b32 s25, 1
    s_cbranch_scc1 A_RARE1_D
    v_accvgpr_read_b32 v22, a64
    v_accvgpr_read_b32 v23, a65
    v_accvgpr_read_b32 v24, a66
    v_accvgpr_read_b32 v25, a67
    v_mul_f32 v22, v22, v21
    v_mul_f32 v23, v23, v21
    v_mul_f32 v24, v24, v21
    v_mul_f32 v25, v25, v21
    v_accvgpr_write_b32 a64, v22
    v_accvgpr_write_b32 a65, v23
    v_accvgpr_write_b32 a66, v24
    v_accvgpr_write_b32 a67, v25
    v_accvgpr_read_b32 v22, a68
    v_accvgpr_read_b32 v23, a69
    v_accvgpr_read_b32 v24, a70
    v_accvgpr_read_b32 v25, a71
    v_mul_f32 v22, v22, v21
    v_mul_f32 v23, v23, v21
    v_mul_f32 v24, v24, v21
    v_mul_f32 v25, v25, v21
    v_accvgpr_write_b32 a68, v22
    v_accvgpr_write_b32 a69, v23
    v_accvgpr_write_b32 a70, v24
    v_accvgpr_write_b32 a71, v25
    v_accvgpr_read_b32 v22, a72
    v_accvgpr_read_b32 v23, a73
    v_accvgpr_read_b32 v24, a74
    v_accvgpr_read_b32 v25, a75
    v_mul_f32 v22, v22, v21
    v_mul_f32 v23, v23, v21
    v_mul_f32 v24, v24, v21
    v_mul_f32 v25, v25, v21
    v_accvgpr_write_b32 a72, v22
    v_accvgpr_write_b32 a73, v23
    v_accvgpr_write_b32 a74, v24
    v_accvgpr_write_b32 a75, v25
    v_accvgpr_read_b32 v22, a76
    v_accvgpr_read_b32 v23, a77
    v_accvgpr_read_b32 v24, a78
    v_accvgpr_read_b32 v25, a79
    v_mul_f32 v22, v22, v21
    v_mul_f32 v23, v23, v21
    v_mul_f32 v24, v24, v21
    v_mul_f32 v25, v25, v21
    v_accvgpr_write_b32 a76, v22
    v_accvgpr_write_b32 a77, v23
    v_accvgpr_write_b32 a78, v24
    v_accvgpr_write_b32 a79, v25
    v_accvgpr_read_b32 v22, a80
    v_accvgpr_read_b32 v23, a81
    v_accvgpr_read_b32 v24, a82
    v_accvgpr_read_b32 v25, a83
    v_mul_f32 v22, v22, v21
    v_mul_f32 v23, v23, v21
    v_mul_f32 v24, v24, v21
    v_mul_f32 v25, v25, v21
    v_accvgpr_write_b32 a80, v22
    v_accvgpr_write_b32 a81, v23
    v_accvgpr_write_b32 a82, v24
    v_accvgpr_write_b32 a83, v25
    v_accvgpr_read_b32 v22, a84
    v_accvgpr_read_b32 v23, a85
    v_accvgpr_read_b32 v24, a86
    v_accvgpr_read_b32 v25, a87
    v_mul_f32 v22, v22, v21
    v_mul_f32 v23, v23, v21
    v_mul_f32 v24, v24, v21
    v_mul_f32 v25, v25, v21
    v_accvgpr_write_b32 a84, v22
    v_accvgpr_write_b32 a85, v23
    v_accvgpr_write_b32 a86, v24
    v_accvgpr_write_b32 a87, v25
    v_accvgpr_read_b32 v22, a88
    v_accvgpr_read_b32 v23, a89
    v_accvgpr_read_b32 v24, a90
    v_accvgpr_read_b32 v25, a91
    v_mul_f32 v22, v22, v21
    v_mul_f32 v23, v23, v21
    v_mul_f32 v24, v24, v21
    v_mul_f32 v25, v25, v21
    v_accvgpr_write_b32 a88, v22
    v_accvgpr_write_b32 a89, v23
    v_accvgpr_write_b32 a90, v24
    v_accvgpr_write_b32 a91, v25
    v_accvgpr_read_b32 v22, a92
    v_accvgpr_read_b32 v23, a93
    v_accvgpr_read_b32 v24, a94
    v_accvgpr_read_b32 v25, a95
    v_mul_f32 v22, v22, v21
    v_mul_f32 v23, v23, v21
    v_mul_f32 v24, v24, v21
    v_mul_f32 v25, v25, v21
    v_accvgpr_write_b32 a92, v22
    v_accvgpr_write_b32 a93, v23
    v_accvgpr_write_b32 a94, v24
    v_accvgpr_write_b32 a95, v25
    v_accvgpr_read_b32 v22, a96
    v_accvgpr_read_b32 v23, a97
    v_accvgpr_read_b32 v24, a98
    v_accvgpr_read_b32 v25, a99
    v_mul_f32 v22, v22, v21
    v_mul_f32 v23, v23, v21
    v_mul_f32 v24, v24, v21
    v_mul_f32 v25, v25, v21
    v_accvgpr_write_b32 a96, v22
    v_accvgpr_write_b32 a97, v23
    v_accvgpr_write_b32 a98, v24
    v_accvgpr_write_b32 a99, v25
    v_accvgpr_read_b32 v22, a100
    v_accvgpr_read_b32 v23, a101
    v_accvgpr_read_b32 v24, a102
    v_accvgpr_read_b32 v25, a103
    v_mul_f32 v22, v22, v21
    v_mul_f32 v23, v23, v21
    v_mul_f32 v24, v24, v21
    v_mul_f32 v25, v25, v21
    v_accvgpr_write_b32 a100, v22
    v_accvgpr_write_b32 a101, v23
    v_accvgpr_write_b32 a102, v24
    v_accvgpr_write_b32 a103, v25
    v_accvgpr_read_b32 v22, a104
    v_accvgpr_read_b32 v23, a105
    v_accvgpr_read_b32 v24, a106
    v_accvgpr_read_b32 v25, a107
    v_mul_f32 v22, v22, v21
    v_mul_f32 v23, v23, v21
    v_mul_f32 v24, v24, v21
    v_mul_f32 v25, v25, v21
    v_accvgpr_write_b32 a104, v22
    v_accvgpr_write_b32 a105, v23
    v_accvgpr_write_b32 a106, v24
    v_accvgpr_write_b32 a107, v25
    v_accvgpr_read_b32 v22, a108
    v_accvgpr_read_b32 v23, a109
    v_accvgpr_read_b32 v24, a110
    v_accvgpr_read_b32 v25, a111
    v_mul_f32 v22, v22, v21
    v_mul_f32 v23, v23, v21
    v_mul_f32 v24, v24, v21
    v_mul_f32 v25, v25, v21
    v_accvgpr_write_b32 a108, v22
    v_accvgpr_write_b32 a109, v23
    v_accvgpr_write_b32 a110, v24
    v_accvgpr_write_b32 a111, v25
    v_accvgpr_read_b32 v22, a112
    v_accvgpr_read_b32 v23, a113
    v_accvgpr_read_b32 v24, a114
    v_accvgpr_read_b32 v25, a115
    v_mul_f32 v22, v22, v21
    v_mul_f32 v23, v23, v21
    v_mul_f32 v24, v24, v21
    v_mul_f32 v25, v25, v21
    v_accvgpr_write_b32 a112, v22
    v_accvgpr_write_b32 a113, v23
    v_accvgpr_write_b32 a114, v24
    v_accvgpr_write_b32 a115, v25
    v_accvgpr_read_b32 v22, a116
    v_accvgpr_read_b32 v23, a117
    v_accvgpr_read_b32 v24, a118
    v_accvgpr_read_b32 v25, a119
    v_mul_f32 v22, v22, v21
    v_mul_f32 v23, v23, v21
    v_mul_f32 v24, v24, v21
    v_mul_f32 v25, v25, v21
    v_accvgpr_write_b32 a116, v22
    v_accvgpr_write_b32 a117, v23
    v_accvgpr_write_b32 a118, v24
    v_accvgpr_write_b32 a119, v25
    v_accvgpr_read_b32 v22, a120
    v_accvgpr_read_b32 v23, a121
    v_accvgpr_read_b32 v24, a122
    v_accvgpr_read_b32 v25, a123
    v_mul_f32 v22, v22, v21
    v_mul_f32 v23, v23, v21
    v_mul_f32 v24, v24, v21
    v_mul_f32 v25, v25, v21
    v_accvgpr_write_b32 a120, v22
    v_accvgpr_write_b32 a121, v23
    v_accvgpr_write_b32 a122, v24
    v_accvgpr_write_b32 a123, v25
    v_accvgpr_read_b32 v22, a124
    v_accvgpr_read_b32 v23, a125
    v_accvgpr_read_b32 v24, a126
    v_accvgpr_read_b32 v25, a127
    v_mul_f32 v22, v22, v21
    v_mul_f32 v23, v23, v21
    v_mul_f32 v24, v24, v21
    v_mul_f32 v25, v25, v21
    v_accvgpr_write_b32 a124, v22
    v_accvgpr_write_b32 a125, v23
    v_accvgpr_write_b32 a126, v24
    v_accvgpr_write_b32 a127, v25
A_RARE1_D:
    s_nop 1
    s_setpc_b64 s[28:29]
A_SPIN:
    s_mov_b32 s99, 200000
A_SPIN1:
    s_sleep 4
    global_load_dword v253, v252, s[72:73] sc0 sc1
    s_waitcnt vmcnt(0)
    v_readfirstlane_b32 s98, v253
    s_nop 3
    s_and_b32 s98, s98, 0xffff
    s_cmp_ge_u32 s98, 8
    s_cbranch_scc1 A_READY
    s_sub_u32 s99, s99, 1
    s_cmp_lg_u32 s99, 0
    s_cbranch_scc1 A_SPIN1
    s_branch A_READY
.globl mqa_kernel
.p2align 8
.type mqa_kernel,@function
mqa_kernel:
    s_cmp_ge_u32 s2, 256
    s_cbranch_scc1 M_END
    s_load_dwordx2 s[34:35], s[0:1], 112
    s_load_dwordx4 s[40:43], s[0:1], 96
    v_lshrrev_b32 v1, 6, v0
    v_and_b32 v0, 63, v0
    v_readfirstlane_b32 s3, v1
    v_lshlrev_b32 v1, 4, v0
    v_mov_b32 v2, v1
    v_bfe_u32 v160, v0, 2, 2
    v_and_b32 v161, 3, v0
    v_bfe_u32 v163, v0, 4, 1
    v_lshrrev_b32 v164, 5, v0
    v_lshl_add_u32 v165, v164, 2, v160
    v_lshlrev_b32 v166, 3, v161
    v_lshl_add_u32 v3, v165, 5, v166
    v_cmp_eq_u32 vcc, 0, v163
    v_mov_b32 v167, 131072
    v_mov_b32 v168, 65536
    v_cndmask_b32 v167, v167, v168, vcc
    v_add_u32 v3, v3, v167
    v_mov_b32 v5, v3
    v_mov_b32 v168, 1024
    v_cndmask_b32 v4, 0, v168, vcc
    s_and_b32 s48, s2, 7
    s_lshl_b32 s48, s48, 2
    s_lshr_b32 s49, s2, 3
    s_and_b32 s49, s49, 3
    s_add_u32 s48, s48, s49
    s_lshr_b32 s49, s2, 5
    s_lshr_b32 s50, s3, 1
    s_and_b32 s51, s3, 1
    s_mov_b32 s24, s48
    s_mov_b32 s25, s49
    s_lshl_b32 s20, s3, 19
    s_lshl_b32 s52, s49, 11
    s_add_u32 s20, s20, s52
    s_add_u32 s20, s20, 83886080
    s_add_u32 s21, s20, 16384
    s_lshl_b32 s18, s48, 19
    s_lshl_b32 s52, s3, 15
    s_add_u32 s18, s18, s52
    s_add_u32 s18, s18, 50331648
    s_add_u32 s19, s18, 262144
    s_lshl_b32 s23, s48, 1
    s_and_b32 s52, s50, 1
    s_add_u32 s23, s23, s52
    s_lshl_b32 s23, s23, 4
    s_lshl_b32 s52, s49, 1
    s_add_u32 s23, s23, s52
    s_lshr_b32 s52, s3, 2
    s_add_u32 s23, s23, s52
    s_lshl_b32 s23, s23, 1
    s_add_u32 s23, s23, s51
    s_lshl_b32 s23, s23, 10
    s_add_u32 s23, s23, 75497472
    s_and_b32 s48, s2, 31
    s_lshl_b32 s49, s49, 3
    s_add_u32 s49, s49, s3
    s_lshl_b32 s50, s48, 16
    s_lshl_b32 s51, s49, 10
    s_add_u32 s50, s50, s51
    s_add_u32 s50, s50, 67108864
    s_lshl_b32 s22, s49, 15
    s_lshl_b32 s51, s48, 10
    s_add_u32 s22, s22, s51
    s_add_u32 s22, s22, 71303168
    s_waitcnt lgkmcnt(0)
    s_mov_b32 s36, s34
    s_and_b32 s37, s35, 0xffff
    s_mov_b32 s38, 268435456
    s_mov_b32 s39, 0x20000
    s_mov_b32 s44, s40
    s_and_b32 s45, s41, 0xffff
    s_mov_b32 s46, 2097152
    s_mov_b32 s47, 0x20000
    buffer_load_dwordx4 v[8:11], v1, s[36:39], s50 offen
    s_lshl_b32 s52, s3, 10
    s_add_u32 s49, s52, 69206016
    s_add_u32 m0, s52, 0
    s_add_u32 s50, s49, 0
    buffer_load_dwordx4 v1, s[36:39], s50 offen lds
    s_add_u32 m0, s52, 65536
    s_add_u32 s50, s49, 65536
    buffer_load_dwordx4 v1, s[36:39], s50 offen lds
    v_and_b32 v12, 1, v0
    v_cmp_eq_u32 vcc, 0, v12
    v_mov_b32 v13, 0x3f80
    v_mov_b32 v15, 0
    v_mov_b32 v16, 0
    v_mov_b32 v17, 0
    v_cndmask_b32 v14, 0, v13, vcc
    v_add_u32 v12, 131072, v1
    ds_write_b128 v12, v[14:17]
    buffer_load_dwordx4 v[160:163], v1, s[36:39], s20 offen
    buffer_load_dwordx4 v[164:167], v1, s[36:39], s20 offen offset:1024
    buffer_load_dwordx4 v[168:171], v1, s[36:39], s18 offen offset:0
    buffer_load_dwordx4 v[172:175], v1, s[36:39], s19 offen offset:0
    buffer_load_dwordx4 v[176:179], v1, s[36:39], s21 offen
    buffer_load_dwordx4 v[180:183], v1, s[36:39], s21 offen offset:1024
    buffer_load_dwordx4 v[184:187], v1, s[36:39], s18 offen offset:1024
    buffer_load_dwordx4 v[188:191], v1, s[36:39], s19 offen offset:1024
    s_add_u32 s20, s20, 32768
    s_add_u32 s21, s21, 32768
    s_add_u32 s18, s18, 2048
    s_add_u32 s19, s19, 2048
    v_mov_b32 v92, 0
    v_mov_b32 v93, 0
    v_mov_b32 v94, 0
    v_mov_b32 v95, 0
    v_mov_b32 v96, 0
    v_mov_b32 v97, 0
    v_mov_b32 v98, 0
    v_mov_b32 v99, 0
    v_mov_b32 v100, 0
    v_mov_b32 v101, 0
    v_mov_b32 v102, 0
    v_mov_b32 v103, 0
    v_mov_b32 v104, 0
    v_mov_b32 v105, 0
    v_mov_b32 v106, 0
    v_mov_b32 v107, 0
    v_mov_b32 v192, 0
    v_mov_b32 v193, 0
    v_mov_b32 v194, 0
    v_mov_b32 v195, 0
    v_mov_b32 v196, 0
    v_mov_b32 v197, 0
    v_mov_b32 v198, 0
    v_mov_b32 v199, 0
    v_mov_b32 v200, 0
    v_mov_b32 v201, 0
    v_mov_b32 v202, 0
    v_mov_b32 v203, 0
    v_mov_b32 v204, 0
    v_mov_b32 v205, 0
    v_mov_b32 v206, 0
    v_mov_b32 v207, 0
    v_mov_b32 v208, 0
    v_mov_b32 v209, 0
    v_mov_b32 v210, 0
    v_mov_b32 v211, 0
    v_mov_b32 v212, 0
    v_mov_b32 v213, 0
    v_mov_b32 v214, 0
    v_mov_b32 v215, 0
    v_mov_b32 v216, 0
    v_mov_b32 v217, 0
    v_mov_b32 v218, 0
    v_mov_b32 v219, 0
    v_mov_b32 v220, 0
    v_mov_b32 v221, 0
    v_mov_b32 v222, 0
    v_mov_b32 v223, 0
    v_mov_b32 v224, 0
    v_mov_b32 v225, 0
    v_mov_b32 v226, 0
    v_mov_b32 v227, 0
    v_mov_b32 v228, 0
    v_mov_b32 v229, 0
    v_mov_b32 v230, 0
    v_mov_b32 v231, 0
    v_mov_b32 v232, 0
    v_mov_b32 v233, 0
    v_mov_b32 v234, 0
    v_mov_b32 v235, 0
    v_mov_b32 v236, 0
    v_mov_b32 v237, 0
    v_mov_b32 v238, 0
    v_mov_b32 v239, 0
    v_mov_b32 v240, 0
    v_mov_b32 v241, 0
    v_mov_b32 v242, 0
    v_mov_b32 v243, 0
    v_mov_b32 v244, 0
    v_mov_b32 v245, 0
    v_mov_b32 v246, 0
    v_mov_b32 v247, 0
    v_mov_b32 v248, 0
    v_mov_b32 v249, 0
    v_mov_b32 v250, 0
    v_mov_b32 v251, 0
    v_mov_b32 v252, 0
    v_mov_b32 v253, 0
    v_mov_b32 v254, 0
    v_mov_b32 v255, 0
    v_mov_b32 v140, 0
    v_mov_b32 v141, 0
    v_mov_b32 v142, 0
    v_mov_b32 v143, 0
    v_mov_b32 v144, 0
    v_mov_b32 v145, 0
    v_mov_b32 v146, 0
    v_mov_b32 v147, 0
    v_mov_b32 v148, 0
    v_mov_b32 v149, 0
    v_mov_b32 v150, 0
    v_mov_b32 v151, 0
    v_mov_b32 v152, 0
    v_mov_b32 v153, 0
    v_mov_b32 v154, 0
    v_mov_b32 v155, 0
    v_mov_b32 v44, 0
    v_mov_b32 v45, 0
    v_mov_b32 v46, 0
    v_mov_b32 v47, 0
    v_mov_b32 v48, 0
    v_mov_b32 v49, 0
    v_mov_b32 v50, 0
    v_mov_b32 v51, 0
    v_mov_b32 v52, 0
    v_mov_b32 v53, 0
    v_mov_b32 v54, 0
    v_mov_b32 v55, 0
    v_mov_b32 v56, 0
    v_mov_b32 v57, 0
    v_mov_b32 v58, 0
    v_mov_b32 v59, 0
    v_mov_b32 v60, 0xff800000
    v_mov_b32 v61, 0xff800000
    v_mov_b32 v62, 0xff800000
    v_mov_b32 v63, 0xff800000
    v_mov_b32 v64, 0xff800000
    v_mov_b32 v65, 0xff800000
    v_mov_b32 v66, 0xff800000
    v_mov_b32 v67, 0xff800000
    v_mov_b32 v68, 0xff800000
    v_mov_b32 v69, 0xff800000
    v_mov_b32 v70, 0xff800000
    v_mov_b32 v71, 0xff800000
    v_mov_b32 v72, 0xff800000
    v_mov_b32 v73, 0xff800000
    v_mov_b32 v74, 0xff800000
    v_mov_b32 v75, 0xff800000
    s_waitcnt vmcnt(8)
    s_waitcnt lgkmcnt(0)
    s_barrier
    ds_read_b128 v[108:111], v2 offset:0
    ds_read_b128 v[112:115], v2 offset:1024
    ds_read_b128 v[116:119], v2 offset:2048
    ds_read_b128 v[120:123], v2 offset:3072
    s_waitcnt lgkmcnt(3)
    v_mfma_f32_32x32x16_bf16 v[12:27], v[108:111], v[8:11], 0
    s_waitcnt lgkmcnt(2)
    v_mfma_f32_32x32x16_bf16 v[28:43], v[112:115], v[8:11], 0
    s_nop 10
    v_max3_f32 v6, v12, v13, v14
    v_max3_f32 v6, v6, v15, v16
    v_max3_f32 v6, v6, v17, v18
    v_max3_f32 v6, v6, v19, v20
    v_max3_f32 v6, v6, v21, v22
    v_max3_f32 v6, v6, v23, v24
    v_max3_f32 v6, v6, v25, v26
    v_max_f32 v6, v6, v27
    v_max3_f32 v7, v28, v29, v30
    v_max3_f32 v7, v7, v31, v32
    v_max3_f32 v7, v7, v33, v34
    v_max3_f32 v7, v7, v35, v36
    v_max3_f32 v7, v7, v37, v38
    v_max3_f32 v7, v7, v39, v40
    v_max3_f32 v7, v7, v41, v42
    v_max3_f32 v6, v6, v7, v43
    v_mov_b32 v7, v6
    s_nop 1
    v_permlane32_swap_b32 v7, v6
    v_max_f32 v6, v6, v7
    v_sub_f32 v76, 0, v6
    v_sub_f32 v77, 0, v6
    v_sub_f32 v78, 0, v6
    v_sub_f32 v79, 0, v6
    v_sub_f32 v80, 0, v6
    v_sub_f32 v81, 0, v6
    v_sub_f32 v82, 0, v6
    v_sub_f32 v83, 0, v6
    v_sub_f32 v84, 0, v6
    v_sub_f32 v85, 0, v6
    v_sub_f32 v86, 0, v6
    v_sub_f32 v87, 0, v6
    v_sub_f32 v88, 0, v6
    v_sub_f32 v89, 0, v6
    v_sub_f32 v90, 0, v6
    v_sub_f32 v91, 0, v6
    s_mov_b32 s16, 15
    s_nop 0
    v_mfma_f32_32x32x16_bf16 v[12:27], v[108:111], v[8:11], v[76:91]
    s_add_u32 m0, s52, 8192
    s_add_u32 s50, s49, 8192
    buffer_load_dwordx4 v1, s[36:39], s50 offen lds
    v_exp_f32 v60, v60
    v_exp_f32 v61, v61
    v_exp_f32 v62, v62
    v_exp_f32 v63, v63
    v_mfma_f32_32x32x16_bf16 v[28:43], v[112:115], v[8:11], v[76:91]
    s_add_u32 m0, s52, 73728
    s_add_u32 s50, s49, 73728
    buffer_load_dwordx4 v1, s[36:39], s50 offen lds
    v_exp_f32 v64, v64
    v_exp_f32 v65, v65
    v_cvt_pk_bf16_f32 v60, v60, v61
    v_exp_f32 v66, v66
    ds_read_b64_tr_b16 v[124:125], v3 offset:0
    s_waitcnt vmcnt(7)
    v_mfma_f32_32x32x16_bf16 v[192:207], v[160:163], v[168:171], v[192:207]
    s_add_u32 m0, s52, 16384
    s_add_u32 s50, s49, 16384
    buffer_load_dwordx4 v1, s[36:39], s50 offen lds
    v_exp_f32 v67, v67
    v_cvt_pk_bf16_f32 v61, v62, v63
    v_exp_f32 v68, v68
    v_exp_f32 v69, v69
    v_cvt_pk_bf16_f32 v62, v64, v65
    s_waitcnt vmcnt(7)
    v_mfma_f32_32x32x16_bf16 v[208:223], v[160:163], v[172:175], v[208:223]
    s_add_u32 m0, s52, 81920
    s_add_u32 s50, s49, 81920
    buffer_load_dwordx4 v1, s[36:39], s50 offen lds
    v_exp_f32 v70, v70
    v_exp_f32 v71, v71
    v_cvt_pk_bf16_f32 v63, v66, v67
    buffer_load_dwordx4 v[160:163], v1, s[36:39], s20 offen
    ds_read_b64_tr_b16 v[126:127], v3 offset:256
    v_mfma_f32_32x32x16_bf16 v[92:107], v[140:143], v[44:47], v[92:107]
    s_add_u32 m0, s52, 24576
    s_add_u32 s50, s49, 24576
    buffer_load_dwordx4 v1, s[36:39], s50 offen lds
    v_exp_f32 v72, v72
    v_exp_f32 v73, v73
    v_cvt_pk_bf16_f32 v68, v68, v69
    v_exp_f32 v74, v74
    ds_read_b64_tr_b16 v[128:129], v3 offset:512
    v_mfma_f32_32x32x16_bf16 v[224:239], v[164:167], v[168:171], v[224:239]
    s_add_u32 m0, s52, 90112
    s_add_u32 s50, s49, 90112
    buffer_load_dwordx4 v1, s[36:39], s50 offen lds
    v_exp_f32 v75, v75
    v_cvt_pk_bf16_f32 v69, v70, v71
    v_cvt_pk_bf16_f32 v70, v72, v73
    v_cvt_pk_bf16_f32 v71, v74, v75
    ds_read_b128 v[108:111], v2 offset:4096
    ds_read_b128 v[112:115], v2 offset:5120
    ds_read_b64_tr_b16 v[130:131], v3 offset:768
    v_mfma_f32_32x32x16_bf16 v[92:107], v[144:147], v[52:55], v[92:107]
    s_add_u32 m0, s52, 32768
    s_add_u32 s50, s49, 32768
    buffer_load_dwordx4 v1, s[36:39], s50 offen lds
    buffer_load_dwordx4 v[168:171], v1, s[36:39], s18 offen offset:0
    v_add_u32 v3, v4, v3
    ds_read_b64_tr_b16 v[132:133], v3 offset:0
    ds_read_b64_tr_b16 v[134:135], v3 offset:256
    ds_read_b64_tr_b16 v[136:137], v3 offset:512
    ds_read_b64_tr_b16 v[138:139], v3 offset:768
    v_add_u32 v3, v4, v3
    v_mfma_f32_32x32x16_bf16 v[240:255], v[164:167], v[172:175], v[240:255]
    s_add_u32 m0, s52, 98304
    s_add_u32 s50, s49, 98304
    buffer_load_dwordx4 v1, s[36:39], s50 offen lds
    buffer_load_dwordx4 v[164:167], v1, s[36:39], s20 offen offset:1024
    v_exp_f32 v12, v12
    v_exp_f32 v13, v13
    v_exp_f32 v14, v14
    v_mfma_f32_32x32x16_bf16 v[92:107], v[148:151], v[60:63], v[92:107]
    buffer_load_dwordx4 v[172:175], v1, s[36:39], s19 offen offset:0
    s_add_u32 m0, s52, 40960
    s_add_u32 s50, s49, 40960
    buffer_load_dwordx4 v1, s[36:39], s50 offen lds
    v_exp_f32 v15, v15
    v_exp_f32 v16, v16
    v_exp_f32 v17, v17
    v_mfma_f32_32x32x16_bf16 v[92:107], v[152:155], v[68:71], v[92:107]
    s_add_u32 m0, s52, 106496
    s_add_u32 s50, s49, 106496
    buffer_load_dwordx4 v1, s[36:39], s50 offen lds
    v_cvt_pk_bf16_f32 v12, v12, v13
    v_exp_f32 v18, v18
    v_exp_f32 v19, v19
    v_cvt_pk_bf16_f32 v13, v14, v15
    v_exp_f32 v20, v20
    s_waitcnt lgkmcnt(11)
    v_mfma_f32_32x32x16_bf16 v[44:59], v[116:119], v[8:11], v[76:91]
    s_add_u32 m0, s52, 49152
    s_add_u32 s50, s49, 49152
    buffer_load_dwordx4 v1, s[36:39], s50 offen lds
    v_exp_f32 v21, v21
    v_cvt_pk_bf16_f32 v14, v16, v17
    v_exp_f32 v22, v22
    v_exp_f32 v23, v23
    v_cvt_pk_bf16_f32 v15, v18, v19
    s_waitcnt lgkmcnt(10)
    v_mfma_f32_32x32x16_bf16 v[60:75], v[120:123], v[8:11], v[76:91]
    s_add_u32 m0, s52, 114688
    s_add_u32 s50, s49, 114688
    buffer_load_dwordx4 v1, s[36:39], s50 offen lds
    v_exp_f32 v24, v24
    v_exp_f32 v25, v25
    v_cvt_pk_bf16_f32 v20, v20, v21
    v_exp_f32 v26, v26
    ds_read_b64_tr_b16 v[140:141], v3 offset:0
    s_waitcnt vmcnt(17)
    v_mfma_f32_32x32x16_bf16 v[192:207], v[176:179], v[184:187], v[192:207]
    s_add_u32 m0, s52, 57344
    s_add_u32 s50, s49, 57344
    buffer_load_dwordx4 v1, s[36:39], s50 offen lds
    v_exp_f32 v27, v27
    v_cvt_pk_bf16_f32 v21, v22, v23
    v_cvt_pk_bf16_f32 v22, v24, v25
    v_cvt_pk_bf16_f32 v23, v26, v27
    v_exp_f32 v28, v28
    ds_read_b64_tr_b16 v[142:143], v3 offset:256
    s_waitcnt vmcnt(17)
    v_mfma_f32_32x32x16_bf16 v[208:223], v[176:179], v[188:191], v[208:223]
    s_add_u32 m0, s52, 122880
    s_add_u32 s50, s49, 122880
    buffer_load_dwordx4 v1, s[36:39], s50 offen lds
    v_exp_f32 v29, v29
    v_exp_f32 v30, v30
    v_exp_f32 v31, v31
    v_exp_f32 v32, v32
    s_waitcnt lgkmcnt(10)
    v_mfma_f32_32x32x16_bf16 v[92:107], v[124:127], v[12:15], v[92:107]
    v_exp_f32 v33, v33
    v_cvt_pk_bf16_f32 v28, v28, v29
    v_exp_f32 v34, v34
    v_exp_f32 v35, v35
    v_cvt_pk_bf16_f32 v29, v30, v31
    v_exp_f32 v36, v36
    ds_read_b64_tr_b16 v[144:145], v3 offset:512
    v_mfma_f32_32x32x16_bf16 v[224:239], v[180:183], v[184:187], v[224:239]
    v_exp_f32 v37, v37
    v_cvt_pk_bf16_f32 v30, v32, v33
    v_exp_f32 v38, v38
    v_exp_f32 v39, v39
    v_cvt_pk_bf16_f32 v31, v34, v35
    buffer_load_dwordx4 v[176:179], v1, s[36:39], s21 offen
    ds_read_b64_tr_b16 v[146:147], v3 offset:768
    s_waitcnt lgkmcnt(8)
    v_mfma_f32_32x32x16_bf16 v[92:107], v[128:131], v[20:23], v[92:107]
    v_exp_f32 v40, v40
    v_exp_f32 v41, v41
    v_cvt_pk_bf16_f32 v36, v36, v37
    v_exp_f32 v42, v42
    v_exp_f32 v43, v43
    v_cvt_pk_bf16_f32 v37, v38, v39
    v_cvt_pk_bf16_f32 v38, v40, v41
    v_mfma_f32_32x32x16_bf16 v[240:255], v[180:183], v[188:191], v[240:255]
    v_cvt_pk_bf16_f32 v39, v42, v43
    ds_read_b128 v[116:119], v2 offset:6144
    ds_read_b128 v[120:123], v2 offset:7168
    buffer_load_dwordx4 v[184:187], v1, s[36:39], s18 offen offset:1024
    buffer_load_dwordx4 v[180:183], v1, s[36:39], s21 offen offset:1024
    v_exp_f32 v44, v44
    v_exp_f32 v45, v45
    s_waitcnt lgkmcnt(8)
    v_mfma_f32_32x32x16_bf16 v[92:107], v[132:135], v[28:31], v[92:107]
    buffer_load_dwordx4 v[188:191], v1, s[36:39], s19 offen offset:1024
    v_exp_f32 v46, v46
    v_exp_f32 v47, v47
    v_exp_f32 v48, v48
    v_exp_f32 v49, v49
    v_cvt_pk_bf16_f32 v44, v44, v45
    s_waitcnt lgkmcnt(6)
    v_mfma_f32_32x32x16_bf16 v[92:107], v[136:139], v[36:39], v[92:107]
    v_exp_f32 v50, v50
    v_exp_f32 v51, v51
    v_cvt_pk_bf16_f32 v45, v46, v47
    v_exp_f32 v52, v52
    v_exp_f32 v53, v53
    v_cvt_pk_bf16_f32 v46, v48, v49
    v_exp_f32 v54, v54
    v_exp_f32 v55, v55
    v_cvt_pk_bf16_f32 v47, v50, v51
    v_exp_f32 v56, v56
    v_exp_f32 v57, v57
    v_cvt_pk_bf16_f32 v52, v52, v53
    v_exp_f32 v58, v58
    v_exp_f32 v59, v59
    v_cvt_pk_bf16_f32 v53, v54, v55
    v_cvt_pk_bf16_f32 v54, v56, v57
    v_cvt_pk_bf16_f32 v55, v58, v59
    v_add_u32 v3, v4, v3
    ds_read_b64_tr_b16 v[148:149], v3 offset:0
    ds_read_b64_tr_b16 v[150:151], v3 offset:256
    ds_read_b64_tr_b16 v[152:153], v3 offset:512
    ds_read_b64_tr_b16 v[154:155], v3 offset:768
    v_add_u32 v3, v4, v3
    v_add_u32 v2, 4096, v2
    s_add_u32 s20, s20, 32768
    s_add_u32 s21, s21, 32768
    s_add_u32 s18, s18, 2048
    s_add_u32 s19, s19, 2048
    s_waitcnt vmcnt(4)
    s_barrier
M_LOOP:
    v_mfma_f32_32x32x16_bf16 v[12:27], v[108:111], v[8:11], v[76:91]
    v_exp_f32 v60, v60
    v_exp_f32 v61, v61
    v_exp_f32 v62, v62
    v_exp_f32 v63, v63
    v_exp_f32 v64, v64
    ds_read_b64_tr_b16 v[124:125], v3 offset:0
    v_mfma_f32_32x32x16_bf16 v[28:43], v[112:115], v[8:11], v[76:91]
    v_exp_f32 v65, v65
    v_cvt_pk_bf16_f32 v60, v60, v61
    v_exp_f32 v66, v66
    v_exp_f32 v67, v67
    v_cvt_pk_bf16_f32 v61, v62, v63
    v_exp_f32 v68, v68
    ds_read_b64_tr_b16 v[126:127], v3 offset:256
    s_waitcnt vmcnt(6)
    v_mfma_f32_32x32x16_bf16 v[192:207], v[160:163], v[168:171], v[192:207]
    v_exp_f32 v69, v69
    v_cvt_pk_bf16_f32 v62, v64, v65
    v_exp_f32 v70, v70
    v_exp_f32 v71, v71
    v_cvt_pk_bf16_f32 v63, v66, v67
    v_exp_f32 v72, v72
    ds_read_b64_tr_b16 v[128:129], v3 offset:512
    s_waitcnt vmcnt(4)
    v_mfma_f32_32x32x16_bf16 v[208:223], v[160:163], v[172:175], v[208:223]
    buffer_load_dwordx4 v[160:163], v1, s[36:39], s20 offen
    v_exp_f32 v73, v73
    v_cvt_pk_bf16_f32 v68, v68, v69
    v_exp_f32 v74, v74
    v_exp_f32 v75, v75
    v_cvt_pk_bf16_f32 v69, v70, v71
    v_cvt_pk_bf16_f32 v70, v72, v73
    s_waitcnt lgkmcnt(9)
    v_mfma_f32_32x32x16_bf16 v[92:107], v[140:143], v[44:47], v[92:107]
    v_cvt_pk_bf16_f32 v71, v74, v75
    ds_read_b128 v[108:111], v2 offset:4096
    ds_read_b128 v[112:115], v2 offset:5120
    ds_read_b64_tr_b16 v[130:131], v3 offset:768
    v_add_u32 v3, v4, v3
    ds_read_b64_tr_b16 v[132:133], v3 offset:0
    ds_read_b64_tr_b16 v[134:135], v3 offset:256
    ds_read_b64_tr_b16 v[136:137], v3 offset:512
    ds_read_b64_tr_b16 v[138:139], v3 offset:768
    v_add_u32 v3, v4, v3
    v_mfma_f32_32x32x16_bf16 v[224:239], v[164:167], v[168:171], v[224:239]
    buffer_load_dwordx4 v[168:171], v1, s[36:39], s18 offen offset:0
    v_exp_f32 v12, v12
    v_exp_f32 v13, v13
    v_exp_f32 v14, v14
    v_exp_f32 v15, v15
    s_waitcnt lgkmcnt(14)
    v_mfma_f32_32x32x16_bf16 v[92:107], v[144:147], v[52:55], v[92:107]
    v_exp_f32 v16, v16
    v_exp_f32 v17, v17
    v_cvt_pk_bf16_f32 v12, v12, v13
    v_exp_f32 v18, v18
    v_exp_f32 v19, v19
    v_cvt_pk_bf16_f32 v13, v14, v15
    v_mfma_f32_32x32x16_bf16 v[240:255], v[164:167], v[172:175], v[240:255]
    buffer_load_dwordx4 v[164:167], v1, s[36:39], s20 offen offset:1024
    v_exp_f32 v20, v20
    v_exp_f32 v21, v21
    v_cvt_pk_bf16_f32 v14, v16, v17
    v_exp_f32 v22, v22
    v_exp_f32 v23, v23
    s_waitcnt lgkmcnt(12)
    v_mfma_f32_32x32x16_bf16 v[92:107], v[148:151], v[60:63], v[92:107]
    buffer_load_dwordx4 v[172:175], v1, s[36:39], s19 offen offset:0
    v_cvt_pk_bf16_f32 v15, v18, v19
    v_exp_f32 v24, v24
    v_exp_f32 v25, v25
    v_cvt_pk_bf16_f32 v20, v20, v21
    v_exp_f32 v26, v26
    s_waitcnt lgkmcnt(10)
    v_mfma_f32_32x32x16_bf16 v[92:107], v[152:155], v[68:71], v[92:107]
    v_exp_f32 v27, v27
    v_cvt_pk_bf16_f32 v21, v22, v23
    v_cvt_pk_bf16_f32 v22, v24, v25
    v_cvt_pk_bf16_f32 v23, v26, v27
    v_exp_f32 v28, v28
    v_exp_f32 v29, v29
    v_exp_f32 v30, v30
    v_mfma_f32_32x32x16_bf16 v[44:59], v[116:119], v[8:11], v[76:91]
    v_exp_f32 v31, v31
    v_exp_f32 v32, v32
    v_exp_f32 v33, v33
    v_cvt_pk_bf16_f32 v28, v28, v29
    v_exp_f32 v34, v34
    v_exp_f32 v35, v35
    v_mfma_f32_32x32x16_bf16 v[60:75], v[120:123], v[8:11], v[76:91]
    v_cvt_pk_bf16_f32 v29, v30, v31
    v_exp_f32 v36, v36
    v_exp_f32 v37, v37
    v_cvt_pk_bf16_f32 v30, v32, v33
    v_exp_f32 v38, v38
    v_exp_f32 v39, v39
    v_cvt_pk_bf16_f32 v31, v34, v35
    s_waitcnt vmcnt(6)
    v_mfma_f32_32x32x16_bf16 v[192:207], v[176:179], v[184:187], v[192:207]
    v_exp_f32 v40, v40
    v_exp_f32 v41, v41
    v_cvt_pk_bf16_f32 v36, v36, v37
    v_exp_f32 v42, v42
    v_exp_f32 v43, v43
    v_cvt_pk_bf16_f32 v37, v38, v39
    v_cvt_pk_bf16_f32 v38, v40, v41
    s_waitcnt vmcnt(4)
    v_mfma_f32_32x32x16_bf16 v[208:223], v[176:179], v[188:191], v[208:223]
    buffer_load_dwordx4 v[176:179], v1, s[36:39], s21 offen
    v_cvt_pk_bf16_f32 v39, v42, v43
    ds_read_b128 v[116:119], v2 offset:6144
    ds_read_b128 v[120:123], v2 offset:7168
    v_exp_f32 v44, v44
    v_exp_f32 v45, v45
    v_exp_f32 v46, v46
    s_waitcnt lgkmcnt(10)
    v_mfma_f32_32x32x16_bf16 v[92:107], v[124:127], v[12:15], v[92:107]
    v_exp_f32 v47, v47
    v_exp_f32 v48, v48
    v_exp_f32 v49, v49
    v_cvt_pk_bf16_f32 v44, v44, v45
    v_exp_f32 v50, v50
    v_exp_f32 v51, v51
    v_mfma_f32_32x32x16_bf16 v[224:239], v[180:183], v[184:187], v[224:239]
    buffer_load_dwordx4 v[184:187], v1, s[36:39], s18 offen offset:1024
    v_cvt_pk_bf16_f32 v45, v46, v47
    v_exp_f32 v52, v52
    v_exp_f32 v53, v53
    v_cvt_pk_bf16_f32 v46, v48, v49
    v_exp_f32 v54, v54
    ds_read_b64_tr_b16 v[140:141], v3 offset:0
    s_waitcnt lgkmcnt(7)
    v_mfma_f32_32x32x16_bf16 v[92:107], v[128:131], v[20:23], v[92:107]
    v_exp_f32 v55, v55
    v_cvt_pk_bf16_f32 v47, v50, v51
    v_exp_f32 v56, v56
    v_exp_f32 v57, v57
    v_cvt_pk_bf16_f32 v52, v52, v53
    v_exp_f32 v58, v58
    ds_read_b64_tr_b16 v[142:143], v3 offset:256
    v_mfma_f32_32x32x16_bf16 v[240:255], v[180:183], v[188:191], v[240:255]
    buffer_load_dwordx4 v[180:183], v1, s[36:39], s21 offen offset:1024
    v_exp_f32 v59, v59
    v_cvt_pk_bf16_f32 v53, v54, v55
    v_cvt_pk_bf16_f32 v54, v56, v57
    v_cvt_pk_bf16_f32 v55, v58, v59
    ds_read_b64_tr_b16 v[144:145], v3 offset:512
    ds_read_b64_tr_b16 v[146:147], v3 offset:768
    v_add_u32 v3, v4, v3
    ds_read_b64_tr_b16 v[148:149], v3 offset:0
    s_waitcnt lgkmcnt(9)
    v_mfma_f32_32x32x16_bf16 v[92:107], v[132:135], v[28:31], v[92:107]
    buffer_load_dwordx4 v[188:191], v1, s[36:39], s19 offen offset:1024
    ds_read_b64_tr_b16 v[150:151], v3 offset:256
    ds_read_b64_tr_b16 v[152:153], v3 offset:512
    ds_read_b64_tr_b16 v[154:155], v3 offset:768
    v_add_u32 v3, v4, v3
    s_waitcnt lgkmcnt(10)
    v_mfma_f32_32x32x16_bf16 v[92:107], v[136:139], v[36:39], v[92:107]
    v_add_u32 v2, 4096, v2
    s_add_u32 s20, s20, 32768
    s_add_u32 s21, s21, 32768
    s_add_u32 s18, s18, 2048
    s_add_u32 s19, s19, 2048
    s_sub_u32 s16, s16, 1
    s_cmp_lg_u32 s16, 0
    s_cbranch_scc1 M_LOOP
    s_waitcnt lgkmcnt(6)
    v_mfma_f32_32x32x16_bf16 v[92:107], v[140:143], v[44:47], v[92:107]
    s_waitcnt lgkmcnt(4)
    v_mfma_f32_32x32x16_bf16 v[92:107], v[144:147], v[52:55], v[92:107]
    v_exp_f32 v60, v60
    v_exp_f32 v61, v61
    v_exp_f32 v62, v62
    v_exp_f32 v63, v63
    v_exp_f32 v64, v64
    v_exp_f32 v65, v65
    v_cvt_pk_bf16_f32 v60, v60, v61
    v_exp_f32 v66, v66
    v_exp_f32 v67, v67
    v_cvt_pk_bf16_f32 v61, v62, v63
    v_exp_f32 v68, v68
    v_exp_f32 v69, v69
    v_cvt_pk_bf16_f32 v62, v64, v65
    v_exp_f32 v70, v70
    v_exp_f32 v71, v71
    v_cvt_pk_bf16_f32 v63, v66, v67
    v_exp_f32 v72, v72
    v_exp_f32 v73, v73
    v_cvt_pk_bf16_f32 v68, v68, v69
    v_exp_f32 v74, v74
    v_exp_f32 v75, v75
    v_cvt_pk_bf16_f32 v69, v70, v71
    v_cvt_pk_bf16_f32 v70, v72, v73
    v_cvt_pk_bf16_f32 v71, v74, v75
    s_waitcnt lgkmcnt(2)
    v_mfma_f32_32x32x16_bf16 v[92:107], v[148:151], v[60:63], v[92:107]
    s_nop 0
    s_waitcnt lgkmcnt(0)
    v_mfma_f32_32x32x16_bf16 v[92:107], v[152:155], v[68:71], v[92:107]
    s_waitcnt vmcnt(0)
    s_nop 10
    v_mov_b32 v160, v100
    s_nop 1
    v_permlane32_swap_b32 v160, v100
    v_max3_f32 v161, |v92|, |v93|, |v94|
    v_max3_f32 v161, v161, |v95|, |v96|
    v_max3_f32 v161, v161, |v97|, |v98|
    v_add_f32 v162, v92, v93
    v_add_f32 v163, v94, v95
    v_add_f32 v162, v162, v96
    v_add_f32 v163, v163, v97
    v_add_f32 v162, v162, v98
    v_add_f32 v163, v163, v99
    v_max_f32 v161, v161, |v99|
    v_mov_b32 v164, 0x53800000
    v_mov_b32 v165, 0x7b800000
    v_cmp_nlt_f32 vcc, v160, v164
    v_cmp_nlt_f32 s[48:49], v161, v165
    v_cmp_u_f32 s[50:51], v162, v163
    s_or_b64 vcc, vcc, s[48:49]
    s_or_b64 vcc, vcc, s[50:51]
    s_cbranch_vccnz M_SAFE
M_BACK:
    v_rcp_f32 v160, v160
    s_nop 0
    v_mul_f32 v92, v92, v160
    v_mul_f32 v93, v93, v160
    v_mul_f32 v94, v94, v160
    v_mul_f32 v95, v95, v160
    v_mul_f32 v96, v96, v160
    v_mul_f32 v97, v97, v160
    v_mul_f32 v98, v98, v160
    v_mul_f32 v99, v99, v160
    v_cvt_pk_bf16_f32 v92, v92, v93
    v_cvt_pk_bf16_f32 v93, v94, v95
    v_cvt_pk_bf16_f32 v94, v96, v97
    v_cvt_pk_bf16_f32 v95, v98, v99
    buffer_store_dwordx4 v[92:95], v1, s[36:39], s22 offen sc1
    s_waitcnt vmcnt(0)
    s_and_b32 s48, s3, 1
    s_lshl_b32 s48, s48, 18
    s_lshl_b32 s49, s25, 11
    s_add_u32 s48, s48, s49
    s_lshr_b32 s49, s3, 2
    s_lshl_b32 s49, s49, 10
    s_add_u32 s48, s48, s49
    s_add_u32 s48, s48, 88080384
    s_add_u32 s49, s48, 0
    buffer_load_dwordx4 v[108:111], v1, s[36:39], s49 offen
    s_add_u32 s49, s48, 16384
    buffer_load_dwordx4 v[112:115], v1, s[36:39], s49 offen
    s_add_u32 s49, s48, 32768
    buffer_load_dwordx4 v[116:119], v1, s[36:39], s49 offen
    s_add_u32 s49, s48, 49152
    buffer_load_dwordx4 v[120:123], v1, s[36:39], s49 offen
    s_add_u32 s49, s48, 65536
    buffer_load_dwordx4 v[124:127], v1, s[36:39], s49 offen
    s_add_u32 s49, s48, 81920
    buffer_load_dwordx4 v[128:131], v1, s[36:39], s49 offen
    s_add_u32 s49, s48, 98304
    buffer_load_dwordx4 v[132:135], v1, s[36:39], s49 offen
    s_add_u32 s49, s48, 114688
    buffer_load_dwordx4 v[136:139], v1, s[36:39], s49 offen
    s_add_u32 s49, s48, 131072
    buffer_load_dwordx4 v[140:143], v1, s[36:39], s49 offen
    s_add_u32 s49, s48, 147456
    buffer_load_dwordx4 v[144:147], v1, s[36:39], s49 offen
    s_add_u32 s49, s48, 163840
    buffer_load_dwordx4 v[148:151], v1, s[36:39], s49 offen
    s_add_u32 s49, s48, 180224
    buffer_load_dwordx4 v[152:155], v1, s[36:39], s49 offen
    s_add_u32 s49, s48, 196608
    buffer_load_dwordx4 v[76:79], v1, s[36:39], s49 offen
    s_add_u32 s49, s48, 212992
    buffer_load_dwordx4 v[80:83], v1, s[36:39], s49 offen
    s_add_u32 s49, s48, 229376
    buffer_load_dwordx4 v[84:87], v1, s[36:39], s49 offen
    s_add_u32 s49, s48, 245760
    buffer_load_dwordx4 v[88:91], v1, s[36:39], s49 offen
    s_lshl_b32 s48, s24, 6
    s_lshr_b32 s49, s3, 1
    s_and_b32 s49, s49, 1
    s_lshl_b32 s49, s49, 5
    s_add_u32 s48, s48, s49
    v_and_b32 v165, 31, v0
    v_add_u32 v165, s48, v165
    v_lshlrev_b32 v166, 3, v165
    s_mov_b32 s50, 69337088
    buffer_load_dwordx2 v[6:7], v166, s[36:39], s50 offen
    s_lshl_b32 s48, s25, 7
    s_lshr_b32 s49, s3, 2
    s_lshl_b32 s49, s49, 6
    s_add_u32 s48, s48, s49
    s_and_b32 s49, s3, 1
    s_lshl_b32 s49, s49, 5
    s_add_u32 s48, s48, s49
    v_lshlrev_b32 v165, 10, v165
    v_lshrrev_b32 v166, 5, v0
    v_lshl_add_u32 v165, v166, 4, v165
    v_add_u32 v165, s48, v165
    s_barrier
    s_cmp_lg_u32 s3, 0
    s_cbranch_scc1 M_NOSIG
    s_lshr_b32 s48, s2, 5
    s_lshl_b32 s48, s48, 8
    s_add_u32 s48, s48, 89128960
    v_mov_b32 v163, s48
    v_mov_b32 v164, 1
    s_mov_b64 exec, 1
    global_atomic_add v163, v164, s[34:35]
    s_mov_b64 exec, -1
M_NOSIG:
    s_lshl_b32 s48, s3, 14
    v_add_u32 v160, s48, v1
    s_lshl_b32 s48, s3, 11
    v_add_u32 v161, s48, v1
    v_add_u32 v162, 65536, v161
    ds_write_b128 v160, v[192:195] offset:0
    ds_write_b128 v160, v[196:199] offset:1024
    ds_write_b128 v160, v[200:203] offset:2048
    ds_write_b128 v160, v[204:207] offset:3072
    ds_write_b128 v160, v[208:211] offset:4096
    ds_write_b128 v160, v[212:215] offset:5120
    ds_write_b128 v160, v[216:219] offset:6144
    ds_write_b128 v160, v[220:223] offset:7168
    ds_write_b128 v160, v[224:227] offset:8192
    ds_write_b128 v160, v[228:231] offset:9216
    ds_write_b128 v160, v[232:235] offset:10240
    ds_write_b128 v160, v[236:239] offset:11264
    ds_write_b128 v160, v[240:243] offset:12288
    ds_write_b128 v160, v[244:247] offset:13312
    ds_write_b128 v160, v[248:251] offset:14336
    ds_write_b128 v160, v[252:255] offset:15360
    s_waitcnt lgkmcnt(0)
    s_barrier
    ds_read_b128 v[12:15], v161 offset:0
    ds_read_b128 v[16:19], v161 offset:1024
    ds_read_b128 v[20:23], v161 offset:16384
    ds_read_b128 v[24:27], v161 offset:17408
    ds_read_b128 v[28:31], v161 offset:32768
    ds_read_b128 v[32:35], v161 offset:33792
    ds_read_b128 v[36:39], v161 offset:49152
    ds_read_b128 v[40:43], v161 offset:50176
    ds_read_b128 v[44:47], v162 offset:0
    ds_read_b128 v[48:51], v162 offset:1024
    ds_read_b128 v[52:55], v162 offset:16384
    ds_read_b128 v[56:59], v162 offset:17408
    ds_read_b128 v[60:63], v162 offset:32768
    ds_read_b128 v[64:67], v162 offset:33792
    ds_read_b128 v[68:71], v162 offset:49152
    ds_read_b128 v[72:75], v162 offset:50176
    s_waitcnt lgkmcnt(7)
    v_add_f32 v12, v12, v44
    v_add_f32 v13, v13, v45
    v_add_f32 v14, v14, v46
    v_add_f32 v15, v15, v47
    s_waitcnt lgkmcnt(6)
    v_add_f32 v16, v16, v48
    v_add_f32 v17, v17, v49
    v_add_f32 v18, v18, v50
    v_add_f32 v19, v19, v51
    s_waitcnt lgkmcnt(5)
    v_add_f32 v20, v20, v52
    v_add_f32 v21, v21, v53
    v_add_f32 v22, v22, v54
    v_add_f32 v23, v23, v55
    s_waitcnt lgkmcnt(4)
    v_add_f32 v24, v24, v56
    v_add_f32 v25, v25, v57
    v_add_f32 v26, v26, v58
    v_add_f32 v27, v27, v59
    s_waitcnt lgkmcnt(3)
    v_add_f32 v28, v28, v60
    v_add_f32 v29, v29, v61
    v_add_f32 v30, v30, v62
    v_add_f32 v31, v31, v63
    s_waitcnt lgkmcnt(2)
    v_add_f32 v32, v32, v64
    v_add_f32 v33, v33, v65
    v_add_f32 v34, v34, v66
    v_add_f32 v35, v35, v67
    s_waitcnt lgkmcnt(1)
    v_add_f32 v36, v36, v68
    v_add_f32 v37, v37, v69
    v_add_f32 v38, v38, v70
    v_add_f32 v39, v39, v71
    s_waitcnt lgkmcnt(0)
    v_add_f32 v40, v40, v72
    v_add_f32 v41, v41, v73
    v_add_f32 v42, v42, v74
    v_add_f32 v43, v43, v75
    v_add_f32 v12, v12, v28
    v_add_f32 v13, v13, v29
    v_add_f32 v14, v14, v30
    v_add_f32 v15, v15, v31
    v_add_f32 v16, v16, v32
    v_add_f32 v17, v17, v33
    v_add_f32 v18, v18, v34
    v_add_f32 v19, v19, v35
    v_add_f32 v20, v20, v36
    v_add_f32 v21, v21, v37
    v_add_f32 v22, v22, v38
    v_add_f32 v23, v23, v39
    v_add_f32 v24, v24, v40
    v_add_f32 v25, v25, v41
    v_add_f32 v26, v26, v42
    v_add_f32 v27, v27, v43
    v_add_f32 v12, v12, v20
    v_add_f32 v13, v13, v21
    v_add_f32 v14, v14, v22
    v_add_f32 v15, v15, v23
    v_add_f32 v16, v16, v24
    v_add_f32 v17, v17, v25
    v_add_f32 v18, v18, v26
    v_add_f32 v19, v19, v27
    v_cvt_pk_bf16_f32 v156, v12, v13
    v_cvt_pk_bf16_f32 v157, v14, v15
    v_cvt_pk_bf16_f32 v158, v16, v17
    v_cvt_pk_bf16_f32 v159, v18, v19
    s_cmp_lg_u32 s3, 0
    s_cbranch_scc1 M_READY
    s_lshr_b32 s48, s24, 2
    s_lshl_b32 s48, s48, 8
    s_add_u32 s48, s48, 89128960
    v_mov_b32 v163, s48
    s_mov_b32 s49, 200000
M_POLL:
    global_load_dword v164, v163, s[34:35] sc0 sc1
    s_waitcnt vmcnt(0)
    v_readfirstlane_b32 s48, v164
    s_nop 3
    s_cmp_ge_u32 s48, 32
    s_cbranch_scc1 M_READY
    s_sleep 2
    s_sub_u32 s49, s49, 1
    s_cmp_lg_u32 s49, 0
    s_cbranch_scc1 M_POLL
M_READY:
    s_barrier
    s_lshl_b32 s48, s24, 16
    s_lshr_b32 s49, s3, 1
    s_and_b32 s49, s49, 1
    s_lshl_b32 s49, s49, 15
    s_add_u32 s48, s48, s49
    s_and_b32 s49, s3, 1
    s_lshl_b32 s49, s49, 14
    s_add_u32 s48, s48, s49
    s_add_u32 s48, s48, 71303168
    s_add_u32 s49, s48, 0
    buffer_load_dwordx4 v[12:15], v1, s[36:39], s49 offen offset:0 sc1
    buffer_load_dwordx4 v[16:19], v1, s[36:39], s49 offen offset:1024 sc1
    buffer_load_dwordx4 v[20:23], v1, s[36:39], s49 offen offset:2048 sc1
    buffer_load_dwordx4 v[24:27], v1, s[36:39], s49 offen offset:3072 sc1
    s_add_u32 s49, s48, 4096
    buffer_load_dwordx4 v[28:31], v1, s[36:39], s49 offen offset:0 sc1
    buffer_load_dwordx4 v[32:35], v1, s[36:39], s49 offen offset:1024 sc1
    buffer_load_dwordx4 v[36:39], v1, s[36:39], s49 offen offset:2048 sc1
    buffer_load_dwordx4 v[40:43], v1, s[36:39], s49 offen offset:3072 sc1
    s_add_u32 s49, s48, 8192
    buffer_load_dwordx4 v[44:47], v1, s[36:39], s49 offen offset:0 sc1
    buffer_load_dwordx4 v[48:51], v1, s[36:39], s49 offen offset:1024 sc1
    buffer_load_dwordx4 v[52:55], v1, s[36:39], s49 offen offset:2048 sc1
    buffer_load_dwordx4 v[56:59], v1, s[36:39], s49 offen offset:3072 sc1
    s_add_u32 s49, s48, 12288
    buffer_load_dwordx4 v[60:63], v1, s[36:39], s49 offen offset:0 sc1
    buffer_load_dwordx4 v[64:67], v1, s[36:39], s49 offen offset:1024 sc1
    buffer_load_dwordx4 v[68:71], v1, s[36:39], s49 offen offset:2048 sc1
    buffer_load_dwordx4 v[72:75], v1, s[36:39], s49 offen offset:3072 sc1
    s_waitcnt vmcnt(15)
    v_mfma_f32_32x32x16_bf16 v[192:207], v[108:111], v[12:15], 0
    s_waitcnt vmcnt(14)
    v_mfma_f32_32x32x16_bf16 v[208:223], v[112:115], v[16:19], 0
    s_waitcnt vmcnt(13)
    v_mfma_f32_32x32x16_bf16 v[192:207], v[116:119], v[20:23], v[192:207]
    s_waitcnt vmcnt(12)
    v_mfma_f32_32x32x16_bf16 v[208:223], v[120:123], v[24:27], v[208:223]
    s_waitcnt vmcnt(11)
    v_mfma_f32_32x32x16_bf16 v[192:207], v[124:127], v[28:31], v[192:207]
    s_waitcnt vmcnt(10)
    v_mfma_f32_32x32x16_bf16 v[208:223], v[128:131], v[32:35], v[208:223]
    s_waitcnt vmcnt(9)
    v_mfma_f32_32x32x16_bf16 v[192:207], v[132:135], v[36:39], v[192:207]
    s_waitcnt vmcnt(8)
    v_mfma_f32_32x32x16_bf16 v[208:223], v[136:139], v[40:43], v[208:223]
    s_waitcnt vmcnt(7)
    v_mfma_f32_32x32x16_bf16 v[192:207], v[140:143], v[44:47], v[192:207]
    s_waitcnt vmcnt(6)
    v_mfma_f32_32x32x16_bf16 v[208:223], v[144:147], v[48:51], v[208:223]
    s_waitcnt vmcnt(5)
    v_mfma_f32_32x32x16_bf16 v[192:207], v[148:151], v[52:55], v[192:207]
    s_waitcnt vmcnt(4)
    v_mfma_f32_32x32x16_bf16 v[208:223], v[152:155], v[56:59], v[208:223]
    s_waitcnt vmcnt(3)
    v_mfma_f32_32x32x16_bf16 v[192:207], v[76:79], v[60:63], v[192:207]
    s_waitcnt vmcnt(2)
    v_mfma_f32_32x32x16_bf16 v[208:223], v[80:83], v[64:67], v[208:223]
    s_waitcnt vmcnt(1)
    v_mfma_f32_32x32x16_bf16 v[192:207], v[84:87], v[68:71], v[192:207]
    s_waitcnt vmcnt(0)
    v_mfma_f32_32x32x16_bf16 v[208:223], v[88:91], v[72:75], v[208:223]
    s_nop 11
    v_add_f32 v192, v192, v208
    v_add_f32 v193, v193, v209
    v_add_f32 v194, v194, v210
    v_add_f32 v195, v195, v211
    v_add_f32 v196, v196, v212
    v_add_f32 v197, v197, v213
    v_add_f32 v198, v198, v214
    v_add_f32 v199, v199, v215
    v_add_f32 v200, v200, v216
    v_add_f32 v201, v201, v217
    v_add_f32 v202, v202, v218
    v_add_f32 v203, v203, v219
    v_add_f32 v204, v204, v220
    v_add_f32 v205, v205, v221
    v_add_f32 v206, v206, v222
    v_add_f32 v207, v207, v223
    s_bitcmp1_b32 s3, 0
    s_cselect_b64 vcc, -1, 0
    v_cndmask_b32 v208, v200, v192, vcc
    v_cndmask_b32 v192, v192, v200, vcc
    v_cndmask_b32 v209, v201, v193, vcc
    v_cndmask_b32 v193, v193, v201, vcc
    v_cndmask_b32 v210, v202, v194, vcc
    v_cndmask_b32 v194, v194, v202, vcc
    v_cndmask_b32 v211, v203, v195, vcc
    v_cndmask_b32 v195, v195, v203, vcc
    v_cndmask_b32 v212, v204, v196, vcc
    v_cndmask_b32 v196, v196, v204, vcc
    v_cndmask_b32 v213, v205, v197, vcc
    v_cndmask_b32 v197, v197, v205, vcc
    v_cndmask_b32 v214, v206, v198, vcc
    v_cndmask_b32 v198, v198, v206, vcc
    v_cndmask_b32 v215, v207, v199, vcc
    v_cndmask_b32 v199, v199, v207, vcc
    s_lshl_b32 s48, s3, 11
    s_add_u32 s48, s48, 0
    v_add_u32 v161, s48, v1
    v_xor_b32 v162, 2048, v161
    s_barrier
    ds_write_b128 v161, v[208:211]
    ds_write_b128 v161, v[212:215] offset:1024
    s_waitcnt lgkmcnt(0)
    s_barrier
    ds_read_b128 v[208:211], v162
    ds_read_b128 v[212:215], v162 offset:1024
    s_waitcnt lgkmcnt(1)
    v_add_f32 v192, v192, v208
    v_add_f32 v193, v193, v209
    v_add_f32 v194, v194, v210
    v_add_f32 v195, v195, v211
    s_waitcnt lgkmcnt(0)
    v_add_f32 v196, v196, v212
    v_add_f32 v197, v197, v213
    v_add_f32 v198, v198, v214
    v_add_f32 v199, v199, v215
    s_mov_b32 s48, 0xffff0000
    v_cvt_pk_bf16_f32 v192, v192, v193
    v_and_b32 v193, s48, v192
    v_lshlrev_b32 v192, 16, v192
    v_and_b32 v21, s48, v156
    v_lshlrev_b32 v20, 16, v156
    v_mul_f32 v192, v192, v6
    v_mul_f32 v193, v193, v6
    v_mul_f32 v20, v20, v7
    v_mul_f32 v21, v21, v7
    v_cvt_pk_bf16_f32 v192, v192, v193
    v_cvt_pk_bf16_f32 v20, v20, v21
    v_and_b32 v193, s48, v192
    v_lshlrev_b32 v192, 16, v192
    v_and_b32 v21, s48, v20
    v_lshlrev_b32 v20, 16, v20
    v_add_f32 v192, v192, v20
    v_add_f32 v193, v193, v21
    v_cvt_pk_bf16_f32 v28, v192, v193
    v_cvt_pk_bf16_f32 v194, v194, v195
    v_and_b32 v195, s48, v194
    v_lshlrev_b32 v194, 16, v194
    v_and_b32 v23, s48, v157
    v_lshlrev_b32 v22, 16, v157
    v_mul_f32 v194, v194, v6
    v_mul_f32 v195, v195, v6
    v_mul_f32 v22, v22, v7
    v_mul_f32 v23, v23, v7
    v_cvt_pk_bf16_f32 v194, v194, v195
    v_cvt_pk_bf16_f32 v22, v22, v23
    v_and_b32 v195, s48, v194
    v_lshlrev_b32 v194, 16, v194
    v_and_b32 v23, s48, v22
    v_lshlrev_b32 v22, 16, v22
    v_add_f32 v194, v194, v22
    v_add_f32 v195, v195, v23
    v_cvt_pk_bf16_f32 v29, v194, v195
    v_cvt_pk_bf16_f32 v196, v196, v197
    v_and_b32 v197, s48, v196
    v_lshlrev_b32 v196, 16, v196
    v_and_b32 v25, s48, v158
    v_lshlrev_b32 v24, 16, v158
    v_mul_f32 v196, v196, v6
    v_mul_f32 v197, v197, v6
    v_mul_f32 v24, v24, v7
    v_mul_f32 v25, v25, v7
    v_cvt_pk_bf16_f32 v196, v196, v197
    v_cvt_pk_bf16_f32 v24, v24, v25
    v_and_b32 v197, s48, v196
    v_lshlrev_b32 v196, 16, v196
    v_and_b32 v25, s48, v24
    v_lshlrev_b32 v24, 16, v24
    v_add_f32 v196, v196, v24
    v_add_f32 v197, v197, v25
    v_cvt_pk_bf16_f32 v30, v196, v197
    v_cvt_pk_bf16_f32 v198, v198, v199
    v_and_b32 v199, s48, v198
    v_lshlrev_b32 v198, 16, v198
    v_and_b32 v27, s48, v159
    v_lshlrev_b32 v26, 16, v159
    v_mul_f32 v198, v198, v6
    v_mul_f32 v199, v199, v6
    v_mul_f32 v26, v26, v7
    v_mul_f32 v27, v27, v7
    v_cvt_pk_bf16_f32 v198, v198, v199
    v_cvt_pk_bf16_f32 v26, v26, v27
    v_and_b32 v199, s48, v198
    v_lshlrev_b32 v198, 16, v198
    v_and_b32 v27, s48, v26
    v_lshlrev_b32 v26, 16, v26
    v_add_f32 v198, v198, v26
    v_add_f32 v199, v199, v27
    v_cvt_pk_bf16_f32 v31, v198, v199
    buffer_store_dwordx4 v[28:31], v165, s[44:47], 0 offen
M_END:
    s_endpgm
M_SAFE:
    s_waitcnt vmcnt(0) lgkmcnt(0)
    s_nop 7
    s_nop 7
    v_mov_b32 v2, v1
    v_mov_b32 v3, v5
    v_mov_b32 v166, 0xff7fffff
    s_mov_b32 s16, 32
    v_mov_b32 v92, 0
    v_mov_b32 v93, 0
    v_mov_b32 v94, 0
    v_mov_b32 v95, 0
    v_mov_b32 v96, 0
    v_mov_b32 v97, 0
    v_mov_b32 v98, 0
    v_mov_b32 v99, 0
    v_mov_b32 v100, 0
    v_mov_b32 v101, 0
    v_mov_b32 v102, 0
    v_mov_b32 v103, 0
    v_mov_b32 v104, 0
    v_mov_b32 v105, 0
    v_mov_b32 v106, 0
    v_mov_b32 v107, 0
M_SLOOP:
    ds_read_b128 v[108:111], v2 offset:0
    ds_read_b128 v[112:115], v2 offset:1024
    ds_read_b64_tr_b16 v[124:125], v3 offset:0
    ds_read_b64_tr_b16 v[126:127], v3 offset:256
    ds_read_b64_tr_b16 v[128:129], v3 offset:512
    ds_read_b64_tr_b16 v[130:131], v3 offset:768
    v_add_u32 v3, v4, v3
    ds_read_b64_tr_b16 v[132:133], v3 offset:0
    ds_read_b64_tr_b16 v[134:135], v3 offset:256
    ds_read_b64_tr_b16 v[136:137], v3 offset:512
    ds_read_b64_tr_b16 v[138:139], v3 offset:768
    v_add_u32 v3, v4, v3
    v_add_u32 v2, 2048, v2
    s_waitcnt lgkmcnt(9)
    v_mfma_f32_32x32x16_bf16 v[12:27], v[108:111], v[8:11], 0
    s_waitcnt lgkmcnt(8)
    v_mfma_f32_32x32x16_bf16 v[28:43], v[112:115], v[8:11], 0
    s_nop 10
    v_max3_f32 v160, v12, v13, v14
    v_max3_f32 v160, v160, v15, v16
    v_max3_f32 v160, v160, v17, v18
    v_max3_f32 v160, v160, v19, v20
    v_max3_f32 v160, v160, v21, v22
    v_max3_f32 v160, v160, v23, v24
    v_max3_f32 v160, v160, v25, v26
    v_max_f32 v160, v160, v27
    v_max3_f32 v161, v28, v29, v30
    v_max3_f32 v161, v161, v31, v32
    v_max3_f32 v161, v161, v33, v34
    v_max3_f32 v161, v161, v35, v36
    v_max3_f32 v161, v161, v37, v38
    v_max3_f32 v161, v161, v39, v40
    v_max3_f32 v161, v161, v41, v42
    v_max3_f32 v160, v160, v161, v43
    v_mov_b32 v161, v160
    s_nop 1
    v_permlane32_swap_b32 v161, v160
    v_max_f32 v160, v160, v161
    v_max_f32 v160, v160, v166
    v_sub_f32 v161, v166, v160
    v_exp_f32 v161, v161
    v_mov_b32 v166, v160
    v_sub_f32 v12, v12, v160
    v_sub_f32 v13, v13, v160
    v_sub_f32 v14, v14, v160
    v_sub_f32 v15, v15, v160
    v_sub_f32 v16, v16, v160
    v_sub_f32 v17, v17, v160
    v_sub_f32 v18, v18, v160
    v_sub_f32 v19, v19, v160
    v_sub_f32 v20, v20, v160
    v_sub_f32 v21, v21, v160
    v_sub_f32 v22, v22, v160
    v_sub_f32 v23, v23, v160
    v_sub_f32 v24, v24, v160
    v_sub_f32 v25, v25, v160
    v_sub_f32 v26, v26, v160
    v_sub_f32 v27, v27, v160
    v_sub_f32 v28, v28, v160
    v_sub_f32 v29, v29, v160
    v_sub_f32 v30, v30, v160
    v_sub_f32 v31, v31, v160
    v_sub_f32 v32, v32, v160
    v_sub_f32 v33, v33, v160
    v_sub_f32 v34, v34, v160
    v_sub_f32 v35, v35, v160
    v_sub_f32 v36, v36, v160
    v_sub_f32 v37, v37, v160
    v_sub_f32 v38, v38, v160
    v_sub_f32 v39, v39, v160
    v_sub_f32 v40, v40, v160
    v_sub_f32 v41, v41, v160
    v_sub_f32 v42, v42, v160
    v_sub_f32 v43, v43, v160
    v_mul_f32 v92, v92, v161
    v_mul_f32 v93, v93, v161
    v_mul_f32 v94, v94, v161
    v_mul_f32 v95, v95, v161
    v_mul_f32 v96, v96, v161
    v_mul_f32 v97, v97, v161
    v_mul_f32 v98, v98, v161
    v_mul_f32 v99, v99, v161
    v_mul_f32 v100, v100, v161
    v_mul_f32 v101, v101, v161
    v_mul_f32 v102, v102, v161
    v_mul_f32 v103, v103, v161
    v_mul_f32 v104, v104, v161
    v_mul_f32 v105, v105, v161
    v_mul_f32 v106, v106, v161
    v_mul_f32 v107, v107, v161
    v_exp_f32 v12, v12
    v_exp_f32 v13, v13
    v_exp_f32 v14, v14
    v_exp_f32 v15, v15
    v_exp_f32 v16, v16
    v_exp_f32 v17, v17
    v_cvt_pk_bf16_f32 v12, v12, v13
    v_exp_f32 v18, v18
    v_exp_f32 v19, v19
    v_cvt_pk_bf16_f32 v13, v14, v15
    v_exp_f32 v20, v20
    v_exp_f32 v21, v21
    v_cvt_pk_bf16_f32 v14, v16, v17
    v_exp_f32 v22, v22
    v_exp_f32 v23, v23
    v_cvt_pk_bf16_f32 v15, v18, v19
    v_exp_f32 v24, v24
    v_exp_f32 v25, v25
    v_cvt_pk_bf16_f32 v20, v20, v21
    v_exp_f32 v26, v26
    v_exp_f32 v27, v27
    v_cvt_pk_bf16_f32 v21, v22, v23
    v_cvt_pk_bf16_f32 v22, v24, v25
    v_cvt_pk_bf16_f32 v23, v26, v27
    v_exp_f32 v28, v28
    v_exp_f32 v29, v29
    v_exp_f32 v30, v30
    v_exp_f32 v31, v31
    v_exp_f32 v32, v32
    v_exp_f32 v33, v33
    v_cvt_pk_bf16_f32 v28, v28, v29
    v_exp_f32 v34, v34
    v_exp_f32 v35, v35
    v_cvt_pk_bf16_f32 v29, v30, v31
    v_exp_f32 v36, v36
    v_exp_f32 v37, v37
    v_cvt_pk_bf16_f32 v30, v32, v33
    v_exp_f32 v38, v38
    v_exp_f32 v39, v39
    v_cvt_pk_bf16_f32 v31, v34, v35
    v_exp_f32 v40, v40
    v_exp_f32 v41, v41
    v_cvt_pk_bf16_f32 v36, v36, v37
    v_exp_f32 v42, v42
    v_exp_f32 v43, v43
    v_cvt_pk_bf16_f32 v37, v38, v39
    v_cvt_pk_bf16_f32 v38, v40, v41
    v_cvt_pk_bf16_f32 v39, v42, v43
    s_waitcnt lgkmcnt(6)
    v_mfma_f32_32x32x16_bf16 v[92:107], v[124:127], v[12:15], v[92:107]
    s_waitcnt lgkmcnt(4)
    v_mfma_f32_32x32x16_bf16 v[92:107], v[128:131], v[20:23], v[92:107]
    s_waitcnt lgkmcnt(2)
    v_mfma_f32_32x32x16_bf16 v[92:107], v[132:135], v[28:31], v[92:107]
    s_waitcnt lgkmcnt(0)
    v_mfma_f32_32x32x16_bf16 v[92:107], v[136:139], v[36:39], v[92:107]
    s_nop 7
    s_nop 7
    s_sub_u32 s16, s16, 1
    s_cmp_lg_u32 s16, 0
    s_cbranch_scc1 M_SLOOP
    v_mov_b32 v160, v100
    s_nop 1
    v_permlane32_swap_b32 v160, v100
    s_nop 1
    s_branch M_BACK
TEXT_END:
.section .rodata,"a"
.p2align 6
.amdhsa_kernel projattn_kernel
  .amdhsa_next_free_vgpr 512
  .amdhsa_next_free_sgpr 102
  .amdhsa_accum_offset 256
  .amdhsa_group_segment_fixed_size 0
  .amdhsa_kernarg_size 120
  .amdhsa_user_sgpr_count 2
  .amdhsa_user_sgpr_kernarg_segment_ptr 1
  .amdhsa_system_sgpr_workgroup_id_x 1
.end_amdhsa_kernel
.p2align 6
.amdhsa_kernel mqa_kernel
  .amdhsa_next_free_vgpr 256
  .amdhsa_next_free_sgpr 102
  .amdhsa_accum_offset 256
  .amdhsa_group_segment_fixed_size 0
  .amdhsa_kernarg_size 120
  .amdhsa_user_sgpr_count 2
  .amdhsa_user_sgpr_kernarg_segment_ptr 1
  .amdhsa_system_sgpr_workgroup_id_x 1
.end_amdhsa_kernel
```
